```python
import torch

def _softmax(x, axis=-1):
    return torch.softmax(x, dim=axis)

def _gelu(x):
    return torch.nn.functional.gelu(x, approximate='tanh')

def _silu(x):
    return torch.nn.functional.silu(x)

def _sigmoid(x):
    return torch.sigmoid(x)

def _layernorm(x, axis=-1, eps=1e-05):
    m = x.mean(dim=axis, keepdim=True)
    v = x.var(dim=axis, keepdim=True, unbiased=False)
    return (x - m) / torch.sqrt(v + eps)

def _scatter_add(tgt, idx, src, axis=0):
    return tgt.clone().index_add_(axis, idx, src)

def _segment_sum(src, seg, n):
    out = torch.zeros((n,) + src.shape[1:], dtype=src.dtype)
    return out.index_add_(0, seg, src)

def _pad(x, pw):
    flat = tuple((v for pair in reversed(pw) for v in pair))
    return torch.nn.functional.pad(x, flat)
kernel_name = 'adaLN_cond__sliding_block__moe_arch_mod__prompt'

def setup_inputs():

    _w = lambda a: (lambda t: t.to(torch.bfloat16) if t.is_floating_point() else t)(torch.as_tensor(a))

    def _A_setup():
        B, S, D = (1, 2048, 512)
        return {'x': _w((lambda *s: torch.randn(*s, dtype=torch.bfloat16) * 0.05)(B, S, D)), 'wqkv': _w((lambda *s: torch.randn(*s, dtype=torch.bfloat16) * 0.05)(D, 3 * D)), 'wo': _w((lambda *s: torch.randn(*s, dtype=torch.bfloat16) * 0.05)(D, D))}
    _A_in = _A_setup()

    def _B_setup():
        B, S, D, F, C = (1, 2048, 512, 1792, 2)
        return {'x': _w((lambda *s: torch.randn(*s, dtype=torch.bfloat16) * 0.05)(B, S, D)), 'w_r': _w((lambda *s: torch.randn(*s, dtype=torch.bfloat16) * 0.05)(D)), 'w_gate': _w((lambda *s: torch.randn(*s, dtype=torch.bfloat16) * 0.05)(D, F)), 'w_up': _w((lambda *s: torch.randn(*s, dtype=torch.bfloat16) * 0.05)(D, F)), 'w_down': _w((lambda *s: torch.randn(*s, dtype=torch.bfloat16) * 0.05)(F, D))}
    _B_in = _B_setup()
    return {'A_x': _A_in['x'], 'A_wqkv': _A_in['wqkv'], 'A_wo': _A_in['wo'], 'B_x': _B_in['x'], 'B_w_r': _B_in['w_r'], 'B_w_gate': _B_in['w_gate'], 'B_w_up': _B_in['w_up'], 'B_w_down': _B_in['w_down'], 'c': _w((lambda *s: torch.randn(*s, dtype=torch.bfloat16) * 0.1)(1, 512) * 8.0), 'w_mod': _w((lambda *s: torch.randn(*s, dtype=torch.bfloat16) * 0.1)(512, 6 * 512) * 512 ** (-0.5) * 8.0)}

def reference(A_x, A_wqkv, A_wo, B_x, B_w_r, B_w_gate, B_w_up, B_w_down, c, w_mod):

    def _A_ref(x, wqkv, wo):
        B, S, D = x.shape
        H = 32
        Dh = D // H
        W = 256
        qkv = (lambda x, *d: x.permute(*d))((x @ wqkv).reshape(B, S, 3, H, Dh), 2, 0, 3, 1, 4)
        q, k, v = (qkv[0], qkv[1], qkv[2])
        scores = torch.einsum('bhqd,bhkd->bhqk', q, k) * Dh ** (-0.5)
        idx = torch.arange(S)
        mask = (idx[:, None] - idx[None, :] >= 0) & (idx[:, None] - idx[None, :] < W)
        scores = torch.where(mask[None, None], scores, -1000000000.0)
        p = _softmax(scores, axis=-1)
        o = torch.einsum('bhqk,bhkd->bhqd', p, v)
        return (lambda x, *d: x.permute(*d))(o, 0, 2, 1, 3).reshape(B, S, D) @ wo

    def _B_ref(x, w_r, w_gate, w_up, w_down):
        B, S, D = x.shape
        C = 2
        r = x @ w_r
        idx = torch.argsort(-r, axis=-1)[:, :C]
        idx_e = (lambda x, n, axis: torch.repeat_interleave(x, n, dim=axis))(idx.reshape(B, C, 1), D, axis=2)
        x_sel = (lambda x, i, axis: torch.take_along_dim(x, i, dim=axis))(x, idx_e, axis=1)
        g = _silu(x_sel @ w_gate)
        u = x_sel @ w_up
        y = g * u @ w_down
        r_sel = _sigmoid((lambda x, i, axis: torch.take_along_dim(x, i, dim=axis))(r, idx, axis=1))
        y = y * r_sel.reshape(B, C, 1)
        b_off = (torch.arange(B) * S).reshape(B, 1)
        flat_idx = (idx + b_off).reshape(B * C)
        zero = (x * 0.0).reshape(B * S, D)
        upd = _scatter_add(zero, flat_idx, y.reshape(B * C, D), axis=0)
        return x + upd.reshape(B, S, D)
    x = A_x
    mod = (_silu(c) @ w_mod).reshape(c.shape[0], 6, 1, -1)
    sa, ca, ga, sb, cb, gb = (mod[:, 0].clone(), mod[:, 1].clone(), mod[:, 2].clone(), mod[:, 3].clone(), mod[:, 4].clone(), mod[:, 5].clone())
    h = _layernorm(x, axis=-1) * (1 + ca) + sa
    x = x + ga * _A_ref(h, A_wqkv, A_wo)
    h = _layernorm(x, axis=-1) * (1 + cb) + sb
    x = x + gb * _B_ref(h, B_w_r, B_w_gate, B_w_up, B_w_down)
    return x
```

```asm
; @launch grid=(256,1,1) block=(512,1,1) lds=163840
.amdgcn_target "amdgcn-amd-amdhsa--gfx950"
.text
.globl adaLN_cond__sliding_block__moe_arch_mod__prompt_kernel
.p2align 8
.type adaLN_cond__sliding_block__moe_arch_mod__prompt_kernel,@function
adaLN_cond__sliding_block__moe_arch_mod__prompt_kernel:
    s_getpc_b64 s[48:49]
L_pc:
    s_load_dwordx2 s[4:5], s[0:1], 0
    s_load_dwordx2 s[36:37], s[0:1], 72
    s_load_dwordx2 s[32:33], s[0:1], 64
    s_load_dwordx2 s[44:45], s[0:1], 96
    s_load_dwordx2 s[8:9], s[0:1], 8
    v_lshrrev_b32 v2, 8, v0
    v_mul_u32_u24 v2, L_helper-L_pc-4096-448, v2
    v_lshl_add_u32 v1, v0, 4, v2
    global_load_dwordx4 v[56:59], v1, s[48:49] offset:384
    s_cmpk_ge_u32 s2, 256
    s_cbranch_scc1 L_exit
    s_mov_b32 s51, 0x20000
    v_mov_b32 v1, 32768
    v_mov_b32 v2, 0
    ds_write_b32 v1, v2
    v_lshrrev_b32 v1, 6, v0
    v_and_b32 v4, 63, v0
    v_readfirstlane_b32 s52, v1
    v_bfe_u32 v5, v0, 3, 3
    v_and_b32 v6, 7, v0
    s_mov_b32 s38, 3145728
    s_mov_b32 s39, s51
    s_mov_b32 s34, 1024
    s_mov_b32 s35, s51
    s_mov_b32 s6, 2097152
    s_mov_b32 s7, s51
    s_lshr_b32 s96, s52, 2
    s_and_b32 s52, s52, 3
    s_bfe_u32 s55, s2, 0x30003
    s_and_b32 s53, s2, 6
    s_lshl2_add_u32 s53, s53, s55
    s_lshr_b32 s57, s2, 6
    s_add_u32 s55, s57, s55
    s_and_b32 s54, s2, 1
    s_lshl2_add_u32 s54, s54, s57
    v_lshlrev_b32 v2, 4, v6
    v_lshl_add_u32 v24, v5, 10, v2
    s_lshl2_add_u32 s60, s53, s52
    s_lshl_b32 s60, s60, 14
    v_add_u32 v24, s60, v24
    v_add_u32 v25, 0x2000, v24
    s_movk_i32 s62, 0x380
    s_lshl2_add_u32 s61, s96, s55
    s_lshl_b32 s61, s61, 7
    s_or_b32 s57, s57, s96
    s_cbranch_scc1 L_x
    v_mul_u32_u24 v7, 24576, v5
    v_add_u32 v7, v7, v2
    v_lshlrev_b32 v8, 3, v5
    s_and_b32 s57, s2, 3
    s_lshl2_add_u32 s57, s57, s52
    s_lshl_b32 s58, s57, 6
    s_mul_i32 s57, s57, 196608
    s_lshr_b32 s59, s2, 2
    s_lshl_b32 s59, s59, 7
    s_add_u32 s57, s57, s59
    s_waitcnt lgkmcnt(0)
    buffer_load_dwordx2 v[208:209], v8, s[32:35], s58 offen
    buffer_load_dwordx4 v[192:195], v7, s[36:39], s57 offen nt
    s_addk_i32 s57, 6144
    buffer_load_dwordx4 v[196:199], v7, s[36:39], s57 offen nt
    s_addk_i32 s57, 6144
    buffer_load_dwordx4 v[200:203], v7, s[36:39], s57 offen nt
    s_addk_i32 s57, 6144
    buffer_load_dwordx4 v[204:207], v7, s[36:39], s57 offen nt
    s_branch L_x2
L_x:
    s_waitcnt lgkmcnt(0)
    s_sleep 4
L_x2:
    s_and_b32 s72, s61, s62
    buffer_load_dwordx4 v[96:99], v24, s[4:7], s72 offen
    buffer_load_dwordx4 v[100:103], v25, s[4:7], s72 offen
    s_addk_i32 s61, 128
    s_and_b32 s73, s61, s62
    s_addk_i32 s61, 128
    s_and_b32 s74, s61, s62
    s_addk_i32 s61, 128
    s_and_b32 s75, s61, s62
    s_load_dword s97, s[44:45], 0
    s_barrier
L_open_end:
    s_cmp_lg_u32 s96, 0
    s_cbranch_scc1 L_helper
    s_mov_b32 s46, 23068672
    s_mov_b32 s47, 0x20000
    s_cmp_ge_u32 s2, 64
    s_cbranch_scc1 L_nomod
    s_setprio 3
    v_lshrrev_b32 v210, 4, v4
    v_lshlrev_b32 v210, 3, v210
    v_lshl_add_u32 v210, v6, 5, v210
    s_lshl_b32 s57, s52, 8
    s_add_u32 s57, s57, 33792
    v_add_u32 v210, s57, v210
    v_lshlrev_b32 v211, 2, v4
    v_add_u32 v212, 33792, v211
    v_and_b32 v213, 3, v4
    v_lshlrev_b32 v213, 3, v213
    v_mov_b32 v214, 0xff
    v_mov_b32 v215, 32768
    s_lshr_b32 s57, s2, 6
    s_lshl_b32 s57, s57, 14
    s_and_b32 s58, s2, 31
    s_lshl_b32 s58, s58, 9
    s_add_u32 s57, s57, s58
    s_and_b32 s58, s2, 32
    s_lshl3_add_u32 s57, s58, s57
    s_add_u32 s57, s57, 4096
    s_waitcnt vmcnt(6)
    v_lshlrev_b32 v216, 16, v208
    v_and_b32 v217, 0xffff0000, v208
    v_lshlrev_b32 v218, 16, v209
    v_and_b32 v219, 0xffff0000, v209
    v_mul_f32 v220, 0xbfb8aa3b, v216
    v_mul_f32 v221, 0xbfb8aa3b, v217
    v_mul_f32 v222, 0xbfb8aa3b, v218
    v_mul_f32 v223, 0xbfb8aa3b, v219
    v_exp_f32 v220, v220
    v_exp_f32 v221, v221
    v_exp_f32 v222, v222
    v_exp_f32 v223, v223
    v_add_f32 v220, 1.0, v220
    v_add_f32 v221, 1.0, v221
    v_add_f32 v222, 1.0, v222
    v_add_f32 v223, 1.0, v223
    v_rcp_f32 v220, v220
    v_rcp_f32 v221, v221
    v_rcp_f32 v222, v222
    v_rcp_f32 v223, v223
    v_mul_f32 v216, v216, v220
    v_mul_f32 v217, v217, v221
    v_mul_f32 v218, v218, v222
    v_mul_f32 v219, v219, v223
    v_cvt_pk_bf16_f32 v224, v216, 0
    v_cvt_pk_bf16_f32 v225, 0, v216
    v_cvt_pk_bf16_f32 v226, v217, 0
    v_cvt_pk_bf16_f32 v227, 0, v217
    v_cvt_pk_bf16_f32 v228, v218, 0
    v_cvt_pk_bf16_f32 v229, 0, v218
    v_cvt_pk_bf16_f32 v230, v219, 0
    v_cvt_pk_bf16_f32 v231, 0, v219
    s_waitcnt vmcnt(5)
    v_dot2_f32_bf16 v232, v192, v224, 0
    v_dot2_f32_bf16 v233, v192, v225, 0
    v_dot2_f32_bf16 v234, v193, v224, 0
    v_dot2_f32_bf16 v235, v193, v225, 0
    v_dot2_f32_bf16 v236, v194, v224, 0
    v_dot2_f32_bf16 v237, v194, v225, 0
    v_dot2_f32_bf16 v238, v195, v224, 0
    v_dot2_f32_bf16 v239, v195, v225, 0
    s_waitcnt vmcnt(4)
    v_dot2_f32_bf16 v232, v196, v226, v232
    v_dot2_f32_bf16 v233, v196, v227, v233
    v_dot2_f32_bf16 v234, v197, v226, v234
    v_dot2_f32_bf16 v235, v197, v227, v235
    v_dot2_f32_bf16 v236, v198, v226, v236
    v_dot2_f32_bf16 v237, v198, v227, v237
    v_dot2_f32_bf16 v238, v199, v226, v238
    v_dot2_f32_bf16 v239, v199, v227, v239
    s_waitcnt vmcnt(3)
    v_dot2_f32_bf16 v232, v200, v228, v232
    v_dot2_f32_bf16 v233, v200, v229, v233
    v_dot2_f32_bf16 v234, v201, v228, v234
    v_dot2_f32_bf16 v235, v201, v229, v235
    v_dot2_f32_bf16 v236, v202, v228, v236
    v_dot2_f32_bf16 v237, v202, v229, v237
    v_dot2_f32_bf16 v238, v203, v228, v238
    v_dot2_f32_bf16 v239, v203, v229, v239
    s_waitcnt vmcnt(2)
    v_dot2_f32_bf16 v232, v204, v230, v232
    v_dot2_f32_bf16 v233, v204, v231, v233
    v_dot2_f32_bf16 v234, v205, v230, v234
    v_dot2_f32_bf16 v235, v205, v231, v235
    v_dot2_f32_bf16 v236, v206, v230, v236
    v_dot2_f32_bf16 v237, v206, v231, v237
    v_dot2_f32_bf16 v238, v207, v230, v238
    v_dot2_f32_bf16 v239, v207, v231, v239
    v_mov_b32 v216, 1
    s_waitcnt lgkmcnt(0)
    s_mul_i32 s56, s97, 1664525
    s_add_u32 s56, s56, 1013904223
    v_lshrrev_b32 v213, v213, s56
    v_permlane32_swap_b32 v232, v236
    v_permlane32_swap_b32 v233, v237
    v_permlane32_swap_b32 v234, v238
    v_permlane32_swap_b32 v235, v239
    v_add_f32 v232, v232, v236
    v_add_f32 v233, v233, v237
    v_add_f32 v234, v234, v238
    v_add_f32 v235, v235, v239
    s_nop 0
    v_permlane16_swap_b32 v232, v234
    v_permlane16_swap_b32 v233, v235
    v_add_f32 v232, v232, v234
    v_add_f32 v233, v233, v235
    s_nop 0
    v_add_f32_dpp v232, v232, v232 row_ror:8 row_mask:0xf bank_mask:0xf
    v_add_f32_dpp v233, v233, v233 row_ror:8 row_mask:0xf bank_mask:0xf
    ds_write_b64 v210, v[232:233]
    s_mov_b64 exec, 1
    ds_add_rtn_u32 v216, v215, v216
    s_mov_b64 exec, -1
    ds_read2st64_b32 v[232:233], v212 offset0:0 offset1:1
    ds_read2st64_b32 v[234:235], v212 offset0:2 offset1:3
    s_waitcnt lgkmcnt(2)
    v_readfirstlane_b32 s58, v216
    s_waitcnt lgkmcnt(1)
    v_add_f32 v232, v232, v233
    s_waitcnt lgkmcnt(0)
    v_add_f32 v234, v234, v235
    s_cmp_lg_u32 s58, 3
    s_cselect_b32 s58, 1073741824, 0
    v_add_f32 v232, v232, v234
    v_or_b32 v211, s58, v211
    v_bfi_b32 v232, v214, v213, v232
    buffer_store_dword v232, v211, s[44:47], s57 offen sc1
    s_branch L_moddone
L_nomod:
    v_mov_b32 v63, 1073741824
    buffer_store_dword v63, v63, s[44:47], 0 offen
L_moddone:
    s_setprio 0
    buffer_load_dwordx4 v[104:107], v24, s[4:7], s73 offen
    buffer_load_dwordx4 v[108:111], v25, s[4:7], s73 offen
    s_load_dwordx2 s[20:21], s[0:1], 40
    s_load_dwordx2 s[24:25], s[0:1], 48
    s_load_dwordx2 s[28:29], s[0:1], 56
    s_mov_b32 s22, 1835008
    s_mov_b32 s23, s7
    s_mov_b32 s26, 1835008
    s_mov_b32 s27, s7
    s_mov_b32 s30, 1835008
    s_mov_b32 s31, s7
    s_mov_b32 s63, 0
    v_mov_b32 v29, 0x3f803f80
    s_lshl_b32 s57, s96, 11
    s_add_u32 s57, s57, 155648
    v_lshl_add_u32 v28, v6, 5, s57
    s_lshl1_add_u32 s57, s52, s96
    s_lshl_b32 s57, s57, 7
    s_add_u32 s57, s57, 159744
    v_lshl_add_u32 v30, v5, 4, s57
    v_xor_b32 v31, 128, v30
    v_lshrrev_b32 v2, 5, v4
    s_lshl1_add_u32 s58, s52, s55
    v_add_u32 v2, s58, v2
    v_and_b32 v2, 7, v2
    v_lshlrev_b32 v2, 11, v2
    v_and_b32 v38, 31, v4
    v_lshl_add_u32 v38, v38, 4, v2
    s_mov_b32 s60, 4096
    v_bfe_u32 v2, v4, 4, 1
    v_cvt_f32_u32 v37, v2
    s_lshl_b32 s57, s52, 10
    s_add_u32 s57, s57, 155648
    v_lshl_add_u32 v36, v4, 4, s57
    buffer_load_dwordx4 v[112:115], v24, s[4:7], s74 offen
    buffer_load_dwordx4 v[116:119], v25, s[4:7], s74 offen
    buffer_load_dwordx4 v[120:123], v24, s[4:7], s75 offen
    buffer_load_dwordx4 v[124:127], v25, s[4:7], s75 offen
    s_waitcnt lgkmcnt(0)
    s_mul_i32 s56, s97, 1664525
    s_add_u32 s56, s56, 1013904223
    s_and_b32 s0, s56, 0xff
    s_bfe_u32 s98, s56, 0x80008
    s_bfe_u32 s99, s56, 0x80010
    s_lshr_b32 s3, s56, 24
    s_waitcnt vmcnt(8)
    v_dot2_f32_bf16 v16, v96, v29, 0
    v_lshlrev_b32 v128, 16, v96
    v_dot2_f32_bf16 v17, v96, v96, 0
    v_and_b32 v129, 0xffff0000, v96
    v_dot2_f32_bf16 v16, v97, v29, v16
    v_lshlrev_b32 v130, 16, v97
    v_dot2_f32_bf16 v17, v97, v97, v17
    v_and_b32 v131, 0xffff0000, v97
    v_dot2_f32_bf16 v16, v98, v29, v16
    v_lshlrev_b32 v132, 16, v98
    v_dot2_f32_bf16 v17, v98, v98, v17
    v_and_b32 v133, 0xffff0000, v98
    v_dot2_f32_bf16 v16, v99, v29, v16
    v_lshlrev_b32 v134, 16, v99
    v_dot2_f32_bf16 v17, v99, v99, v17
    v_and_b32 v135, 0xffff0000, v99
    s_waitcnt vmcnt(7)
    v_dot2_f32_bf16 v18, v100, v29, 0
    v_lshlrev_b32 v136, 16, v100
    v_dot2_f32_bf16 v19, v100, v100, 0
    v_and_b32 v137, 0xffff0000, v100
    v_dot2_f32_bf16 v18, v101, v29, v18
    v_lshlrev_b32 v138, 16, v101
    v_dot2_f32_bf16 v19, v101, v101, v19
    v_and_b32 v139, 0xffff0000, v101
    v_dot2_f32_bf16 v18, v102, v29, v18
    v_lshlrev_b32 v140, 16, v102
    v_dot2_f32_bf16 v19, v102, v102, v19
    v_and_b32 v141, 0xffff0000, v102
    v_dot2_f32_bf16 v18, v103, v29, v18
    v_lshlrev_b32 v142, 16, v103
    v_dot2_f32_bf16 v19, v103, v103, v19
    v_and_b32 v143, 0xffff0000, v103
    s_barrier
    s_waitcnt vmcnt(5)
    v_dot2_f32_bf16 v16, v104, v29, v16
    v_lshlrev_b32 v144, 16, v104
    v_dot2_f32_bf16 v17, v104, v104, v17
    v_and_b32 v145, 0xffff0000, v104
    v_dot2_f32_bf16 v16, v105, v29, v16
    v_lshlrev_b32 v146, 16, v105
    v_dot2_f32_bf16 v17, v105, v105, v17
    v_and_b32 v147, 0xffff0000, v105
    v_dot2_f32_bf16 v16, v106, v29, v16
    v_lshlrev_b32 v148, 16, v106
    v_dot2_f32_bf16 v17, v106, v106, v17
    v_and_b32 v149, 0xffff0000, v106
    v_dot2_f32_bf16 v16, v107, v29, v16
    v_lshlrev_b32 v150, 16, v107
    v_dot2_f32_bf16 v17, v107, v107, v17
    v_and_b32 v151, 0xffff0000, v107
    s_waitcnt vmcnt(4)
    v_dot2_f32_bf16 v18, v108, v29, v18
    v_lshlrev_b32 v152, 16, v108
    v_dot2_f32_bf16 v19, v108, v108, v19
    v_and_b32 v153, 0xffff0000, v108
    v_dot2_f32_bf16 v18, v109, v29, v18
    v_lshlrev_b32 v154, 16, v109
    v_dot2_f32_bf16 v19, v109, v109, v19
    v_and_b32 v155, 0xffff0000, v109
    v_dot2_f32_bf16 v18, v110, v29, v18
    v_lshlrev_b32 v156, 16, v110
    v_dot2_f32_bf16 v19, v110, v110, v19
    v_and_b32 v157, 0xffff0000, v110
    v_dot2_f32_bf16 v18, v111, v29, v18
    v_lshlrev_b32 v158, 16, v111
    v_dot2_f32_bf16 v19, v111, v111, v19
    v_and_b32 v159, 0xffff0000, v111
    s_waitcnt vmcnt(3)
    v_dot2_f32_bf16 v16, v112, v29, v16
    v_lshlrev_b32 v160, 16, v112
    v_dot2_f32_bf16 v17, v112, v112, v17
    v_and_b32 v161, 0xffff0000, v112
    v_dot2_f32_bf16 v16, v113, v29, v16
    v_lshlrev_b32 v162, 16, v113
    v_dot2_f32_bf16 v17, v113, v113, v17
    v_and_b32 v163, 0xffff0000, v113
    v_dot2_f32_bf16 v16, v114, v29, v16
    v_lshlrev_b32 v164, 16, v114
    v_dot2_f32_bf16 v17, v114, v114, v17
    v_and_b32 v165, 0xffff0000, v114
    v_dot2_f32_bf16 v16, v115, v29, v16
    v_lshlrev_b32 v166, 16, v115
    v_dot2_f32_bf16 v17, v115, v115, v17
    v_and_b32 v167, 0xffff0000, v115
    s_waitcnt vmcnt(2)
    v_dot2_f32_bf16 v18, v116, v29, v18
    v_lshlrev_b32 v168, 16, v116
    v_dot2_f32_bf16 v19, v116, v116, v19
    v_and_b32 v169, 0xffff0000, v116
    v_dot2_f32_bf16 v18, v117, v29, v18
    v_lshlrev_b32 v170, 16, v117
    v_dot2_f32_bf16 v19, v117, v117, v19
    v_and_b32 v171, 0xffff0000, v117
    v_dot2_f32_bf16 v18, v118, v29, v18
    v_lshlrev_b32 v172, 16, v118
    v_dot2_f32_bf16 v19, v118, v118, v19
    v_and_b32 v173, 0xffff0000, v118
    v_dot2_f32_bf16 v18, v119, v29, v18
    v_lshlrev_b32 v174, 16, v119
    v_dot2_f32_bf16 v19, v119, v119, v19
    v_and_b32 v175, 0xffff0000, v119
    s_waitcnt vmcnt(1)
    v_dot2_f32_bf16 v16, v120, v29, v16
    v_lshlrev_b32 v176, 16, v120
    v_dot2_f32_bf16 v17, v120, v120, v17
    v_and_b32 v177, 0xffff0000, v120
    v_dot2_f32_bf16 v16, v121, v29, v16
    v_lshlrev_b32 v178, 16, v121
    v_dot2_f32_bf16 v17, v121, v121, v17
    v_and_b32 v179, 0xffff0000, v121
    v_dot2_f32_bf16 v16, v122, v29, v16
    v_lshlrev_b32 v180, 16, v122
    v_dot2_f32_bf16 v17, v122, v122, v17
    v_and_b32 v181, 0xffff0000, v122
    v_dot2_f32_bf16 v16, v123, v29, v16
    v_lshlrev_b32 v182, 16, v123
    v_dot2_f32_bf16 v17, v123, v123, v17
    v_and_b32 v183, 0xffff0000, v123
    s_waitcnt vmcnt(0)
    v_dot2_f32_bf16 v18, v124, v29, v18
    v_lshlrev_b32 v184, 16, v124
    v_dot2_f32_bf16 v19, v124, v124, v19
    v_and_b32 v185, 0xffff0000, v124
    v_dot2_f32_bf16 v18, v125, v29, v18
    v_lshlrev_b32 v186, 16, v125
    v_dot2_f32_bf16 v19, v125, v125, v19
    v_and_b32 v187, 0xffff0000, v125
    v_dot2_f32_bf16 v18, v126, v29, v18
    v_lshlrev_b32 v188, 16, v126
    v_dot2_f32_bf16 v19, v126, v126, v19
    v_and_b32 v189, 0xffff0000, v126
    v_dot2_f32_bf16 v18, v127, v29, v18
    v_lshlrev_b32 v190, 16, v127
    v_dot2_f32_bf16 v19, v127, v127, v19
    v_and_b32 v191, 0xffff0000, v127
    v_add_f32_dpp v16, v16, v16 quad_perm:[1,0,3,2] row_mask:0xf bank_mask:0xf
    v_add_f32_dpp v17, v17, v17 quad_perm:[1,0,3,2] row_mask:0xf bank_mask:0xf
    v_add_f32_dpp v18, v18, v18 quad_perm:[1,0,3,2] row_mask:0xf bank_mask:0xf
    v_add_f32_dpp v19, v19, v19 quad_perm:[1,0,3,2] row_mask:0xf bank_mask:0xf
    v_add_f32_dpp v16, v16, v16 quad_perm:[2,3,0,1] row_mask:0xf bank_mask:0xf
    v_add_f32_dpp v17, v17, v17 quad_perm:[2,3,0,1] row_mask:0xf bank_mask:0xf
    v_add_f32_dpp v18, v18, v18 quad_perm:[2,3,0,1] row_mask:0xf bank_mask:0xf
    v_add_f32_dpp v19, v19, v19 quad_perm:[2,3,0,1] row_mask:0xf bank_mask:0xf
    v_add_f32_dpp v16, v16, v16 row_half_mirror row_mask:0xf bank_mask:0xf
    v_add_f32_dpp v17, v17, v17 row_half_mirror row_mask:0xf bank_mask:0xf
    v_add_f32_dpp v18, v18, v18 row_half_mirror row_mask:0xf bank_mask:0xf
    v_add_f32_dpp v19, v19, v19 row_half_mirror row_mask:0xf bank_mask:0xf
    ds_write_b128 v30, v[16:19]
    s_waitcnt lgkmcnt(0)
    s_barrier
    ds_read_b128 v[20:23], v31
    s_waitcnt lgkmcnt(0)
    v_add_f32 v16, v16, v20
    v_add_f32 v17, v17, v21
    v_add_f32 v18, v18, v22
    v_add_f32 v19, v19, v23
    v_mul_f32 v16, 0xbb000000, v16
    v_mul_f32 v18, 0xbb000000, v18
    v_mul_f32 v17, 0x3b000000, v17
    v_mul_f32 v19, 0x3b000000, v19
    v_fma_f32 v17, -v16, v16, v17
    v_fma_f32 v19, -v18, v18, v19
    v_max_f32 v17, 0, v17
    v_max_f32 v19, 0, v19
    v_add_f32 v17, 0x3727c5ac, v17
    v_add_f32 v19, 0x3727c5ac, v19
    v_rsq_f32 v20, v17
    v_rsq_f32 v22, v19
    v_mul_f32 v21, v16, v20
    v_mul_f32 v23, v18, v22
    v_pk_fma_f32 v[128:129], v[128:129], v[20:21], v[20:21] op_sel:[0,0,1] op_sel_hi:[1,0,1]
    v_pk_fma_f32 v[130:131], v[130:131], v[20:21], v[20:21] op_sel:[0,0,1] op_sel_hi:[1,0,1]
    v_pk_fma_f32 v[132:133], v[132:133], v[20:21], v[20:21] op_sel:[0,0,1] op_sel_hi:[1,0,1]
    v_pk_fma_f32 v[134:135], v[134:135], v[20:21], v[20:21] op_sel:[0,0,1] op_sel_hi:[1,0,1]
    v_pk_fma_f32 v[136:137], v[136:137], v[22:23], v[22:23] op_sel:[0,0,1] op_sel_hi:[1,0,1]
    v_pk_fma_f32 v[138:139], v[138:139], v[22:23], v[22:23] op_sel:[0,0,1] op_sel_hi:[1,0,1]
    v_pk_fma_f32 v[140:141], v[140:141], v[22:23], v[22:23] op_sel:[0,0,1] op_sel_hi:[1,0,1]
    v_pk_fma_f32 v[142:143], v[142:143], v[22:23], v[22:23] op_sel:[0,0,1] op_sel_hi:[1,0,1]
    v_pk_fma_f32 v[144:145], v[144:145], v[20:21], v[20:21] op_sel:[0,0,1] op_sel_hi:[1,0,1]
    v_pk_fma_f32 v[146:147], v[146:147], v[20:21], v[20:21] op_sel:[0,0,1] op_sel_hi:[1,0,1]
    v_pk_fma_f32 v[148:149], v[148:149], v[20:21], v[20:21] op_sel:[0,0,1] op_sel_hi:[1,0,1]
    v_pk_fma_f32 v[150:151], v[150:151], v[20:21], v[20:21] op_sel:[0,0,1] op_sel_hi:[1,0,1]
    v_pk_fma_f32 v[152:153], v[152:153], v[22:23], v[22:23] op_sel:[0,0,1] op_sel_hi:[1,0,1]
    v_pk_fma_f32 v[154:155], v[154:155], v[22:23], v[22:23] op_sel:[0,0,1] op_sel_hi:[1,0,1]
    v_pk_fma_f32 v[156:157], v[156:157], v[22:23], v[22:23] op_sel:[0,0,1] op_sel_hi:[1,0,1]
    v_pk_fma_f32 v[158:159], v[158:159], v[22:23], v[22:23] op_sel:[0,0,1] op_sel_hi:[1,0,1]
    v_pk_fma_f32 v[160:161], v[160:161], v[20:21], v[20:21] op_sel:[0,0,1] op_sel_hi:[1,0,1]
    v_pk_fma_f32 v[162:163], v[162:163], v[20:21], v[20:21] op_sel:[0,0,1] op_sel_hi:[1,0,1]
    v_pk_fma_f32 v[164:165], v[164:165], v[20:21], v[20:21] op_sel:[0,0,1] op_sel_hi:[1,0,1]
    v_pk_fma_f32 v[166:167], v[166:167], v[20:21], v[20:21] op_sel:[0,0,1] op_sel_hi:[1,0,1]
    v_pk_fma_f32 v[168:169], v[168:169], v[22:23], v[22:23] op_sel:[0,0,1] op_sel_hi:[1,0,1]
    v_pk_fma_f32 v[170:171], v[170:171], v[22:23], v[22:23] op_sel:[0,0,1] op_sel_hi:[1,0,1]
    v_pk_fma_f32 v[172:173], v[172:173], v[22:23], v[22:23] op_sel:[0,0,1] op_sel_hi:[1,0,1]
    v_pk_fma_f32 v[174:175], v[174:175], v[22:23], v[22:23] op_sel:[0,0,1] op_sel_hi:[1,0,1]
    v_pk_fma_f32 v[176:177], v[176:177], v[20:21], v[20:21] op_sel:[0,0,1] op_sel_hi:[1,0,1]
    v_pk_fma_f32 v[178:179], v[178:179], v[20:21], v[20:21] op_sel:[0,0,1] op_sel_hi:[1,0,1]
    v_pk_fma_f32 v[180:181], v[180:181], v[20:21], v[20:21] op_sel:[0,0,1] op_sel_hi:[1,0,1]
    v_pk_fma_f32 v[182:183], v[182:183], v[20:21], v[20:21] op_sel:[0,0,1] op_sel_hi:[1,0,1]
    v_pk_fma_f32 v[184:185], v[184:185], v[22:23], v[22:23] op_sel:[0,0,1] op_sel_hi:[1,0,1]
    v_pk_fma_f32 v[186:187], v[186:187], v[22:23], v[22:23] op_sel:[0,0,1] op_sel_hi:[1,0,1]
    v_pk_fma_f32 v[188:189], v[188:189], v[22:23], v[22:23] op_sel:[0,0,1] op_sel_hi:[1,0,1]
    v_pk_fma_f32 v[190:191], v[190:191], v[22:23], v[22:23] op_sel:[0,0,1] op_sel_hi:[1,0,1]
    buffer_load_dwordx4 v[40:43], v38, s[44:47], s60 offen offset:0 sc1
    buffer_load_dwordx4 v[44:47], v38, s[44:47], s60 offen offset:512 sc1
    buffer_load_dwordx4 v[48:51], v38, s[44:47], s60 offen offset:1024 sc1
    buffer_load_dwordx4 v[52:55], v38, s[44:47], s60 offen offset:1536 sc1
    s_barrier
    v_bfe_u32 v1, v4, 4, 1
    v_bfe_u32 v3, v4, 3, 1
    v_lshrrev_b32 v14, 5, v4
    v_bfe_u32 v2, v4, 2, 1
    v_lshl_add_u32 v8, v1, 2, v3
    v_lshl_add_u32 v8, v8, 2, v14
    v_lshl_add_u32 v8, v8, 1, v2
    v_lshlrev_b32 v12, 7, v8
    v_lshl_add_u32 v8, v1, 1, v3
    v_xor_b32 v8, s52, v8
    v_lshl_add_u32 v12, v8, 5, v12
    v_and_b32 v8, 3, v4
    v_lshl_add_u32 v12, v8, 3, v12
    v_add_u32 v13, 98304, v12
    v_lshl_add_u32 v8, v3, 2, v14
    v_lshl_add_u32 v8, v8, 3, v6
    v_lshl_add_u32 v8, v8, 1, v1
    v_lshlrev_b32 v8, 4, v8
    v_add_u32 v7, 32768, v8
    v_lshrrev_b32 v2, 2, v4
    v_xor_b32 v2, v2, v4
    v_and_b32 v2, 4, v2
    v_cmp_eq_u32 vcc, 0, v2
    v_mov_b32 v2, 0x3f803f80
    v_lshlrev_b32 v1, 4, v4
    v_cndmask_b32 v3, 0, v2, vcc
    v_lshlrev_b32 v14, 2, v4
    s_lshl_b32 s57, s53, 5
    s_lshl2_add_u32 s57, s54, s57
    s_add_u32 s57, s57, s52
    s_mul_i32 s80, s57, 4608
    s_add_u32 s80, s80, 6291456
    s_sub_u32 s58, s80, 589824
    s_add_u32 s4, s44, s58
    s_addc_u32 s5, s45, 0
    s_cmp_ge_u32 s53, 4
    s_cselect_b32 s6, 4608, 0
    s_mov_b32 s7, 0x20000
    s_sub_u32 s58, s80, 442368
    s_add_u32 s40, s44, s58
    s_addc_u32 s41, s45, 0
    s_cmp_ge_u32 s53, 3
    s_cselect_b32 s42, 4608, 0
    s_mov_b32 s43, 0x20000
    s_sub_u32 s58, s80, 294912
    s_add_u32 s72, s44, s58
    s_addc_u32 s73, s45, 0
    s_cmp_ge_u32 s53, 2
    s_cselect_b32 s74, 4608, 0
    s_mov_b32 s75, 0x20000
    s_sub_u32 s58, s80, 147456
    s_add_u32 s76, s44, s58
    s_addc_u32 s77, s45, 0
    s_cmp_ge_u32 s53, 1
    s_cselect_b32 s78, 4608, 0
    s_mov_b32 s79, 0x20000
    s_lshl_b32 s58, s53, 5
    s_add_u32 s57, s57, s58
    s_lshl_b32 s81, s57, 10
    s_add_u32 s81, s81, 4194304
    s_and_b32 s101, s57, -4
    s_lshl_b32 s101, s101, 8
    s_lshl2_add_u32 s101, s52, s101
    s_add_u32 s101, s101, 2097152
    s_lshl_b32 s19, s57, 8
    s_add_u32 s19, s19, 2097152
    s_lshl_b32 s18, s57, 8
    s_add_u32 s18, s18, 3145728
    s_and_b32 s36, s2, 1
    s_lshl_b32 s36, s36, 13
    s_add_u32 s36, s36, s101
    s_add_u32 s36, s36, 1048576
    s_lshl3_add_u32 s34, s53, s54
    s_lshl_b32 s34, s34, 8
    s_add_u32 s34, s34, 3670016
    v_min_u32 v9, 1, v0
    v_lshlrev_b32 v9, 30, v9
    v_mov_b32 v8, s56
    v_and_b32 v2, 31, v4
    v_lshrrev_b32 v11, 5, v4
    v_lshlrev_b32 v11, 2, v11
    v_sub_u32 v2, v2, v11
    v_cmp_le_i32 s[64:65], 0, v2
    v_cmp_le_i32 s[66:67], 1, v2
    v_cmp_le_i32 s[68:69], 2, v2
    v_cmp_le_i32 s[70:71], 3, v2
    v_cmp_le_i32 s[82:83], 8, v2
    v_cmp_le_i32 s[84:85], 9, v2
    v_cmp_le_i32 s[86:87], 10, v2
    v_cmp_le_i32 s[88:89], 11, v2
    v_cmp_le_i32 s[90:91], 16, v2
    v_cmp_le_i32 s[92:93], 17, v2
    v_cmp_le_i32 s[94:95], 18, v2
    v_cmp_le_i32 s[8:9], 19, v2
    v_cmp_le_i32 s[10:11], 24, v2
    v_cmp_le_i32 s[12:13], 25, v2
    v_cmp_le_i32 s[14:15], 26, v2
    v_cmp_le_i32 s[16:17], 27, v2
    s_waitcnt vmcnt(0)
L_mod_c:
    v_xor_b32 v40, s0, v40
    v_xor_b32 v41, s98, v41
    v_or_b32 v2, v40, v41
    v_xor_b32 v42, s99, v42
    v_xor_b32 v43, s3, v43
    v_or3_b32 v2, v42, v43, v2
    v_xor_b32 v44, s0, v44
    v_xor_b32 v45, s98, v45
    v_or3_b32 v2, v44, v45, v2
    v_xor_b32 v46, s99, v46
    v_xor_b32 v47, s3, v47
    v_or3_b32 v2, v46, v47, v2
    v_xor_b32 v48, s0, v48
    v_xor_b32 v49, s98, v49
    v_or3_b32 v2, v48, v49, v2
    v_xor_b32 v50, s99, v50
    v_xor_b32 v51, s3, v51
    v_or3_b32 v2, v50, v51, v2
    v_xor_b32 v52, s0, v52
    v_xor_b32 v53, s98, v53
    v_or3_b32 v2, v52, v53, v2
    v_xor_b32 v54, s99, v54
    v_xor_b32 v55, s3, v55
    v_or3_b32 v2, v54, v55, v2
    v_and_b32 v2, 0xff, v2
    v_cmp_ne_u32 vcc, 0, v2
    s_nop 0
    s_cmp_lg_u64 vcc, 0
    s_cbranch_scc1 L_mod_p
L_mod_o:
    v_pk_add_f32 v[40:41], v[40:41], v[44:45]
    v_pk_add_f32 v[48:49], v[48:49], v[52:53]
    v_pk_add_f32 v[42:43], v[42:43], v[46:47]
    v_pk_add_f32 v[50:51], v[50:51], v[54:55]
    v_pk_add_f32 v[40:41], v[40:41], v[48:49]
    v_pk_add_f32 v[42:43], v[42:43], v[50:51]
    v_cvt_pk_bf16_f32 v44, v40, v41
    v_cvt_pk_bf16_f32 v45, v42, v43
    v_lshlrev_b32 v40, 16, v44
    v_and_b32 v41, 0xffff0000, v44
    v_lshlrev_b32 v42, 16, v45
    v_and_b32 v43, 0xffff0000, v45
    v_add_f32 v40, v40, v37
    v_add_f32 v41, v41, v37
    v_add_f32 v42, v42, v37
    v_add_f32 v43, v43, v37
    v_cvt_pk_bf16_f32 v44, v40, v41
    v_cvt_pk_bf16_f32 v45, v42, v43
    v_lshlrev_b32 v40, 16, v44
    v_and_b32 v41, 0xffff0000, v44
    v_lshlrev_b32 v42, 16, v45
    v_and_b32 v43, 0xffff0000, v45
    ds_write_b128 v36, v[40:43]
    s_waitcnt lgkmcnt(0)
    s_barrier
    ds_read_b128 v[64:67], v28 offset:0
    ds_read_b128 v[68:71], v28 offset:16
    ds_read_b128 v[72:75], v28 offset:256
    ds_read_b128 v[76:79], v28 offset:272
    ds_read_b128 v[80:83], v28 offset:512
    ds_read_b128 v[84:87], v28 offset:528
    ds_read_b128 v[88:91], v28 offset:768
    ds_read_b128 v[92:95], v28 offset:784
    ds_read_b128 v[96:99], v28 offset:1024
    ds_read_b128 v[100:103], v28 offset:1040
    ds_read_b128 v[104:107], v28 offset:1280
    ds_read_b128 v[108:111], v28 offset:1296
    ds_read_b128 v[112:115], v28 offset:1536
    ds_read_b128 v[116:119], v28 offset:1552
    ds_read_b128 v[120:123], v28 offset:1792
    ds_read_b128 v[124:127], v28 offset:1808
    s_waitcnt lgkmcnt(13)
    v_pk_fma_f32 v[128:129], v[128:129], v[72:73], v[64:65]
    v_pk_fma_f32 v[130:131], v[130:131], v[74:75], v[66:67]
    s_waitcnt lgkmcnt(12)
    v_pk_fma_f32 v[132:133], v[132:133], v[76:77], v[68:69]
    v_pk_fma_f32 v[134:135], v[134:135], v[78:79], v[70:71]
    v_cvt_pk_bf16_f32 v128, v128, v129
    v_cvt_pk_bf16_f32 v129, v130, v131
    v_cvt_pk_bf16_f32 v130, v132, v133
    v_cvt_pk_bf16_f32 v131, v134, v135
    v_pk_fma_f32 v[136:137], v[136:137], v[72:73], v[64:65]
    v_pk_fma_f32 v[138:139], v[138:139], v[74:75], v[66:67]
    v_pk_fma_f32 v[140:141], v[140:141], v[76:77], v[68:69]
    v_pk_fma_f32 v[142:143], v[142:143], v[78:79], v[70:71]
    v_cvt_pk_bf16_f32 v136, v136, v137
    v_cvt_pk_bf16_f32 v137, v138, v139
    v_cvt_pk_bf16_f32 v138, v140, v141
    v_cvt_pk_bf16_f32 v139, v142, v143
    s_waitcnt lgkmcnt(9)
    v_pk_fma_f32 v[144:145], v[144:145], v[88:89], v[80:81]
    v_pk_fma_f32 v[146:147], v[146:147], v[90:91], v[82:83]
    s_waitcnt lgkmcnt(8)
    v_pk_fma_f32 v[148:149], v[148:149], v[92:93], v[84:85]
    v_pk_fma_f32 v[150:151], v[150:151], v[94:95], v[86:87]
    v_cvt_pk_bf16_f32 v144, v144, v145
    v_cvt_pk_bf16_f32 v145, v146, v147
    v_cvt_pk_bf16_f32 v146, v148, v149
    v_cvt_pk_bf16_f32 v147, v150, v151
    v_pk_fma_f32 v[152:153], v[152:153], v[88:89], v[80:81]
    v_pk_fma_f32 v[154:155], v[154:155], v[90:91], v[82:83]
    v_pk_fma_f32 v[156:157], v[156:157], v[92:93], v[84:85]
    v_pk_fma_f32 v[158:159], v[158:159], v[94:95], v[86:87]
    v_cvt_pk_bf16_f32 v152, v152, v153
    v_cvt_pk_bf16_f32 v153, v154, v155
    v_cvt_pk_bf16_f32 v154, v156, v157
    v_cvt_pk_bf16_f32 v155, v158, v159
    s_waitcnt lgkmcnt(5)
    v_pk_fma_f32 v[160:161], v[160:161], v[104:105], v[96:97]
    v_pk_fma_f32 v[162:163], v[162:163], v[106:107], v[98:99]
    s_waitcnt lgkmcnt(4)
    v_pk_fma_f32 v[164:165], v[164:165], v[108:109], v[100:101]
    v_pk_fma_f32 v[166:167], v[166:167], v[110:111], v[102:103]
    v_cvt_pk_bf16_f32 v160, v160, v161
    v_cvt_pk_bf16_f32 v161, v162, v163
    v_cvt_pk_bf16_f32 v162, v164, v165
    v_cvt_pk_bf16_f32 v163, v166, v167
    v_pk_fma_f32 v[168:169], v[168:169], v[104:105], v[96:97]
    v_pk_fma_f32 v[170:171], v[170:171], v[106:107], v[98:99]
    v_pk_fma_f32 v[172:173], v[172:173], v[108:109], v[100:101]
    v_pk_fma_f32 v[174:175], v[174:175], v[110:111], v[102:103]
    v_cvt_pk_bf16_f32 v168, v168, v169
    v_cvt_pk_bf16_f32 v169, v170, v171
    v_cvt_pk_bf16_f32 v170, v172, v173
    v_cvt_pk_bf16_f32 v171, v174, v175
    s_waitcnt lgkmcnt(1)
    v_pk_fma_f32 v[176:177], v[176:177], v[120:121], v[112:113]
    v_pk_fma_f32 v[178:179], v[178:179], v[122:123], v[114:115]
    s_waitcnt lgkmcnt(0)
    v_pk_fma_f32 v[180:181], v[180:181], v[124:125], v[116:117]
    v_pk_fma_f32 v[182:183], v[182:183], v[126:127], v[118:119]
    v_cvt_pk_bf16_f32 v176, v176, v177
    v_cvt_pk_bf16_f32 v177, v178, v179
    v_cvt_pk_bf16_f32 v178, v180, v181
    v_cvt_pk_bf16_f32 v179, v182, v183
    v_pk_fma_f32 v[184:185], v[184:185], v[120:121], v[112:113]
    v_pk_fma_f32 v[186:187], v[186:187], v[122:123], v[114:115]
    v_pk_fma_f32 v[188:189], v[188:189], v[124:125], v[116:117]
    v_pk_fma_f32 v[190:191], v[190:191], v[126:127], v[118:119]
    v_cvt_pk_bf16_f32 v184, v184, v185
    v_cvt_pk_bf16_f32 v185, v186, v187
    v_cvt_pk_bf16_f32 v186, v188, v189
    v_cvt_pk_bf16_f32 v187, v190, v191
    s_lshl2_add_u32 s57, s96, s52
    s_lshl_b32 m0, s57, 13
    s_nop 0
    ds_write_addtid_b32 v128 offset:32768
    ds_write_addtid_b32 v129 offset:33024
    ds_write_addtid_b32 v130 offset:33280
    ds_write_addtid_b32 v131 offset:33536
    ds_write_addtid_b32 v136 offset:33792
    ds_write_addtid_b32 v137 offset:34048
    ds_write_addtid_b32 v138 offset:34304
    ds_write_addtid_b32 v139 offset:34560
    ds_write_addtid_b32 v144 offset:34816
    ds_write_addtid_b32 v145 offset:35072
    ds_write_addtid_b32 v146 offset:35328
    ds_write_addtid_b32 v147 offset:35584
    ds_write_addtid_b32 v152 offset:35840
    ds_write_addtid_b32 v153 offset:36096
    ds_write_addtid_b32 v154 offset:36352
    ds_write_addtid_b32 v155 offset:36608
    ds_write_addtid_b32 v160 offset:36864
    ds_write_addtid_b32 v161 offset:37120
    ds_write_addtid_b32 v162 offset:37376
    ds_write_addtid_b32 v163 offset:37632
    ds_write_addtid_b32 v168 offset:37888
    ds_write_addtid_b32 v169 offset:38144
    ds_write_addtid_b32 v170 offset:38400
    ds_write_addtid_b32 v171 offset:38656
    ds_write_addtid_b32 v176 offset:38912
    ds_write_addtid_b32 v177 offset:39168
    ds_write_addtid_b32 v178 offset:39424
    ds_write_addtid_b32 v179 offset:39680
    ds_write_addtid_b32 v184 offset:39936
    ds_write_addtid_b32 v185 offset:40192
    ds_write_addtid_b32 v186 offset:40448
    ds_write_addtid_b32 v187 offset:40704
    s_waitcnt lgkmcnt(0)
    s_barrier
    ds_read_b64_tr_b16 v[88:89], v12 offset:0
    ds_read_b64_tr_b16 v[90:91], v12 offset:2048
    ds_read_b128 v[48:51], v7 offset:0
    ds_read_b128 v[52:55], v7 offset:8192
    ds_read_b128 v[56:59], v7 offset:16384
    ds_read_b128 v[60:63], v7 offset:24576
    ds_read_b64_tr_b16 v[92:93], v12 offset:8192
    ds_read_b64_tr_b16 v[94:95], v12 offset:10240
    ds_read_b64_tr_b16 v[120:121], v12 offset:512
    ds_read_b64_tr_b16 v[122:123], v12 offset:2560
    ds_read_b128 v[64:67], v7 offset:512
    ds_read_b128 v[68:71], v7 offset:8704
    ds_read_b128 v[72:75], v7 offset:16896
    ds_read_b128 v[76:79], v7 offset:25088
    s_waitcnt lgkmcnt(11)
    v_mfma_f32_16x16x32_bf16 v[16:19], v[88:91], v[48:51], 0
    ds_read_b64_tr_b16 v[124:125], v12 offset:8704
    s_waitcnt lgkmcnt(11)
    v_mfma_f32_16x16x32_bf16 v[20:23], v[88:91], v[52:55], 0
    ds_read_b128 v[80:83], v7 offset:2048
    s_waitcnt lgkmcnt(11)
    v_mfma_f32_16x16x32_bf16 v[24:27], v[88:91], v[56:59], 0
    ds_read_b64_tr_b16 v[126:127], v12 offset:10752
    ds_read_b128 v[84:87], v7 offset:10240
    s_waitcnt lgkmcnt(12)
    v_mfma_f32_16x16x32_bf16 v[28:31], v[88:91], v[60:63], 0
    ds_read_b128 v[128:131], v7 offset:32768
    s_waitcnt lgkmcnt(11)
    v_mfma_f32_16x16x32_bf16 v[32:35], v[48:51], v[92:95], 0
    ds_read_b64_tr_b16 v[88:89], v12 offset:16384
    v_mfma_f32_16x16x32_bf16 v[36:39], v[52:55], v[92:95], 0
    ds_read_b128 v[48:51], v7 offset:18432
    v_mfma_f32_16x16x32_bf16 v[40:43], v[56:59], v[92:95], 0
    ds_read_b64_tr_b16 v[90:91], v12 offset:18432
    ds_read_b128 v[52:55], v7 offset:26624
    v_mfma_f32_16x16x32_bf16 v[44:47], v[60:63], v[92:95], 0
    ds_read_b128 v[56:59], v7 offset:2560
    s_waitcnt lgkmcnt(13)
    v_mfma_f32_16x16x32_bf16 v[16:19], v[120:123], v[64:67], v[16:19]
    ds_read_b64_tr_b16 v[92:93], v12 offset:24576
    s_waitcnt lgkmcnt(13)
    v_mfma_f32_16x16x32_bf16 v[20:23], v[120:123], v[68:71], v[20:23]
    ds_read_b128 v[60:63], v7 offset:10752
    s_waitcnt lgkmcnt(13)
    v_mfma_f32_16x16x32_bf16 v[24:27], v[120:123], v[72:75], v[24:27]
    ds_read_b64_tr_b16 v[94:95], v12 offset:26624
    ds_read_b128 v[132:135], v7 offset:40960
    s_waitcnt lgkmcnt(14)
    v_mfma_f32_16x16x32_bf16 v[28:31], v[120:123], v[76:79], v[28:31]
    ds_read_b128 v[136:139], v7 offset:49152
    s_waitcnt lgkmcnt(12)
    v_mfma_f32_16x16x32_bf16 v[32:35], v[64:67], v[124:127], v[32:35]
    ds_read_b64_tr_b16 v[120:121], v12 offset:16896
    v_mfma_f32_16x16x32_bf16 v[36:39], v[68:71], v[124:127], v[36:39]
    ds_read_b128 v[64:67], v7 offset:18944
    v_mfma_f32_16x16x32_bf16 v[40:43], v[72:75], v[124:127], v[40:43]
    ds_read_b64_tr_b16 v[122:123], v12 offset:18944
    ds_read_b128 v[68:71], v7 offset:27136
    v_mfma_f32_16x16x32_bf16 v[44:47], v[76:79], v[124:127], v[44:47]
    ds_read_b128 v[72:75], v7 offset:4096
    s_waitcnt lgkmcnt(12)
    v_mfma_f32_16x16x32_bf16 v[16:19], v[88:91], v[80:83], v[16:19]
    ds_read_b64_tr_b16 v[124:125], v12 offset:25088
    v_mfma_f32_16x16x32_bf16 v[20:23], v[88:91], v[84:87], v[20:23]
    ds_read_b128 v[76:79], v7 offset:12288
    v_mfma_f32_16x16x32_bf16 v[24:27], v[88:91], v[48:51], v[24:27]
    ds_read_b64_tr_b16 v[126:127], v12 offset:27136
    ds_read_b128 v[140:143], v7 offset:57344
    s_waitcnt lgkmcnt(15)
    v_mfma_f32_16x16x32_bf16 v[28:31], v[88:91], v[52:55], v[28:31]
    ds_read_b128 v[144:147], v7 offset:33280
    s_barrier
    s_waitcnt lgkmcnt(12)
    v_mfma_f32_16x16x32_bf16 v[32:35], v[80:83], v[92:95], v[32:35]
    ds_read_b64_tr_b16 v[88:89], v13 offset:0
    v_mfma_f32_16x16x32_bf16 v[36:39], v[84:87], v[92:95], v[36:39]
    ds_read_b128 v[80:83], v7 offset:20480
    v_mfma_f32_16x16x32_bf16 v[40:43], v[48:51], v[92:95], v[40:43]
    ds_read_b64_tr_b16 v[90:91], v13 offset:2048
    ds_read_b128 v[84:87], v7 offset:28672
    v_mfma_f32_16x16x32_bf16 v[44:47], v[52:55], v[92:95], v[44:47]
    ds_read_b128 v[48:51], v7 offset:4608
    s_waitcnt lgkmcnt(12)
    v_mfma_f32_16x16x32_bf16 v[16:19], v[120:123], v[56:59], v[16:19]
    ds_read_b64_tr_b16 v[92:93], v13 offset:8192
    v_mfma_f32_16x16x32_bf16 v[20:23], v[120:123], v[60:63], v[20:23]
    ds_read_b128 v[52:55], v7 offset:12800
    v_mfma_f32_16x16x32_bf16 v[24:27], v[120:123], v[64:67], v[24:27]
    ds_read_b64_tr_b16 v[94:95], v13 offset:10240
    ds_read_b128 v[148:151], v7 offset:41472
    s_waitcnt lgkmcnt(15)
    v_mfma_f32_16x16x32_bf16 v[28:31], v[120:123], v[68:71], v[28:31]
    ds_read_b128 v[152:155], v7 offset:49664
    s_waitcnt lgkmcnt(12)
    v_mfma_f32_16x16x32_bf16 v[32:35], v[56:59], v[124:127], v[32:35]
    s_barrier
    ds_read_b64_tr_b16 v[120:121], v13 offset:512
    v_mfma_f32_16x16x32_bf16 v[36:39], v[60:63], v[124:127], v[36:39]
    ds_read_b128 v[56:59], v7 offset:20992
    v_mfma_f32_16x16x32_bf16 v[40:43], v[64:67], v[124:127], v[40:43]
    ds_read_b64_tr_b16 v[122:123], v13 offset:2560
    ds_read_b128 v[60:63], v7 offset:29184
    v_mfma_f32_16x16x32_bf16 v[44:47], v[68:71], v[124:127], v[44:47]
    ds_read_b128 v[64:67], v7 offset:6144
    s_waitcnt lgkmcnt(12)
    v_mfma_f32_16x16x32_bf16 v[16:19], v[88:91], v[72:75], v[16:19]
    ds_read_b64_tr_b16 v[124:125], v13 offset:8704
    v_mfma_f32_16x16x32_bf16 v[20:23], v[88:91], v[76:79], v[20:23]
    ds_read_b128 v[68:71], v7 offset:14336
    v_mfma_f32_16x16x32_bf16 v[24:27], v[88:91], v[80:83], v[24:27]
    ds_read_b64_tr_b16 v[126:127], v13 offset:10752
    ds_read_b128 v[156:159], v7 offset:57856
    s_waitcnt lgkmcnt(15)
    v_mfma_f32_16x16x32_bf16 v[28:31], v[88:91], v[84:87], v[28:31]
    ds_read_b128 v[160:163], v7 offset:34816
    s_waitcnt lgkmcnt(12)
    v_mfma_f32_16x16x32_bf16 v[32:35], v[72:75], v[92:95], v[32:35]
    ds_read_b64_tr_b16 v[88:89], v13 offset:16384
    v_mfma_f32_16x16x32_bf16 v[36:39], v[76:79], v[92:95], v[36:39]
    ds_read_b128 v[72:75], v7 offset:22528
    v_mfma_f32_16x16x32_bf16 v[40:43], v[80:83], v[92:95], v[40:43]
    ds_read_b64_tr_b16 v[90:91], v13 offset:18432
    ds_read_b128 v[76:79], v7 offset:30720
    v_mfma_f32_16x16x32_bf16 v[44:47], v[84:87], v[92:95], v[44:47]
    ds_read_b128 v[80:83], v7 offset:6656
    s_waitcnt lgkmcnt(12)
    v_mfma_f32_16x16x32_bf16 v[16:19], v[120:123], v[48:51], v[16:19]
    ds_read_b64_tr_b16 v[92:93], v13 offset:24576
    v_mfma_f32_16x16x32_bf16 v[20:23], v[120:123], v[52:55], v[20:23]
    ds_read_b128 v[84:87], v7 offset:14848
    v_mfma_f32_16x16x32_bf16 v[24:27], v[120:123], v[56:59], v[24:27]
    ds_read_b64_tr_b16 v[94:95], v13 offset:26624
    ds_read_b128 v[164:167], v7 offset:43008
    s_waitcnt lgkmcnt(15)
    v_mfma_f32_16x16x32_bf16 v[28:31], v[120:123], v[60:63], v[28:31]
    ds_read_b128 v[168:171], v7 offset:51200
    s_waitcnt lgkmcnt(12)
    v_mfma_f32_16x16x32_bf16 v[32:35], v[48:51], v[124:127], v[32:35]
    ds_read_b64_tr_b16 v[120:121], v13 offset:16896
    v_mfma_f32_16x16x32_bf16 v[36:39], v[52:55], v[124:127], v[36:39]
    ds_read_b128 v[48:51], v7 offset:23040
    v_mfma_f32_16x16x32_bf16 v[40:43], v[56:59], v[124:127], v[40:43]
    ds_read_b64_tr_b16 v[122:123], v13 offset:18944
    ds_read_b128 v[52:55], v7 offset:31232
    v_mfma_f32_16x16x32_bf16 v[44:47], v[60:63], v[124:127], v[44:47]
    ds_read_b128 v[172:175], v7 offset:59392
    s_waitcnt lgkmcnt(12)
    v_mfma_f32_16x16x32_bf16 v[16:19], v[88:91], v[64:67], v[16:19]
    ds_read_b64_tr_b16 v[124:125], v13 offset:25088
    v_mfma_f32_16x16x32_bf16 v[20:23], v[88:91], v[68:71], v[20:23]
    ds_read_b128 v[176:179], v7 offset:35328
    v_mfma_f32_16x16x32_bf16 v[24:27], v[88:91], v[72:75], v[24:27]
    ds_read_b64_tr_b16 v[126:127], v13 offset:27136
    ds_read_b128 v[180:183], v7 offset:43520
    s_waitcnt lgkmcnt(15)
    v_mfma_f32_16x16x32_bf16 v[28:31], v[88:91], v[76:79], v[28:31]
    ds_read_b128 v[184:187], v7 offset:51712
    s_barrier
    s_waitcnt lgkmcnt(12)
    v_mfma_f32_16x16x32_bf16 v[32:35], v[64:67], v[92:95], v[32:35]
    ds_read_b64_tr_b16 v[88:89], v13 offset:32768
    v_mfma_f32_16x16x32_bf16 v[36:39], v[68:71], v[92:95], v[36:39]
    ds_read_b128 v[188:191], v7 offset:59904
    v_mfma_f32_16x16x32_bf16 v[40:43], v[72:75], v[92:95], v[40:43]
    ds_read_b64_tr_b16 v[90:91], v13 offset:34816
    ds_read_b128 v[192:195], v7 offset:36864
    v_mfma_f32_16x16x32_bf16 v[44:47], v[76:79], v[92:95], v[44:47]
    ds_read_b128 v[196:199], v7 offset:45056
    s_waitcnt lgkmcnt(12)
    v_mfma_f32_16x16x32_bf16 v[16:19], v[120:123], v[80:83], v[16:19]
    ds_read_b64_tr_b16 v[92:93], v13 offset:33280
    v_mfma_f32_16x16x32_bf16 v[20:23], v[120:123], v[84:87], v[20:23]
    ds_read_b128 v[200:203], v7 offset:53248
    v_mfma_f32_16x16x32_bf16 v[24:27], v[120:123], v[48:51], v[24:27]
    ds_read_b64_tr_b16 v[94:95], v13 offset:35328
    ds_read_b128 v[204:207], v7 offset:61440
    s_waitcnt lgkmcnt(15)
    v_mfma_f32_16x16x32_bf16 v[28:31], v[120:123], v[52:55], v[28:31]
    ds_read_b128 v[208:211], v7 offset:37376
    s_waitcnt lgkmcnt(12)
    v_mfma_f32_16x16x32_bf16 v[32:35], v[80:83], v[124:127], v[32:35]
    s_barrier
    ds_read_b64_tr_b16 v[120:121], v13 offset:40960
    v_mfma_f32_16x16x32_bf16 v[36:39], v[84:87], v[124:127], v[36:39]
    ds_read_b128 v[212:215], v7 offset:45568
    v_mfma_f32_16x16x32_bf16 v[40:43], v[48:51], v[124:127], v[40:43]
    ds_read_b64_tr_b16 v[122:123], v13 offset:43008
    ds_read_b128 v[216:219], v7 offset:53760
    v_mfma_f32_16x16x32_bf16 v[44:47], v[52:55], v[124:127], v[44:47]
    ds_read_b128 v[220:223], v7 offset:61952
    s_waitcnt lgkmcnt(12)
    v_mfma_f32_16x16x32_bf16 v[16:19], v[88:91], v[128:131], v[16:19]
    ds_read_b64_tr_b16 v[124:125], v13 offset:41472
    v_mfma_f32_16x16x32_bf16 v[20:23], v[88:91], v[132:135], v[20:23]
    ds_read_b128 v[224:227], v7 offset:38912
    v_mfma_f32_16x16x32_bf16 v[24:27], v[88:91], v[136:139], v[24:27]
    ds_read_b64_tr_b16 v[126:127], v13 offset:43520
    ds_read_b128 v[228:231], v7 offset:47104
    v_mfma_f32_16x16x32_bf16 v[28:31], v[88:91], v[140:143], v[28:31]
    ds_read_b128 v[232:235], v7 offset:55296
    s_waitcnt lgkmcnt(12)
    v_mfma_f32_16x16x32_bf16 v[16:19], v[92:95], v[144:147], v[16:19]
    ds_read_b64_tr_b16 v[88:89], v13 offset:49152
    v_mfma_f32_16x16x32_bf16 v[20:23], v[92:95], v[148:151], v[20:23]
    ds_read_b128 v[236:239], v7 offset:63488
    v_mfma_f32_16x16x32_bf16 v[24:27], v[92:95], v[152:155], v[24:27]
    ds_read_b64_tr_b16 v[90:91], v13 offset:51200
    ds_read_b128 v[240:243], v7 offset:39424
    v_mfma_f32_16x16x32_bf16 v[28:31], v[92:95], v[156:159], v[28:31]
    ds_read_b128 v[244:247], v7 offset:47616
    s_waitcnt lgkmcnt(12)
    v_mfma_f32_16x16x32_bf16 v[16:19], v[120:123], v[160:163], v[16:19]
    ds_read_b64_tr_b16 v[92:93], v13 offset:49664
    v_mfma_f32_16x16x32_bf16 v[20:23], v[120:123], v[164:167], v[20:23]
    ds_read_b128 v[248:251], v7 offset:55808
    v_mfma_f32_16x16x32_bf16 v[24:27], v[120:123], v[168:171], v[24:27]
    ds_read_b64_tr_b16 v[94:95], v13 offset:51712
    ds_read_b128 v[252:255], v7 offset:64000
    v_mfma_f32_16x16x32_bf16 v[28:31], v[120:123], v[172:175], v[28:31]
    s_waitcnt lgkmcnt(11)
    v_mfma_f32_16x16x32_bf16 v[16:19], v[124:127], v[176:179], v[16:19]
    ds_read_b64_tr_b16 v[120:121], v13 offset:57344
    v_mfma_f32_16x16x32_bf16 v[20:23], v[124:127], v[180:183], v[20:23]
    v_mfma_f32_16x16x32_bf16 v[24:27], v[124:127], v[184:187], v[24:27]
    ds_read_b64_tr_b16 v[122:123], v13 offset:59392
    v_mfma_f32_16x16x32_bf16 v[28:31], v[124:127], v[188:191], v[28:31]
    s_waitcnt lgkmcnt(8)
    v_mfma_f32_16x16x32_bf16 v[16:19], v[88:91], v[192:195], v[16:19]
    ds_read_b64_tr_b16 v[124:125], v13 offset:57856
    v_mfma_f32_16x16x32_bf16 v[20:23], v[88:91], v[196:199], v[20:23]
    v_mfma_f32_16x16x32_bf16 v[24:27], v[88:91], v[200:203], v[24:27]
    ds_read_b64_tr_b16 v[126:127], v13 offset:59904
    v_mfma_f32_16x16x32_bf16 v[28:31], v[88:91], v[204:207], v[28:31]
    s_barrier
    s_waitcnt lgkmcnt(5)
    v_mfma_f32_16x16x32_bf16 v[16:19], v[92:95], v[208:211], v[16:19]
    ds_read_b64_tr_b16 v[88:89], v12 offset:0
    v_mfma_f32_16x16x32_bf16 v[20:23], v[92:95], v[212:215], v[20:23]
    v_mfma_f32_16x16x32_bf16 v[24:27], v[92:95], v[216:219], v[24:27]
    ds_read_b64_tr_b16 v[90:91], v12 offset:2048
    v_mfma_f32_16x16x32_bf16 v[28:31], v[92:95], v[220:223], v[28:31]
    s_waitcnt lgkmcnt(4)
    v_mfma_f32_16x16x32_bf16 v[16:19], v[120:123], v[224:227], v[16:19]
    ds_read_b64_tr_b16 v[92:93], v12 offset:512
    v_mfma_f32_16x16x32_bf16 v[20:23], v[120:123], v[228:231], v[20:23]
    v_mfma_f32_16x16x32_bf16 v[24:27], v[120:123], v[232:235], v[24:27]
    ds_read_b64_tr_b16 v[94:95], v12 offset:2560
    v_mfma_f32_16x16x32_bf16 v[28:31], v[120:123], v[236:239], v[28:31]
    s_waitcnt lgkmcnt(4)
    v_mfma_f32_16x16x32_bf16 v[16:19], v[124:127], v[240:243], v[16:19]
    s_barrier
    ds_read_b64_tr_b16 v[120:121], v12 offset:8192
    v_mfma_f32_16x16x32_bf16 v[20:23], v[124:127], v[244:247], v[20:23]
    v_mfma_f32_16x16x32_bf16 v[24:27], v[124:127], v[248:251], v[24:27]
    ds_read_b64_tr_b16 v[122:123], v12 offset:10240
    v_mfma_f32_16x16x32_bf16 v[28:31], v[124:127], v[252:255], v[28:31]
    s_waitcnt lgkmcnt(4)
    v_mfma_f32_16x16x32_bf16 v[32:35], v[128:131], v[88:91], v[32:35]
    ds_read_b64_tr_b16 v[124:125], v12 offset:8704
    s_nop 0
    v_mfma_f32_16x16x32_bf16 v[36:39], v[132:135], v[88:91], v[36:39]
    s_nop 0
    s_nop 0
    v_mfma_f32_16x16x32_bf16 v[40:43], v[136:139], v[88:91], v[40:43]
    ds_read_b64_tr_b16 v[126:127], v12 offset:10752
    s_nop 0
    v_mfma_f32_16x16x32_bf16 v[44:47], v[140:143], v[88:91], v[44:47]
    v_cvt_pk_bf16_f32 v96, v16, v17
    v_cvt_pk_bf16_f32 v98, v20, v21
    s_waitcnt lgkmcnt(4)
    v_mfma_f32_16x16x32_bf16 v[32:35], v[144:147], v[92:95], v[32:35]
    ds_read_b64_tr_b16 v[88:89], v12 offset:16384
    v_cvt_pk_bf16_f32 v97, v18, v19
    v_mfma_f32_16x16x32_bf16 v[36:39], v[148:151], v[92:95], v[36:39]
    v_cvt_pk_bf16_f32 v99, v22, v23
    v_cvt_pk_bf16_f32 v100, v24, v25
    v_mfma_f32_16x16x32_bf16 v[40:43], v[152:155], v[92:95], v[40:43]
    ds_read_b64_tr_b16 v[90:91], v12 offset:18432
    v_cvt_pk_bf16_f32 v102, v28, v29
    v_mfma_f32_16x16x32_bf16 v[44:47], v[156:159], v[92:95], v[44:47]
    v_cvt_pk_bf16_f32 v101, v26, v27
    v_cvt_pk_bf16_f32 v103, v30, v31
    s_waitcnt lgkmcnt(4)
    v_mfma_f32_16x16x32_bf16 v[32:35], v[160:163], v[120:123], v[32:35]
    ds_read_b64_tr_b16 v[92:93], v12 offset:16896
    v_permlane16_swap_b32 v96, v98
    v_mfma_f32_16x16x32_bf16 v[36:39], v[164:167], v[120:123], v[36:39]
    v_permlane16_swap_b32 v97, v99
    buffer_store_dwordx4 v[96:99], v1, s[44:47], s80 offen offset:0 sc1
    v_mfma_f32_16x16x32_bf16 v[40:43], v[168:171], v[120:123], v[40:43]
    ds_read_b64_tr_b16 v[94:95], v12 offset:18944
    v_permlane16_swap_b32 v100, v102
    v_mfma_f32_16x16x32_bf16 v[44:47], v[172:175], v[120:123], v[44:47]
    v_permlane16_swap_b32 v101, v103
    buffer_store_dwordx4 v[100:103], v1, s[44:47], s80 offen offset:1024 sc1
    s_waitcnt lgkmcnt(4)
    v_mfma_f32_16x16x32_bf16 v[32:35], v[176:179], v[124:127], v[32:35]
    ds_read_b64_tr_b16 v[120:121], v12 offset:24576
    v_add3_u32 v2, v96, v97, s56
    v_mfma_f32_16x16x32_bf16 v[36:39], v[180:183], v[124:127], v[36:39]
    v_add3_u32 v2, v98, v99, v2
    v_add3_u32 v2, v100, v101, v2
    v_mfma_f32_16x16x32_bf16 v[40:43], v[184:187], v[124:127], v[40:43]
    ds_read_b64_tr_b16 v[122:123], v12 offset:26624
    v_add3_u32 v2, v102, v103, v2
    v_mfma_f32_16x16x32_bf16 v[44:47], v[188:191], v[124:127], v[44:47]
    buffer_store_dword v2, v14, s[44:47], s80 offen offset:2048 sc1
    s_waitcnt lgkmcnt(4)
    v_mfma_f32_16x16x32_bf16 v[32:35], v[192:195], v[88:91], v[32:35]
    ds_read_b64_tr_b16 v[124:125], v12 offset:25088
    ds_read_b128 v[56:59], v7 offset:0
    v_mfma_f32_16x16x32_bf16 v[36:39], v[196:199], v[88:91], v[36:39]
    ds_read_b128 v[60:63], v7 offset:8192
    v_mfma_f32_16x16x32_bf16 v[40:43], v[200:203], v[88:91], v[40:43]
    ds_read_b64_tr_b16 v[126:127], v12 offset:27136
    ds_read_b128 v[64:67], v7 offset:16384
    v_mfma_f32_16x16x32_bf16 v[44:47], v[204:207], v[88:91], v[44:47]
    s_barrier
    s_waitcnt lgkmcnt(7)
    v_mfma_f32_16x16x32_bf16 v[32:35], v[208:211], v[92:95], v[32:35]
    ds_read_b64_tr_b16 v[88:89], v13 offset:0
    ds_read_b128 v[68:71], v7 offset:24576
    v_mfma_f32_16x16x32_bf16 v[36:39], v[212:215], v[92:95], v[36:39]
    ds_read_b128 v[72:75], v7 offset:512
    v_mfma_f32_16x16x32_bf16 v[40:43], v[216:219], v[92:95], v[40:43]
    ds_read_b64_tr_b16 v[90:91], v13 offset:2048
    ds_read_b128 v[76:79], v7 offset:8704
    v_mfma_f32_16x16x32_bf16 v[44:47], v[220:223], v[92:95], v[44:47]
    s_waitcnt lgkmcnt(10)
    v_mfma_f32_16x16x32_bf16 v[32:35], v[224:227], v[120:123], v[32:35]
    ds_read_b64_tr_b16 v[92:93], v13 offset:8192
    ds_read_b128 v[80:83], v7 offset:16896
    v_mfma_f32_16x16x32_bf16 v[36:39], v[228:231], v[120:123], v[36:39]
    ds_read_b128 v[84:87], v7 offset:25088
    v_mfma_f32_16x16x32_bf16 v[40:43], v[232:235], v[120:123], v[40:43]
    ds_read_b64_tr_b16 v[94:95], v13 offset:10240
    ds_read_b128 v[48:51], v7 offset:2048
    v_mfma_f32_16x16x32_bf16 v[44:47], v[236:239], v[120:123], v[44:47]
    s_waitcnt lgkmcnt(11)
    v_mfma_f32_16x16x32_bf16 v[32:35], v[240:243], v[124:127], v[32:35]
    ds_read_b64_tr_b16 v[120:121], v13 offset:512
    ds_read_b128 v[52:55], v7 offset:10240
    v_mfma_f32_16x16x32_bf16 v[36:39], v[244:247], v[124:127], v[36:39]
    v_mfma_f32_16x16x32_bf16 v[40:43], v[248:251], v[124:127], v[40:43]
    ds_read_b64_tr_b16 v[122:123], v13 offset:2560
    v_mfma_f32_16x16x32_bf16 v[44:47], v[252:255], v[124:127], v[44:47]
    s_waitcnt lgkmcnt(9)
    v_mfma_f32_16x16x32_bf16 v[16:19], v[88:91], v[128:131], 0
    ds_read_b64_tr_b16 v[124:125], v13 offset:8704
    s_nop 0
    v_mfma_f32_16x16x32_bf16 v[20:23], v[88:91], v[132:135], 0
    s_nop 0
    s_nop 0
    v_mfma_f32_16x16x32_bf16 v[24:27], v[88:91], v[136:139], 0
    ds_read_b64_tr_b16 v[126:127], v13 offset:10752
    s_nop 0
    v_mfma_f32_16x16x32_bf16 v[28:31], v[88:91], v[140:143], 0
    v_cvt_pk_bf16_f32 v104, v32, v33
    v_cvt_pk_bf16_f32 v106, v36, v37
    s_waitcnt lgkmcnt(6)
    v_mfma_f32_16x16x32_bf16 v[16:19], v[92:95], v[56:59], v[16:19]
    ds_read_b64_tr_b16 v[88:89], v13 offset:16384
    ds_read_b128 v[56:59], v7 offset:18432
    v_cvt_pk_bf16_f32 v105, v34, v35
    v_mfma_f32_16x16x32_bf16 v[20:23], v[92:95], v[60:63], v[20:23]
    ds_read_b128 v[60:63], v7 offset:26624
    v_cvt_pk_bf16_f32 v107, v38, v39
    v_mfma_f32_16x16x32_bf16 v[24:27], v[92:95], v[64:67], v[24:27]
    ds_read_b64_tr_b16 v[90:91], v13 offset:18432
    ds_read_b128 v[64:67], v7 offset:2560
    v_cvt_pk_bf16_f32 v108, v40, v41
    v_mfma_f32_16x16x32_bf16 v[28:31], v[92:95], v[68:71], v[28:31]
    v_cvt_pk_bf16_f32 v110, v44, v45
    v_cvt_pk_bf16_f32 v109, v42, v43
    s_waitcnt lgkmcnt(7)
    v_mfma_f32_16x16x32_bf16 v[16:19], v[120:123], v[144:147], v[16:19]
    ds_read_b64_tr_b16 v[92:93], v13 offset:24576
    ds_read_b128 v[68:71], v7 offset:10752
    v_cvt_pk_bf16_f32 v111, v46, v47
    v_mfma_f32_16x16x32_bf16 v[20:23], v[120:123], v[148:151], v[20:23]
    v_permlane16_swap_b32 v104, v106
    v_permlane16_swap_b32 v105, v107
    v_mfma_f32_16x16x32_bf16 v[24:27], v[120:123], v[152:155], v[24:27]
    ds_read_b64_tr_b16 v[94:95], v13 offset:26624
    v_permlane16_swap_b32 v108, v110
    v_mfma_f32_16x16x32_bf16 v[28:31], v[120:123], v[156:159], v[28:31]
    v_permlane16_swap_b32 v109, v111
    v_permlane32_swap_b32 v104, v106
    s_waitcnt lgkmcnt(8)
    v_mfma_f32_16x16x32_bf16 v[16:19], v[124:127], v[72:75], v[16:19]
    ds_read_b64_tr_b16 v[120:121], v13 offset:16896
    ds_read_b128 v[72:75], v7 offset:18944
    v_permlane32_swap_b32 v105, v107
    v_mfma_f32_16x16x32_bf16 v[20:23], v[124:127], v[76:79], v[20:23]
    ds_read_b128 v[76:79], v7 offset:27136
    buffer_store_dwordx4 v[104:107], v1, s[44:47], s80 offen offset:2560 sc1
    v_mfma_f32_16x16x32_bf16 v[24:27], v[124:127], v[80:83], v[24:27]
    ds_read_b64_tr_b16 v[122:123], v13 offset:18944
    ds_read_b128 v[80:83], v7 offset:4096
    v_permlane32_swap_b32 v108, v110
    v_mfma_f32_16x16x32_bf16 v[28:31], v[124:127], v[84:87], v[28:31]
    v_permlane32_swap_b32 v109, v111
    buffer_store_dwordx4 v[108:111], v1, s[44:47], s80 offen offset:3584 sc1
    s_waitcnt lgkmcnt(9)
    v_mfma_f32_16x16x32_bf16 v[16:19], v[88:91], v[160:163], v[16:19]
    ds_read_b64_tr_b16 v[124:125], v13 offset:25088
    ds_read_b128 v[84:87], v7 offset:12288
    v_add3_u32 v11, v104, v105, s56
    v_mfma_f32_16x16x32_bf16 v[20:23], v[88:91], v[164:167], v[20:23]
    v_add3_u32 v11, v106, v107, v11
    v_add3_u32 v11, v108, v109, v11
    v_mfma_f32_16x16x32_bf16 v[24:27], v[88:91], v[168:171], v[24:27]
    ds_read_b64_tr_b16 v[126:127], v13 offset:27136
    v_add3_u32 v11, v110, v111, v11
    v_mfma_f32_16x16x32_bf16 v[28:31], v[88:91], v[172:175], v[28:31]
    buffer_store_dword v11, v14, s[44:47], s80 offen offset:2304 sc1
    s_barrier
    s_waitcnt lgkmcnt(8)
    v_mfma_f32_16x16x32_bf16 v[16:19], v[92:95], v[48:51], v[16:19]
    ds_read_b64_tr_b16 v[88:89], v13 offset:32768
    ds_read_b128 v[48:51], v7 offset:20480
    v_mfma_f32_16x16x32_bf16 v[20:23], v[92:95], v[52:55], v[20:23]
    ds_read_b128 v[52:55], v7 offset:28672
    v_mfma_f32_16x16x32_bf16 v[24:27], v[92:95], v[56:59], v[24:27]
    ds_read_b64_tr_b16 v[90:91], v13 offset:34816
    ds_read_b128 v[56:59], v7 offset:4608
    v_mfma_f32_16x16x32_bf16 v[28:31], v[92:95], v[60:63], v[28:31]
    s_waitcnt lgkmcnt(9)
    v_mfma_f32_16x16x32_bf16 v[16:19], v[120:123], v[176:179], v[16:19]
    ds_read_b64_tr_b16 v[92:93], v13 offset:40960
    ds_read_b128 v[60:63], v7 offset:12800
    v_mfma_f32_16x16x32_bf16 v[20:23], v[120:123], v[180:183], v[20:23]
    v_mfma_f32_16x16x32_bf16 v[24:27], v[120:123], v[184:187], v[24:27]
    ds_read_b64_tr_b16 v[94:95], v13 offset:43008
    v_mfma_f32_16x16x32_bf16 v[28:31], v[120:123], v[188:191], v[28:31]
    s_waitcnt lgkmcnt(8)
    v_mfma_f32_16x16x32_bf16 v[16:19], v[124:127], v[64:67], v[16:19]
    ds_read_b64_tr_b16 v[120:121], v13 offset:33280
    ds_read_b128 v[64:67], v7 offset:20992
    v_mfma_f32_16x16x32_bf16 v[20:23], v[124:127], v[68:71], v[20:23]
    ds_read_b128 v[68:71], v7 offset:29184
    v_mfma_f32_16x16x32_bf16 v[24:27], v[124:127], v[72:75], v[24:27]
    ds_read_b64_tr_b16 v[122:123], v13 offset:35328
    ds_read_b128 v[72:75], v7 offset:6144
    v_mfma_f32_16x16x32_bf16 v[28:31], v[124:127], v[76:79], v[28:31]
    s_waitcnt lgkmcnt(9)
    v_mfma_f32_16x16x32_bf16 v[16:19], v[88:91], v[192:195], v[16:19]
    ds_read_b64_tr_b16 v[124:125], v13 offset:41472
    ds_read_b128 v[76:79], v7 offset:14336
    v_mfma_f32_16x16x32_bf16 v[20:23], v[88:91], v[196:199], v[20:23]
    v_mfma_f32_16x16x32_bf16 v[24:27], v[88:91], v[200:203], v[24:27]
    ds_read_b64_tr_b16 v[126:127], v13 offset:43520
    v_mfma_f32_16x16x32_bf16 v[28:31], v[88:91], v[204:207], v[28:31]
    s_waitcnt lgkmcnt(8)
    v_mfma_f32_16x16x32_bf16 v[16:19], v[92:95], v[80:83], v[16:19]
    ds_read_b64_tr_b16 v[88:89], v13 offset:49152
    ds_read_b128 v[80:83], v7 offset:22528
    v_mfma_f32_16x16x32_bf16 v[20:23], v[92:95], v[84:87], v[20:23]
    ds_read_b128 v[84:87], v7 offset:30720
    v_mfma_f32_16x16x32_bf16 v[24:27], v[92:95], v[48:51], v[24:27]
    ds_read_b64_tr_b16 v[90:91], v13 offset:51200
    ds_read_b128 v[48:51], v7 offset:6656
    v_mfma_f32_16x16x32_bf16 v[28:31], v[92:95], v[52:55], v[28:31]
    s_waitcnt lgkmcnt(9)
    v_mfma_f32_16x16x32_bf16 v[16:19], v[120:123], v[208:211], v[16:19]
    ds_read_b64_tr_b16 v[92:93], v13 offset:57344
    ds_read_b128 v[52:55], v7 offset:14848
    v_mfma_f32_16x16x32_bf16 v[20:23], v[120:123], v[212:215], v[20:23]
    v_mfma_f32_16x16x32_bf16 v[24:27], v[120:123], v[216:219], v[24:27]
    ds_read_b64_tr_b16 v[94:95], v13 offset:59392
    v_mfma_f32_16x16x32_bf16 v[28:31], v[120:123], v[220:223], v[28:31]
    s_waitcnt lgkmcnt(8)
    v_mfma_f32_16x16x32_bf16 v[16:19], v[124:127], v[56:59], v[16:19]
    ds_read_b64_tr_b16 v[120:121], v13 offset:49664
    ds_read_b128 v[56:59], v7 offset:23040
    v_mfma_f32_16x16x32_bf16 v[20:23], v[124:127], v[60:63], v[20:23]
    ds_read_b128 v[60:63], v7 offset:31232
    v_mfma_f32_16x16x32_bf16 v[24:27], v[124:127], v[64:67], v[24:27]
    ds_read_b64_tr_b16 v[122:123], v13 offset:51712
    v_mfma_f32_16x16x32_bf16 v[28:31], v[124:127], v[68:71], v[28:31]
    s_waitcnt lgkmcnt(8)
    v_mfma_f32_16x16x32_bf16 v[16:19], v[88:91], v[224:227], v[16:19]
    ds_read_b64_tr_b16 v[124:125], v13 offset:57856
    v_mfma_f32_16x16x32_bf16 v[20:23], v[88:91], v[228:231], v[20:23]
    v_mfma_f32_16x16x32_bf16 v[24:27], v[88:91], v[232:235], v[24:27]
    ds_read_b64_tr_b16 v[126:127], v13 offset:59904
    v_mfma_f32_16x16x32_bf16 v[28:31], v[88:91], v[236:239], v[28:31]
    s_waitcnt lgkmcnt(6)
    v_mfma_f32_16x16x32_bf16 v[16:19], v[92:95], v[72:75], v[16:19]
    v_mfma_f32_16x16x32_bf16 v[20:23], v[92:95], v[76:79], v[20:23]
    buffer_load_dwordx4 v[152:155], v1, s[76:79], 0 offen offset:0 sc1
    v_mfma_f32_16x16x32_bf16 v[24:27], v[92:95], v[80:83], v[24:27]
    v_mfma_f32_16x16x32_bf16 v[28:31], v[92:95], v[84:87], v[28:31]
    buffer_load_dwordx4 v[156:159], v1, s[76:79], 0 offen offset:1024 sc1
    s_waitcnt lgkmcnt(2)
    v_mfma_f32_16x16x32_bf16 v[16:19], v[120:123], v[240:243], v[16:19]
    v_mfma_f32_16x16x32_bf16 v[20:23], v[120:123], v[244:247], v[20:23]
    buffer_load_dword v115, v14, s[76:79], 0 offen offset:2048 sc1
    v_mfma_f32_16x16x32_bf16 v[24:27], v[120:123], v[248:251], v[24:27]
    v_mfma_f32_16x16x32_bf16 v[28:31], v[120:123], v[252:255], v[28:31]
    buffer_load_dwordx4 v[144:147], v1, s[72:75], 0 offen offset:0 sc1
    s_waitcnt lgkmcnt(0)
    v_mfma_f32_16x16x32_bf16 v[16:19], v[124:127], v[48:51], v[16:19]
    v_mfma_f32_16x16x32_bf16 v[20:23], v[124:127], v[52:55], v[20:23]
    buffer_load_dwordx4 v[148:151], v1, s[72:75], 0 offen offset:1024 sc1
    v_mfma_f32_16x16x32_bf16 v[24:27], v[124:127], v[56:59], v[24:27]
    v_mfma_f32_16x16x32_bf16 v[28:31], v[124:127], v[60:63], v[28:31]
    buffer_load_dword v114, v14, s[72:75], 0 offen offset:2048 sc1
    s_nop 2
    v_mul_f32 v16, 0x3eb8aa3b, v16
    v_mul_f32 v17, 0x3eb8aa3b, v17
    v_mul_f32 v18, 0x3eb8aa3b, v18
    v_mul_f32 v19, 0x3eb8aa3b, v19
    v_mul_f32 v20, 0x3eb8aa3b, v20
    v_mul_f32 v21, 0x3eb8aa3b, v21
    v_mul_f32 v22, 0x3eb8aa3b, v22
    v_mul_f32 v23, 0x3eb8aa3b, v23
    v_mul_f32 v24, 0x3eb8aa3b, v24
    v_mul_f32 v25, 0x3eb8aa3b, v25
    v_mul_f32 v26, 0x3eb8aa3b, v26
    v_mul_f32 v27, 0x3eb8aa3b, v27
    v_mul_f32 v28, 0x3eb8aa3b, v28
    v_mul_f32 v29, 0x3eb8aa3b, v29
    v_mul_f32 v30, 0x3eb8aa3b, v30
    v_mul_f32 v31, 0x3eb8aa3b, v31
    v_cvt_pk_bf16_f32 v120, v16, v17
    v_cvt_pk_bf16_f32 v122, v20, v21
    v_cvt_pk_bf16_f32 v121, v18, v19
    v_cvt_pk_bf16_f32 v123, v22, v23
    v_cvt_pk_bf16_f32 v124, v24, v25
    v_cvt_pk_bf16_f32 v126, v28, v29
    v_cvt_pk_bf16_f32 v125, v26, v27
    v_cvt_pk_bf16_f32 v127, v30, v31
    v_permlane16_swap_b32 v120, v122
    v_permlane16_swap_b32 v121, v123
    v_permlane16_swap_b32 v124, v126
    v_permlane16_swap_b32 v125, v127
    v_mfma_f32_32x32x16_bf16 v[16:31], v[96:99], v[120:123], 0
    s_nop 0
    v_mfma_f32_32x32x16_bf16 v[32:47], v[100:103], v[124:127], 0
    v_mov_b32 v2, 0xffff
    v_cndmask_b32 v240, 0, v2, s[64:65]
    v_cndmask_b32 v241, 0, v2, s[68:69]
    v_cndmask_b32 v242, 0, v2, s[82:83]
    v_cndmask_b32 v243, 0, v2, s[86:87]
    v_cndmask_b32 v244, 0, v2, s[90:91]
    v_cndmask_b32 v245, 0, v2, s[94:95]
    v_cndmask_b32 v246, 0, v2, s[10:11]
    v_cndmask_b32 v247, 0, v2, s[14:15]
    v_cndmask_b32 v240, v240, -1, s[66:67]
    v_cndmask_b32 v241, v241, -1, s[70:71]
    v_cndmask_b32 v242, v242, -1, s[84:85]
    v_cndmask_b32 v243, v243, -1, s[88:89]
    v_cndmask_b32 v244, v244, -1, s[92:93]
    v_cndmask_b32 v245, v245, -1, s[8:9]
    v_cndmask_b32 v246, v246, -1, s[12:13]
    v_cndmask_b32 v247, v247, -1, s[16:17]
    v_mov_b32 v12, s56
    v_lshlrev_b32 v13, 26, v4
    v_mov_b32 v2, v3
    s_cmp_ge_u32 s53, 4
    s_cselect_b32 s59, s56, 0
    s_cselect_b32 s57, -1, 0
    v_and_b32 v208, s57, v2
    v_and_b32 v209, s57, v2
    v_mov_b64 v[210:211], v[208:209]
    s_cmp_ge_u32 s53, 3
    s_cselect_b32 s60, s56, 0
    s_cselect_b32 s57, -1, 0
    v_and_b32 v212, s57, v2
    v_and_b32 v213, s57, v2
    v_mov_b64 v[214:215], v[212:213]
    s_cmp_ge_u32 s53, 2
    s_cselect_b32 s61, s56, 0
    s_cselect_b32 s57, -1, 0
    v_and_b32 v216, s57, v2
    v_and_b32 v217, s57, v2
    v_mov_b64 v[218:219], v[216:217]
    s_cmp_ge_u32 s53, 1
    s_cselect_b32 s62, s56, 0
    s_cselect_b32 s57, -1, 0
    v_and_b32 v220, s57, v2
    v_and_b32 v221, s57, v2
    v_mov_b64 v[222:223], v[220:221]
    v_mov_b64 v[116:117], v[2:3]
    v_mov_b64 v[118:119], v[2:3]
    v_mov_b32 v2, 0xff800000
    s_mov_b32 s32, 0x5d800000
    buffer_load_dwordx4 v[184:187], v1, s[76:79], 0 offen offset:2560 sc1
    buffer_load_dwordx4 v[188:191], v1, s[76:79], 0 offen offset:3584 sc1
    buffer_load_dword v251, v14, s[76:79], 0 offen offset:2304 sc1
    v_cndmask_b32 v16, v2, v16, s[64:65]
    v_cndmask_b32 v17, v2, v17, s[66:67]
    v_cndmask_b32 v18, v2, v18, s[68:69]
    v_cndmask_b32 v19, v2, v19, s[70:71]
    v_cndmask_b32 v20, v2, v20, s[82:83]
    v_cndmask_b32 v21, v2, v21, s[84:85]
    v_cndmask_b32 v22, v2, v22, s[86:87]
    v_cndmask_b32 v23, v2, v23, s[88:89]
    v_cndmask_b32 v24, v2, v24, s[90:91]
    v_cndmask_b32 v25, v2, v25, s[92:93]
    v_cndmask_b32 v26, v2, v26, s[94:95]
    v_cndmask_b32 v27, v2, v27, s[8:9]
    v_cndmask_b32 v28, v2, v28, s[10:11]
    v_cndmask_b32 v29, v2, v29, s[12:13]
    v_cndmask_b32 v30, v2, v30, s[14:15]
    v_cndmask_b32 v31, v2, v31, s[16:17]
    v_max_f32 v8, v16, v17
    v_max_f32 v9, v18, v19
    v_max3_f32 v8, v20, v21, v8
    v_max3_f32 v9, v22, v23, v9
    v_max3_f32 v8, v24, v25, v8
    v_max3_f32 v9, v26, v27, v9
    v_max3_f32 v8, v28, v29, v8
    v_max3_f32 v9, v30, v31, v9
    v_cndmask_b32 v32, v2, v32, s[64:65]
    v_cndmask_b32 v33, v2, v33, s[66:67]
    v_cndmask_b32 v34, v2, v34, s[68:69]
    v_cndmask_b32 v35, v2, v35, s[70:71]
    v_cndmask_b32 v36, v2, v36, s[82:83]
    v_cndmask_b32 v37, v2, v37, s[84:85]
    v_cndmask_b32 v38, v2, v38, s[86:87]
    v_cndmask_b32 v39, v2, v39, s[88:89]
    v_cndmask_b32 v40, v2, v40, s[90:91]
    v_cndmask_b32 v41, v2, v41, s[92:93]
    v_cndmask_b32 v42, v2, v42, s[94:95]
    v_cndmask_b32 v43, v2, v43, s[8:9]
    v_cndmask_b32 v44, v2, v44, s[10:11]
    v_cndmask_b32 v45, v2, v45, s[12:13]
    v_cndmask_b32 v46, v2, v46, s[14:15]
    v_cndmask_b32 v47, v2, v47, s[16:17]
    v_max_f32 v10, v32, v33
    v_max_f32 v11, v34, v35
    v_max3_f32 v10, v36, v37, v10
    v_max3_f32 v11, v38, v39, v11
    v_max3_f32 v10, v40, v41, v10
    v_max3_f32 v11, v42, v43, v11
    v_max3_f32 v10, v44, v45, v10
    v_max3_f32 v11, v46, v47, v11
    v_max_f32 v8, v8, v9
    v_max_f32 v10, v10, v11
    v_mov_b32 v9, v8
    v_mov_b32 v11, v10
    s_nop 0
    v_permlane32_swap_b32 v8, v9
    v_permlane32_swap_b32 v10, v11
    v_max_f32 v8, v8, v9
    v_max_f32 v10, v10, v11
    v_sub_f32 v8, 0, v8
    v_sub_f32 v10, 0, v10
    v_mov_b32 v9, v8
    v_mov_b32 v11, v10
    s_bitcmp1_b32 s2, 0
    s_cbranch_scc1 L_p2b
    v_mov_b64 v[80:81], v[10:11]
    v_mov_b64 v[82:83], v[10:11]
    v_mov_b64 v[84:85], v[10:11]
    v_mov_b64 v[86:87], v[10:11]
    v_mov_b64 v[88:89], v[10:11]
    s_waitcnt vmcnt(7)
    v_add3_u32 v252, v152, v153, s62
    v_add3_u32 v252, v154, v155, v252
    v_add3_u32 v252, v156, v157, v252
    v_add3_u32 v252, v158, v159, v252
    s_waitcnt vmcnt(6)
    v_cmp_ne_u32 vcc, v252, v115
    v_mov_b64 v[90:91], v[10:11]
    v_mov_b64 v[92:93], v[10:11]
    v_mov_b64 v[94:95], v[10:11]
    s_nop 1
    v_mfma_f32_32x32x16_bf16 v[16:31], v[96:99], v[124:127], v[80:95]
    buffer_load_dwordx4 v[136:139], v1, s[40:43], 0 offen offset:0 sc1
    buffer_load_dwordx4 v[140:143], v1, s[40:43], 0 offen offset:1024 sc1
    buffer_load_dword v253, v14, s[40:43], 0 offen offset:2048 sc1
    s_nop 8
    v_exp_f32 v16, v16
    s_cbranch_vccnz L_rk3a
L_gk3a:
    v_mfma_f32_32x32x16_bf16 v[32:47], v[156:159], v[124:127], v[80:95]
    v_exp_f32 v17, v17
    v_exp_f32 v18, v18
    v_exp_f32 v19, v19
    buffer_load_dwordx4 v[176:179], v1, s[72:75], 0 offen offset:2560 sc1
    v_cvt_pk_bf16_f32 v16, v16, v17
    v_exp_f32 v20, v20
    v_exp_f32 v21, v21
    v_cvt_pk_bf16_f32 v17, v18, v19
    buffer_load_dwordx4 v[180:183], v1, s[72:75], 0 offen offset:3584 sc1
    v_exp_f32 v22, v22
    v_exp_f32 v23, v23
    v_cvt_pk_bf16_f32 v18, v20, v21
    v_exp_f32 v24, v24
    buffer_load_dword v250, v14, s[72:75], 0 offen offset:2304 sc1
    v_exp_f32 v25, v25
    v_cvt_pk_bf16_f32 v19, v22, v23
    v_exp_f32 v26, v26
    v_exp_f32 v27, v27
    buffer_load_dwordx4 v[128:131], v1, s[4:7], 0 offen offset:0 sc1
    v_cvt_pk_bf16_f32 v20, v24, v25
    v_exp_f32 v28, v28
    v_exp_f32 v29, v29
    v_cvt_pk_bf16_f32 v21, v26, v27
    buffer_load_dwordx4 v[132:135], v1, s[4:7], 0 offen offset:1024 sc1
    v_exp_f32 v30, v30
    v_exp_f32 v31, v31
    v_cvt_pk_bf16_f32 v22, v28, v29
    v_cvt_pk_bf16_f32 v23, v30, v31
    buffer_load_dword v254, v14, s[4:7], 0 offen offset:2048 sc1
    v_exp_f32 v32, v32
    v_mfma_f32_32x32x16_bf16 v[224:239], v[152:155], v[124:127], v[80:95]
    v_exp_f32 v33, v33
    v_exp_f32 v34, v34
    v_exp_f32 v35, v35
    buffer_load_dwordx4 v[168:171], v1, s[40:43], 0 offen offset:2560 sc1
    v_cvt_pk_bf16_f32 v32, v32, v33
    v_exp_f32 v36, v36
    v_exp_f32 v37, v37
    v_cvt_pk_bf16_f32 v33, v34, v35
    buffer_load_dwordx4 v[172:175], v1, s[40:43], 0 offen offset:3584 sc1
    v_exp_f32 v38, v38
    v_exp_f32 v39, v39
    v_cvt_pk_bf16_f32 v34, v36, v37
    v_exp_f32 v40, v40
    buffer_load_dword v249, v14, s[40:43], 0 offen offset:2304 sc1
    v_exp_f32 v41, v41
    v_cvt_pk_bf16_f32 v35, v38, v39
    v_exp_f32 v42, v42
    v_exp_f32 v43, v43
    buffer_load_dwordx4 v[160:163], v1, s[4:7], 0 offen offset:2560 sc1
    v_cvt_pk_bf16_f32 v36, v40, v41
    v_exp_f32 v44, v44
    v_exp_f32 v45, v45
    v_cvt_pk_bf16_f32 v37, v42, v43
    buffer_load_dwordx4 v[164:167], v1, s[4:7], 0 offen offset:3584 sc1
    s_waitcnt vmcnt(17)
    v_add3_u32 v252, v144, v145, s61
    v_add3_u32 v252, v146, v147, v252
    v_add3_u32 v252, v148, v149, v252
    v_add3_u32 v252, v150, v151, v252
    v_cmp_ne_u32 vcc, v252, v114
    v_exp_f32 v46, v46
    v_exp_f32 v47, v47
    v_cvt_pk_bf16_f32 v38, v44, v45
    v_cvt_pk_bf16_f32 v39, v46, v47
    buffer_load_dword v248, v14, s[4:7], 0 offen offset:2304 sc1
    s_barrier
    v_mov_b32 v2, 0
    ds_read_b32 v2, v2 offset:192
    v_exp_f32 v224, v224
    s_cbranch_vccnz L_rk2a
L_gk2a:
    v_mfma_f32_32x32x16_bf16 v[64:79], v[148:151], v[124:127], v[80:95]
    v_exp_f32 v225, v225
    v_exp_f32 v226, v226
    v_exp_f32 v227, v227
    v_cvt_pk_bf16_f32 v224, v224, v225
    v_mfma_f32_32x32x16_bf16 v[48:63], v[104:107], v[16:19], 0
    v_exp_f32 v228, v228
    v_exp_f32 v229, v229
    v_cvt_pk_bf16_f32 v225, v226, v227
    v_exp_f32 v230, v230
    v_exp_f32 v231, v231
    v_mfma_f32_16x16x32_bf16 v[112:115], v[116:119], v[16:19], 0
    v_cvt_pk_bf16_f32 v226, v228, v229
    v_exp_f32 v232, v232
    v_exp_f32 v233, v233
    v_mfma_f32_32x32x16_bf16 v[192:207], v[104:107], v[20:23], 0
    v_cvt_pk_bf16_f32 v227, v230, v231
    v_exp_f32 v234, v234
    v_exp_f32 v235, v235
    v_cvt_pk_bf16_f32 v228, v232, v233
    v_exp_f32 v236, v236
    v_mfma_f32_16x16x32_bf16 v[112:115], v[116:119], v[20:23], v[112:115]
    v_exp_f32 v237, v237
    v_cvt_pk_bf16_f32 v229, v234, v235
    v_exp_f32 v238, v238
    v_exp_f32 v239, v239
    v_cvt_pk_bf16_f32 v230, v236, v237
    v_cvt_pk_bf16_f32 v231, v238, v239
    v_exp_f32 v64, v64
    s_waitcnt vmcnt(15)
    v_add3_u32 v252, v184, v185, s62
    v_add3_u32 v252, v186, v187, v252
    v_add3_u32 v252, v188, v189, v252
    v_add3_u32 v252, v190, v191, v252
    v_cmp_ne_u32 vcc, v252, v251
    v_mfma_f32_32x32x16_bf16 v[16:31], v[144:147], v[124:127], v[80:95]
    v_exp_f32 v65, v65
    v_exp_f32 v66, v66
    v_exp_f32 v67, v67
    v_cvt_pk_bf16_f32 v64, v64, v65
    s_cbranch_vccnz L_rv3a
L_gv3a:
    v_mfma_f32_32x32x16_bf16 v[48:63], v[188:191], v[32:35], v[48:63]
    v_exp_f32 v68, v68
    v_exp_f32 v69, v69
    v_cvt_pk_bf16_f32 v65, v66, v67
    v_exp_f32 v70, v70
    v_exp_f32 v71, v71
    v_mfma_f32_16x16x32_bf16 v[112:115], v[220:223], v[32:35], v[112:115]
    v_cvt_pk_bf16_f32 v66, v68, v69
    v_exp_f32 v72, v72
    v_exp_f32 v73, v73
    v_mfma_f32_32x32x16_bf16 v[192:207], v[188:191], v[36:39], v[192:207]
    v_cvt_pk_bf16_f32 v67, v70, v71
    v_exp_f32 v74, v74
    v_exp_f32 v75, v75
    v_cvt_pk_bf16_f32 v68, v72, v73
    v_exp_f32 v76, v76
    v_mfma_f32_16x16x32_bf16 v[112:115], v[220:223], v[36:39], v[112:115]
    v_exp_f32 v77, v77
    v_cvt_pk_bf16_f32 v69, v74, v75
    s_waitcnt vmcnt(12)
    v_add3_u32 v252, v136, v137, s60
    v_add3_u32 v252, v138, v139, v252
    v_add3_u32 v252, v140, v141, v252
    v_add3_u32 v252, v142, v143, v252
    v_cmp_ne_u32 vcc, v252, v253
    v_exp_f32 v78, v78
    v_exp_f32 v79, v79
    v_cvt_pk_bf16_f32 v70, v76, v77
    v_cvt_pk_bf16_f32 v71, v78, v79
    v_exp_f32 v16, v16
    s_cbranch_vccnz L_rk1a
L_gk1a:
    v_mfma_f32_32x32x16_bf16 v[32:47], v[140:143], v[124:127], v[80:95]
    v_exp_f32 v17, v17
    v_exp_f32 v18, v18
    v_exp_f32 v19, v19
    v_mfma_f32_32x32x16_bf16 v[48:63], v[184:187], v[224:227], v[48:63]
    v_cvt_pk_bf16_f32 v16, v16, v17
    v_exp_f32 v20, v20
    v_exp_f32 v21, v21
    v_mfma_f32_16x16x32_bf16 v[112:115], v[220:223], v[224:227], v[112:115]
    v_cvt_pk_bf16_f32 v17, v18, v19
    v_exp_f32 v22, v22
    v_mfma_f32_32x32x16_bf16 v[192:207], v[184:187], v[228:231], v[192:207]
    v_exp_f32 v23, v23
    s_waitcnt vmcnt(9)
    v_add3_u32 v252, v176, v177, s61
    v_add3_u32 v252, v178, v179, v252
    v_add3_u32 v252, v180, v181, v252
    v_add3_u32 v252, v182, v183, v252
    v_cmp_ne_u32 vcc, v252, v250
    v_cvt_pk_bf16_f32 v18, v20, v21
    v_exp_f32 v24, v24
    v_mfma_f32_16x16x32_bf16 v[112:115], v[220:223], v[228:231], v[112:115]
    v_exp_f32 v25, v25
    v_cvt_pk_bf16_f32 v19, v22, v23
    s_cbranch_vccnz L_rv2a
L_gv2a:
    v_mfma_f32_32x32x16_bf16 v[48:63], v[180:183], v[64:67], v[48:63]
    v_exp_f32 v26, v26
    v_exp_f32 v27, v27
    v_cvt_pk_bf16_f32 v20, v24, v25
    v_mfma_f32_16x16x32_bf16 v[112:115], v[216:219], v[64:67], v[112:115]
    v_exp_f32 v28, v28
    v_exp_f32 v29, v29
    v_mfma_f32_32x32x16_bf16 v[192:207], v[180:183], v[68:71], v[192:207]
    v_cvt_pk_bf16_f32 v21, v26, v27
    v_exp_f32 v30, v30
    v_exp_f32 v31, v31
    v_mfma_f32_16x16x32_bf16 v[112:115], v[216:219], v[68:71], v[112:115]
    v_cvt_pk_bf16_f32 v22, v28, v29
    v_cvt_pk_bf16_f32 v23, v30, v31
    v_exp_f32 v32, v32
    s_waitcnt vmcnt(6)
    v_add3_u32 v252, v128, v129, s59
    v_add3_u32 v252, v130, v131, v252
    v_add3_u32 v252, v132, v133, v252
    v_add3_u32 v252, v134, v135, v252
    v_cmp_ne_u32 vcc, v252, v254
    v_mfma_f32_32x32x16_bf16 v[224:239], v[100:103], v[124:127], v[80:95]
    v_exp_f32 v33, v33
    v_exp_f32 v34, v34
    v_exp_f32 v35, v35
    v_cvt_pk_bf16_f32 v32, v32, v33
    s_cbranch_vccnz L_rk0a
L_gk0a:
    v_mfma_f32_32x32x16_bf16 v[64:79], v[132:135], v[124:127], v[80:95]
    v_exp_f32 v36, v36
    v_exp_f32 v37, v37
    s_waitcnt lgkmcnt(0)
    v_readfirstlane_b32 s39, v2
    v_cvt_pk_bf16_f32 v33, v34, v35
    v_exp_f32 v38, v38
    v_exp_f32 v39, v39
    v_mfma_f32_32x32x16_bf16 v[48:63], v[176:179], v[16:19], v[48:63]
    v_cvt_pk_bf16_f32 v34, v36, v37
    v_exp_f32 v40, v40
    v_exp_f32 v41, v41
    v_cvt_pk_bf16_f32 v35, v38, v39
    v_mfma_f32_16x16x32_bf16 v[112:115], v[216:219], v[16:19], v[112:115]
    v_exp_f32 v42, v42
    v_exp_f32 v43, v43
    v_cvt_pk_bf16_f32 v36, v40, v41
    v_mfma_f32_32x32x16_bf16 v[192:207], v[176:179], v[20:23], v[192:207]
    v_exp_f32 v44, v44
    v_exp_f32 v45, v45
    v_cvt_pk_bf16_f32 v37, v42, v43
    v_exp_f32 v46, v46
    s_waitcnt vmcnt(3)
    v_add3_u32 v252, v168, v169, s60
    v_add3_u32 v252, v170, v171, v252
    v_add3_u32 v252, v172, v173, v252
    v_add3_u32 v252, v174, v175, v252
    v_cmp_ne_u32 vcc, v252, v249
    v_mfma_f32_16x16x32_bf16 v[112:115], v[216:219], v[20:23], v[112:115]
    v_exp_f32 v47, v47
    v_cvt_pk_bf16_f32 v38, v44, v45
    v_cvt_pk_bf16_f32 v39, v46, v47
    v_cndmask_b32 v224, v64, v224, s[64:65]
    s_cbranch_vccnz L_rv1a
L_gv1a:
    v_mfma_f32_32x32x16_bf16 v[48:63], v[172:175], v[32:35], v[48:63]
    v_cndmask_b32 v225, v65, v225, s[66:67]
    v_cndmask_b32 v226, v66, v226, s[68:69]
    v_cndmask_b32 v227, v67, v227, s[70:71]
    v_cndmask_b32 v228, v68, v228, s[82:83]
    v_cndmask_b32 v229, v69, v229, s[84:85]
    v_cndmask_b32 v230, v70, v230, s[86:87]
    v_cndmask_b32 v231, v71, v231, s[88:89]
    v_cndmask_b32 v232, v72, v232, s[90:91]
    v_cndmask_b32 v233, v73, v233, s[92:93]
    v_mfma_f32_16x16x32_bf16 v[112:115], v[212:215], v[32:35], v[112:115]
    v_cndmask_b32 v234, v74, v234, s[94:95]
    v_cndmask_b32 v235, v75, v235, s[8:9]
    v_cndmask_b32 v236, v76, v236, s[10:11]
    v_cndmask_b32 v237, v77, v237, s[12:13]
    v_cndmask_b32 v238, v78, v238, s[14:15]
    v_mfma_f32_32x32x16_bf16 v[192:207], v[172:175], v[36:39], v[192:207]
    v_cndmask_b32 v239, v79, v239, s[16:17]
    v_exp_f32 v224, v224
    v_exp_f32 v225, v225
    v_exp_f32 v226, v226
    v_exp_f32 v227, v227
    v_cvt_pk_bf16_f32 v224, v224, v225
    v_exp_f32 v228, v228
    v_exp_f32 v229, v229
    v_cvt_pk_bf16_f32 v225, v226, v227
    v_mfma_f32_16x16x32_bf16 v[112:115], v[212:215], v[36:39], v[112:115]
    v_exp_f32 v230, v230
    v_exp_f32 v231, v231
    v_cvt_pk_bf16_f32 v226, v228, v229
    v_exp_f32 v232, v232
    v_exp_f32 v233, v233
    v_cvt_pk_bf16_f32 v227, v230, v231
    v_mfma_f32_32x32x16_bf16 v[16:31], v[136:139], v[124:127], v[80:95]
    v_exp_f32 v234, v234
    v_exp_f32 v235, v235
    v_cvt_pk_bf16_f32 v228, v232, v233
    v_exp_f32 v236, v236
    v_exp_f32 v237, v237
    v_cvt_pk_bf16_f32 v229, v234, v235
    v_exp_f32 v238, v238
    v_exp_f32 v239, v239
    v_cvt_pk_bf16_f32 v230, v236, v237
    v_cvt_pk_bf16_f32 v231, v238, v239
    v_bfi_b32 v232, v240, 0, v224
    v_bfi_b32 v233, v241, 0, v225
    v_bfi_b32 v234, v242, 0, v226
    v_bfi_b32 v235, v243, 0, v227
    v_bfi_b32 v236, v244, 0, v228
    v_bfi_b32 v237, v245, 0, v229
    v_bfi_b32 v238, v246, 0, v230
    v_bfi_b32 v239, v247, 0, v231
    v_and_b32 v224, v240, v224
    v_and_b32 v225, v241, v225
    v_and_b32 v226, v242, v226
    v_and_b32 v227, v243, v227
    v_and_b32 v228, v244, v228
    v_and_b32 v229, v245, v229
    v_and_b32 v230, v246, v230
    v_and_b32 v231, v247, v231
    v_exp_f32 v16, v16
    v_mov_b64 v[80:81], v[8:9]
    v_mfma_f32_32x32x16_bf16 v[48:63], v[108:111], v[224:227], v[48:63]
    v_exp_f32 v17, v17
    v_mov_b64 v[82:83], v[8:9]
    v_exp_f32 v18, v18
    v_mov_b64 v[84:85], v[8:9]
    s_addk_i32 s18, 8192
    buffer_store_dword v12, v13, s[44:47], s18 offen sc1
    v_mfma_f32_16x16x32_bf16 v[112:115], v[116:119], v[224:227], v[112:115]
    v_exp_f32 v19, v19
    v_mov_b64 v[86:87], v[8:9]
    v_cvt_pk_bf16_f32 v16, v16, v17
    v_mov_b64 v[88:89], v[8:9]
    v_mfma_f32_32x32x16_bf16 v[192:207], v[108:111], v[228:231], v[192:207]
    v_exp_f32 v20, v20
    v_mov_b64 v[90:91], v[8:9]
    v_exp_f32 v21, v21
    s_waitcnt vmcnt(1)
    v_add3_u32 v252, v160, v161, s59
    v_add3_u32 v252, v162, v163, v252
    v_add3_u32 v252, v164, v165, v252
    v_add3_u32 v252, v166, v167, v252
    v_cmp_ne_u32 vcc, v252, v248
    v_mov_b64 v[92:93], v[8:9]
    v_mfma_f32_16x16x32_bf16 v[112:115], v[116:119], v[228:231], v[112:115]
    v_cvt_pk_bf16_f32 v17, v18, v19
    v_mov_b64 v[94:95], v[8:9]
    v_exp_f32 v22, v22
    s_cbranch_vccnz L_rv0a
L_gv0a:
    v_mfma_f32_32x32x16_bf16 v[48:63], v[164:167], v[232:235], v[48:63]
    v_exp_f32 v23, v23
    v_cvt_pk_bf16_f32 v18, v20, v21
    v_mfma_f32_16x16x32_bf16 v[112:115], v[208:211], v[232:235], v[112:115]
    v_exp_f32 v24, v24
    v_exp_f32 v25, v25
    v_mfma_f32_32x32x16_bf16 v[64:79], v[156:159], v[120:123], v[80:95]
    v_cvt_pk_bf16_f32 v19, v22, v23
    v_exp_f32 v26, v26
    v_mfma_f32_32x32x16_bf16 v[192:207], v[164:167], v[236:239], v[192:207]
    v_exp_f32 v27, v27
    v_cvt_pk_bf16_f32 v20, v24, v25
    v_exp_f32 v28, v28
    v_mfma_f32_16x16x32_bf16 v[112:115], v[208:211], v[236:239], v[112:115]
    v_exp_f32 v29, v29
    v_mfma_f32_32x32x16_bf16 v[48:63], v[168:171], v[16:19], v[48:63]
    v_cvt_pk_bf16_f32 v21, v26, v27
    v_exp_f32 v30, v30
    v_exp_f32 v31, v31
    v_mfma_f32_16x16x32_bf16 v[112:115], v[212:215], v[16:19], v[112:115]
    v_cvt_pk_bf16_f32 v22, v28, v29
    v_cvt_pk_bf16_f32 v23, v30, v31
    s_nop 1
    v_mfma_f32_16x16x32_bf16 v[112:115], v[212:215], v[20:23], v[112:115]
    v_mfma_f32_32x32x16_bf16 v[192:207], v[168:171], v[20:23], v[192:207]
    v_exp_f32 v64, v64
    v_exp_f32 v65, v65
    v_exp_f32 v66, v66
    v_exp_f32 v67, v67
    v_cvt_pk_bf16_f32 v64, v64, v65
    v_exp_f32 v68, v68
    s_nop 0
    v_cmp_ngt_f32 vcc, s32, v112
    s_mov_b32 s33, 0
    v_exp_f32 v69, v69
    v_mfma_f32_32x32x16_bf16 v[32:47], v[96:99], v[120:123], v[80:95]
    v_cvt_pk_bf16_f32 v65, v66, v67
    v_exp_f32 v70, v70
    v_exp_f32 v71, v71
    v_rcp_f32 v56, v112
    s_add_u32 s57, s81, 32768
    s_add_u32 s58, s19, 8192
    v_pk_add_f32 v[48:49], v[48:49], v[200:201]
    v_pk_add_f32 v[50:51], v[50:51], v[202:203]
    v_pk_add_f32 v[52:53], v[52:53], v[204:205]
    v_pk_add_f32 v[54:55], v[54:55], v[206:207]
    v_pk_mul_f32 v[48:49], v[48:49], v[56:57] op_sel_hi:[1,0]
    v_pk_mul_f32 v[50:51], v[50:51], v[56:57] op_sel_hi:[1,0]
    v_pk_mul_f32 v[52:53], v[52:53], v[56:57] op_sel_hi:[1,0]
    v_pk_mul_f32 v[54:55], v[54:55], v[56:57] op_sel_hi:[1,0]
    v_cvt_pk_bf16_f32 v60, v48, v49
    v_cvt_pk_bf16_f32 v61, v50, v51
    v_cvt_pk_bf16_f32 v62, v52, v53
    v_cvt_pk_bf16_f32 v63, v54, v55
    s_cbranch_vccnz L_exact
    buffer_store_dwordx4 v[60:63], v1, s[44:47], s57 offen sc1
    v_cvt_pk_bf16_f32 v66, v68, v69
    v_mfma_f32_32x32x16_bf16 v[224:239], v[128:131], v[120:123], v[80:95]
    v_exp_f32 v72, v72
    v_exp_f32 v73, v73
    v_cvt_pk_bf16_f32 v67, v70, v71
    v_exp_f32 v74, v74
    v_exp_f32 v75, v75
    v_add3_u32 v56, v60, v61, s56
    v_add3_u32 v56, v62, v63, v56
    buffer_store_dword v56, v14, s[44:47], s58 offen sc1
    v_cvt_pk_bf16_f32 v68, v72, v73
    v_exp_f32 v76, v76
    v_exp_f32 v77, v77
    v_cvt_pk_bf16_f32 v69, v74, v75
    v_exp_f32 v78, v78
    v_exp_f32 v79, v79
    v_cvt_pk_bf16_f32 v70, v76, v77
    v_cvt_pk_bf16_f32 v71, v78, v79
    v_cndmask_b32 v32, v224, v32, s[64:65]
    v_mfma_f32_32x32x16_bf16 v[48:63], v[188:191], v[64:67], 0
    v_cndmask_b32 v33, v225, v33, s[66:67]
    v_cndmask_b32 v34, v226, v34, s[68:69]
    v_cndmask_b32 v35, v227, v35, s[70:71]
    v_cndmask_b32 v36, v228, v36, s[82:83]
    v_cndmask_b32 v37, v229, v37, s[84:85]
    v_cndmask_b32 v38, v230, v38, s[86:87]
    v_cndmask_b32 v39, v231, v39, s[88:89]
    v_cndmask_b32 v40, v232, v40, s[90:91]
    v_cndmask_b32 v41, v233, v41, s[92:93]
    v_mfma_f32_16x16x32_bf16 v[112:115], v[220:223], v[64:67], 0
    v_cndmask_b32 v42, v234, v42, s[94:95]
    v_cndmask_b32 v43, v235, v43, s[8:9]
    v_cndmask_b32 v44, v236, v44, s[10:11]
    v_cndmask_b32 v45, v237, v45, s[12:13]
    v_cndmask_b32 v46, v238, v46, s[14:15]
    v_mfma_f32_32x32x16_bf16 v[192:207], v[188:191], v[68:71], 0
    v_cndmask_b32 v47, v239, v47, s[16:17]
    v_exp_f32 v32, v32
    v_exp_f32 v33, v33
    v_exp_f32 v34, v34
    v_exp_f32 v35, v35
    v_cvt_pk_bf16_f32 v32, v32, v33
    v_exp_f32 v36, v36
    v_exp_f32 v37, v37
    v_cvt_pk_bf16_f32 v33, v34, v35
    v_mfma_f32_16x16x32_bf16 v[112:115], v[220:223], v[68:71], v[112:115]
    v_exp_f32 v38, v38
    v_exp_f32 v39, v39
    v_cvt_pk_bf16_f32 v34, v36, v37
    v_exp_f32 v40, v40
    v_exp_f32 v41, v41
    v_cvt_pk_bf16_f32 v35, v38, v39
    v_mfma_f32_32x32x16_bf16 v[16:31], v[152:155], v[120:123], v[80:95]
    v_exp_f32 v42, v42
    v_exp_f32 v43, v43
    v_cvt_pk_bf16_f32 v36, v40, v41
    v_exp_f32 v44, v44
    v_exp_f32 v45, v45
    v_cvt_pk_bf16_f32 v37, v42, v43
    v_exp_f32 v46, v46
    v_exp_f32 v47, v47
    v_cvt_pk_bf16_f32 v38, v44, v45
    v_cvt_pk_bf16_f32 v39, v46, v47
    v_bfi_b32 v40, v240, 0, v32
    v_bfi_b32 v41, v241, 0, v33
    v_bfi_b32 v42, v242, 0, v34
    v_bfi_b32 v43, v243, 0, v35
    v_bfi_b32 v44, v244, 0, v36
    v_bfi_b32 v45, v245, 0, v37
    v_bfi_b32 v46, v246, 0, v38
    v_bfi_b32 v47, v247, 0, v39
    v_and_b32 v32, v240, v32
    v_and_b32 v33, v241, v33
    v_and_b32 v34, v242, v34
    v_and_b32 v35, v243, v35
    v_and_b32 v36, v244, v36
    v_and_b32 v37, v245, v37
    v_and_b32 v38, v246, v38
    v_and_b32 v39, v247, v39
    v_exp_f32 v16, v16
    v_mfma_f32_32x32x16_bf16 v[224:239], v[148:151], v[120:123], v[80:95]
    v_exp_f32 v17, v17
    v_exp_f32 v18, v18
    v_exp_f32 v19, v19
    v_cvt_pk_bf16_f32 v16, v16, v17
    v_mfma_f32_32x32x16_bf16 v[48:63], v[104:107], v[32:35], v[48:63]
    v_exp_f32 v20, v20
    v_exp_f32 v21, v21
    v_cvt_pk_bf16_f32 v17, v18, v19
    v_exp_f32 v22, v22
    v_exp_f32 v23, v23
    v_mfma_f32_16x16x32_bf16 v[112:115], v[116:119], v[32:35], v[112:115]
    v_cvt_pk_bf16_f32 v18, v20, v21
    v_exp_f32 v24, v24
    v_exp_f32 v25, v25
    v_mfma_f32_32x32x16_bf16 v[192:207], v[104:107], v[36:39], v[192:207]
    v_cvt_pk_bf16_f32 v19, v22, v23
    v_exp_f32 v26, v26
    v_exp_f32 v27, v27
    v_cvt_pk_bf16_f32 v20, v24, v25
    v_exp_f32 v28, v28
    v_mfma_f32_16x16x32_bf16 v[112:115], v[116:119], v[36:39], v[112:115]
    v_exp_f32 v29, v29
    v_cvt_pk_bf16_f32 v21, v26, v27
    v_exp_f32 v30, v30
    v_exp_f32 v31, v31
    v_cvt_pk_bf16_f32 v22, v28, v29
    v_cvt_pk_bf16_f32 v23, v30, v31
    v_exp_f32 v224, v224
    v_mfma_f32_32x32x16_bf16 v[64:79], v[144:147], v[120:123], v[80:95]
    v_exp_f32 v225, v225
    v_exp_f32 v226, v226
    v_exp_f32 v227, v227
    v_cvt_pk_bf16_f32 v224, v224, v225
    v_mfma_f32_32x32x16_bf16 v[48:63], v[184:187], v[16:19], v[48:63]
    v_exp_f32 v228, v228
    v_exp_f32 v229, v229
    v_cvt_pk_bf16_f32 v225, v226, v227
    v_exp_f32 v230, v230
    v_mfma_f32_16x16x32_bf16 v[112:115], v[220:223], v[16:19], v[112:115]
    v_exp_f32 v231, v231
    v_cvt_pk_bf16_f32 v226, v228, v229
    v_mfma_f32_32x32x16_bf16 v[192:207], v[184:187], v[20:23], v[192:207]
    v_exp_f32 v232, v232
    v_exp_f32 v233, v233
    v_cvt_pk_bf16_f32 v227, v230, v231
    v_exp_f32 v234, v234
    v_mfma_f32_16x16x32_bf16 v[112:115], v[220:223], v[20:23], v[112:115]
    v_exp_f32 v235, v235
    v_cvt_pk_bf16_f32 v228, v232, v233
    v_mfma_f32_32x32x16_bf16 v[48:63], v[160:163], v[40:43], v[48:63]
    v_exp_f32 v236, v236
    v_exp_f32 v237, v237
    v_cvt_pk_bf16_f32 v229, v234, v235
    v_exp_f32 v238, v238
    v_mfma_f32_16x16x32_bf16 v[112:115], v[208:211], v[40:43], v[112:115]
    v_exp_f32 v239, v239
    v_cvt_pk_bf16_f32 v230, v236, v237
    v_cvt_pk_bf16_f32 v231, v238, v239
    v_exp_f32 v64, v64
    v_mfma_f32_32x32x16_bf16 v[16:31], v[140:143], v[120:123], v[80:95]
    v_exp_f32 v65, v65
    v_exp_f32 v66, v66
    v_exp_f32 v67, v67
    v_cvt_pk_bf16_f32 v64, v64, v65
    v_mfma_f32_32x32x16_bf16 v[48:63], v[180:183], v[224:227], v[48:63]
    v_exp_f32 v68, v68
    v_exp_f32 v69, v69
    v_cvt_pk_bf16_f32 v65, v66, v67
    v_exp_f32 v70, v70
    v_mfma_f32_16x16x32_bf16 v[112:115], v[216:219], v[224:227], v[112:115]
    v_exp_f32 v71, v71
    v_cvt_pk_bf16_f32 v66, v68, v69
    v_mfma_f32_32x32x16_bf16 v[192:207], v[180:183], v[228:231], v[192:207]
    v_exp_f32 v72, v72
    v_exp_f32 v73, v73
    v_cvt_pk_bf16_f32 v67, v70, v71
    v_exp_f32 v74, v74
    v_mfma_f32_16x16x32_bf16 v[112:115], v[216:219], v[228:231], v[112:115]
    v_exp_f32 v75, v75
    v_cvt_pk_bf16_f32 v68, v72, v73
    v_mfma_f32_32x32x16_bf16 v[192:207], v[160:163], v[44:47], v[192:207]
    v_exp_f32 v76, v76
    v_exp_f32 v77, v77
    v_cvt_pk_bf16_f32 v69, v74, v75
    v_exp_f32 v78, v78
    v_mfma_f32_16x16x32_bf16 v[112:115], v[208:211], v[44:47], v[112:115]
    v_exp_f32 v79, v79
    v_cvt_pk_bf16_f32 v70, v76, v77
    v_cvt_pk_bf16_f32 v71, v78, v79
    v_exp_f32 v16, v16
    v_mfma_f32_32x32x16_bf16 v[224:239], v[136:139], v[120:123], v[80:95]
    v_exp_f32 v17, v17
    v_exp_f32 v18, v18
    v_exp_f32 v19, v19
    v_cvt_pk_bf16_f32 v16, v16, v17
    v_mfma_f32_32x32x16_bf16 v[48:63], v[176:179], v[64:67], v[48:63]
    v_exp_f32 v20, v20
    v_exp_f32 v21, v21
    v_cvt_pk_bf16_f32 v17, v18, v19
    v_exp_f32 v22, v22
    v_exp_f32 v23, v23
    v_mfma_f32_16x16x32_bf16 v[112:115], v[216:219], v[64:67], v[112:115]
    v_cvt_pk_bf16_f32 v18, v20, v21
    v_exp_f32 v24, v24
    v_exp_f32 v25, v25
    v_mfma_f32_32x32x16_bf16 v[192:207], v[176:179], v[68:71], v[192:207]
    v_cvt_pk_bf16_f32 v19, v22, v23
    v_exp_f32 v26, v26
    v_exp_f32 v27, v27
    v_cvt_pk_bf16_f32 v20, v24, v25
    v_exp_f32 v28, v28
    v_mfma_f32_16x16x32_bf16 v[112:115], v[216:219], v[68:71], v[112:115]
    v_exp_f32 v29, v29
    v_cvt_pk_bf16_f32 v21, v26, v27
    v_exp_f32 v30, v30
    v_exp_f32 v31, v31
    v_cvt_pk_bf16_f32 v22, v28, v29
    v_cvt_pk_bf16_f32 v23, v30, v31
    v_exp_f32 v224, v224
    v_mfma_f32_32x32x16_bf16 v[32:47], v[132:135], v[120:123], v[80:95]
    v_exp_f32 v225, v225
    v_exp_f32 v226, v226
    v_exp_f32 v227, v227
    v_cvt_pk_bf16_f32 v224, v224, v225
    v_mfma_f32_32x32x16_bf16 v[48:63], v[172:175], v[16:19], v[48:63]
    v_exp_f32 v228, v228
    v_exp_f32 v229, v229
    v_cvt_pk_bf16_f32 v225, v226, v227
    v_exp_f32 v230, v230
    v_exp_f32 v231, v231
    v_mfma_f32_16x16x32_bf16 v[112:115], v[212:215], v[16:19], v[112:115]
    v_cvt_pk_bf16_f32 v226, v228, v229
    v_exp_f32 v232, v232
    v_exp_f32 v233, v233
    v_mfma_f32_32x32x16_bf16 v[192:207], v[172:175], v[20:23], v[192:207]
    v_cvt_pk_bf16_f32 v227, v230, v231
    v_exp_f32 v234, v234
    v_exp_f32 v235, v235
    v_cvt_pk_bf16_f32 v228, v232, v233
    v_exp_f32 v236, v236
    v_mfma_f32_16x16x32_bf16 v[112:115], v[212:215], v[20:23], v[112:115]
    v_exp_f32 v237, v237
    v_cvt_pk_bf16_f32 v229, v234, v235
    v_exp_f32 v238, v238
    v_exp_f32 v239, v239
    v_cvt_pk_bf16_f32 v230, v236, v237
    v_cvt_pk_bf16_f32 v231, v238, v239
    v_exp_f32 v32, v32
    v_mfma_f32_32x32x16_bf16 v[48:63], v[168:171], v[224:227], v[48:63]
    v_exp_f32 v33, v33
    v_exp_f32 v34, v34
    v_exp_f32 v35, v35
    v_cvt_pk_bf16_f32 v32, v32, v33
    v_mfma_f32_16x16x32_bf16 v[112:115], v[212:215], v[224:227], v[112:115]
    v_exp_f32 v36, v36
    v_exp_f32 v37, v37
    v_cvt_pk_bf16_f32 v33, v34, v35
    v_mfma_f32_32x32x16_bf16 v[192:207], v[168:171], v[228:231], v[192:207]
    v_exp_f32 v38, v38
    v_exp_f32 v39, v39
    v_cvt_pk_bf16_f32 v34, v36, v37
    v_exp_f32 v40, v40
    v_exp_f32 v41, v41
    v_mfma_f32_16x16x32_bf16 v[112:115], v[212:215], v[228:231], v[112:115]
    v_cvt_pk_bf16_f32 v35, v38, v39
    v_exp_f32 v42, v42
    s_nop 0
    v_mfma_f32_32x32x16_bf16 v[48:63], v[164:167], v[32:35], v[48:63]
    v_exp_f32 v43, v43
    v_cvt_pk_bf16_f32 v36, v40, v41
    v_exp_f32 v44, v44
    v_exp_f32 v45, v45
    v_cvt_pk_bf16_f32 v37, v42, v43
    v_mfma_f32_16x16x32_bf16 v[112:115], v[208:211], v[32:35], v[112:115]
    v_exp_f32 v46, v46
    v_exp_f32 v47, v47
    v_cvt_pk_bf16_f32 v38, v44, v45
    v_cvt_pk_bf16_f32 v39, v46, v47
    s_nop 1
    v_mfma_f32_16x16x32_bf16 v[112:115], v[208:211], v[36:39], v[112:115]
    v_mfma_f32_32x32x16_bf16 v[192:207], v[164:167], v[36:39], v[192:207]
    s_bfe_u32 s35, s2, 0x30003
    s_lshr_b32 s57, s2, 6
    s_lshl2_add_u32 s35, s35, s57
    s_and_b32 s38, s2, 7
    s_mul_i32 s38, s38, 14
    s_add_u32 s38, s38, s35
    v_lshrrev_b32 v2, 1, v4
    v_mul_u32_u24 v7, 3584, v2
    v_and_b32 v2, 1, v4
    v_lshl_add_u32 v7, v2, 4, v7
    v_cmp_ngt_f32 vcc, s32, v112
    s_mov_b32 s33, 1
    v_rcp_f32 v56, v112
    s_add_u32 s57, s81, 0
    s_add_u32 s58, s101, 0
    s_add_u32 s57, s57, s39
    s_add_u32 s58, s58, s39
    s_cbranch_vccnz L_exact
    v_pk_add_f32 v[48:49], v[48:49], v[200:201]
    v_pk_add_f32 v[50:51], v[50:51], v[202:203]
    v_pk_add_f32 v[52:53], v[52:53], v[204:205]
    v_pk_add_f32 v[54:55], v[54:55], v[206:207]
    v_pk_mul_f32 v[48:49], v[48:49], v[56:57] op_sel_hi:[1,0]
    v_pk_mul_f32 v[50:51], v[50:51], v[56:57] op_sel_hi:[1,0]
    v_pk_mul_f32 v[52:53], v[52:53], v[56:57] op_sel_hi:[1,0]
    v_pk_mul_f32 v[54:55], v[54:55], v[56:57] op_sel_hi:[1,0]
    v_cvt_pk_bf16_f32 v60, v48, v49
    v_cvt_pk_bf16_f32 v61, v50, v51
    v_cvt_pk_bf16_f32 v62, v52, v53
    v_cvt_pk_bf16_f32 v63, v54, v55
    s_branch L_p2e
L_p2b:
    s_nop 1
    v_mov_b64 v[80:81], v[8:9]
    v_mov_b64 v[82:83], v[8:9]
    v_mov_b64 v[84:85], v[8:9]
    s_waitcnt vmcnt(7)
    v_add3_u32 v252, v152, v153, s62
    v_add3_u32 v252, v154, v155, v252
    v_add3_u32 v252, v156, v157, v252
    v_add3_u32 v252, v158, v159, v252
    s_waitcnt vmcnt(6)
    v_cmp_ne_u32 vcc, v252, v115
    v_mov_b64 v[86:87], v[8:9]
    v_mov_b64 v[88:89], v[8:9]
    v_mov_b64 v[90:91], v[8:9]
    v_mov_b64 v[92:93], v[8:9]
    v_mov_b64 v[94:95], v[8:9]
    s_cbranch_vccnz L_rk3b
L_gk3b:
    s_nop 0
    v_mfma_f32_32x32x16_bf16 v[16:31], v[156:159], v[120:123], v[80:95]
    buffer_load_dwordx4 v[136:139], v1, s[40:43], 0 offen offset:0 sc1
    buffer_load_dwordx4 v[140:143], v1, s[40:43], 0 offen offset:1024 sc1
    buffer_load_dword v253, v14, s[40:43], 0 offen offset:2048 sc1
    s_nop 8
    v_exp_f32 v16, v16
    v_mfma_f32_32x32x16_bf16 v[32:47], v[152:155], v[120:123], v[80:95]
    v_exp_f32 v17, v17
    v_exp_f32 v18, v18
    v_exp_f32 v19, v19
    buffer_load_dwordx4 v[176:179], v1, s[72:75], 0 offen offset:2560 sc1
    v_cvt_pk_bf16_f32 v16, v16, v17
    v_exp_f32 v20, v20
    v_exp_f32 v21, v21
    v_cvt_pk_bf16_f32 v17, v18, v19
    buffer_load_dwordx4 v[180:183], v1, s[72:75], 0 offen offset:3584 sc1
    v_exp_f32 v22, v22
    v_exp_f32 v23, v23
    v_cvt_pk_bf16_f32 v18, v20, v21
    v_exp_f32 v24, v24
    buffer_load_dword v250, v14, s[72:75], 0 offen offset:2304 sc1
    v_exp_f32 v25, v25
    v_cvt_pk_bf16_f32 v19, v22, v23
    v_exp_f32 v26, v26
    v_exp_f32 v27, v27
    buffer_load_dwordx4 v[128:131], v1, s[4:7], 0 offen offset:0 sc1
    v_cvt_pk_bf16_f32 v20, v24, v25
    v_exp_f32 v28, v28
    v_exp_f32 v29, v29
    v_cvt_pk_bf16_f32 v21, v26, v27
    buffer_load_dwordx4 v[132:135], v1, s[4:7], 0 offen offset:1024 sc1
    s_waitcnt vmcnt(11)
    v_add3_u32 v252, v144, v145, s61
    v_add3_u32 v252, v146, v147, v252
    v_add3_u32 v252, v148, v149, v252
    v_add3_u32 v252, v150, v151, v252
    v_cmp_ne_u32 vcc, v252, v114
    v_exp_f32 v30, v30
    v_exp_f32 v31, v31
    v_cvt_pk_bf16_f32 v22, v28, v29
    v_cvt_pk_bf16_f32 v23, v30, v31
    buffer_load_dword v254, v14, s[4:7], 0 offen offset:2048 sc1
    v_exp_f32 v32, v32
    s_cbranch_vccnz L_rk2b
L_gk2b:
    v_mfma_f32_32x32x16_bf16 v[224:239], v[148:151], v[120:123], v[80:95]
    v_exp_f32 v33, v33
    v_exp_f32 v34, v34
    v_exp_f32 v35, v35
    buffer_load_dwordx4 v[168:171], v1, s[40:43], 0 offen offset:2560 sc1
    v_cvt_pk_bf16_f32 v32, v32, v33
    v_exp_f32 v36, v36
    v_exp_f32 v37, v37
    v_cvt_pk_bf16_f32 v33, v34, v35
    buffer_load_dwordx4 v[172:175], v1, s[40:43], 0 offen offset:3584 sc1
    v_exp_f32 v38, v38
    v_exp_f32 v39, v39
    v_cvt_pk_bf16_f32 v34, v36, v37
    v_exp_f32 v40, v40
    buffer_load_dword v249, v14, s[40:43], 0 offen offset:2304 sc1
    v_exp_f32 v41, v41
    v_cvt_pk_bf16_f32 v35, v38, v39
    v_exp_f32 v42, v42
    v_exp_f32 v43, v43
    buffer_load_dwordx4 v[160:163], v1, s[4:7], 0 offen offset:2560 sc1
    v_cvt_pk_bf16_f32 v36, v40, v41
    v_exp_f32 v44, v44
    v_exp_f32 v45, v45
    v_cvt_pk_bf16_f32 v37, v42, v43
    buffer_load_dwordx4 v[164:167], v1, s[4:7], 0 offen offset:3584 sc1
    v_exp_f32 v46, v46
    v_exp_f32 v47, v47
    v_cvt_pk_bf16_f32 v38, v44, v45
    v_cvt_pk_bf16_f32 v39, v46, v47
    buffer_load_dword v248, v14, s[4:7], 0 offen offset:2304 sc1
    s_barrier
    v_mov_b32 v2, 0
    ds_read_b32 v2, v2 offset:192
    v_exp_f32 v224, v224
    s_waitcnt vmcnt(15)
    v_add3_u32 v252, v184, v185, s62
    v_add3_u32 v252, v186, v187, v252
    v_add3_u32 v252, v188, v189, v252
    v_add3_u32 v252, v190, v191, v252
    v_cmp_ne_u32 vcc, v252, v251
    v_mfma_f32_32x32x16_bf16 v[64:79], v[144:147], v[120:123], v[80:95]
    v_exp_f32 v225, v225
    v_exp_f32 v226, v226
    v_exp_f32 v227, v227
    v_cvt_pk_bf16_f32 v224, v224, v225
    s_cbranch_vccnz L_rv3b
L_gv3b:
    v_mfma_f32_32x32x16_bf16 v[48:63], v[188:191], v[16:19], 0
    v_exp_f32 v228, v228
    v_exp_f32 v229, v229
    v_cvt_pk_bf16_f32 v225, v226, v227
    v_exp_f32 v230, v230
    v_exp_f32 v231, v231
    v_mfma_f32_16x16x32_bf16 v[112:115], v[220:223], v[16:19], 0
    v_cvt_pk_bf16_f32 v226, v228, v229
    v_exp_f32 v232, v232
    v_exp_f32 v233, v233
    v_mfma_f32_32x32x16_bf16 v[192:207], v[188:191], v[20:23], 0
    v_cvt_pk_bf16_f32 v227, v230, v231
    v_exp_f32 v234, v234
    v_exp_f32 v235, v235
    v_cvt_pk_bf16_f32 v228, v232, v233
    v_exp_f32 v236, v236
    v_mfma_f32_16x16x32_bf16 v[112:115], v[220:223], v[20:23], v[112:115]
    v_exp_f32 v237, v237
    v_cvt_pk_bf16_f32 v229, v234, v235
    s_waitcnt vmcnt(12)
    v_add3_u32 v252, v136, v137, s60
    v_add3_u32 v252, v138, v139, v252
    v_add3_u32 v252, v140, v141, v252
    v_add3_u32 v252, v142, v143, v252
    v_cmp_ne_u32 vcc, v252, v253
    v_exp_f32 v238, v238
    v_exp_f32 v239, v239
    v_cvt_pk_bf16_f32 v230, v236, v237
    v_cvt_pk_bf16_f32 v231, v238, v239
    v_exp_f32 v64, v64
    s_cbranch_vccnz L_rk1b
L_gk1b:
    v_mfma_f32_32x32x16_bf16 v[16:31], v[140:143], v[120:123], v[80:95]
    v_exp_f32 v65, v65
    v_exp_f32 v66, v66
    v_exp_f32 v67, v67
    v_cvt_pk_bf16_f32 v64, v64, v65
    v_mfma_f32_32x32x16_bf16 v[48:63], v[184:187], v[32:35], v[48:63]
    v_exp_f32 v68, v68
    v_exp_f32 v69, v69
    v_cvt_pk_bf16_f32 v65, v66, v67
    v_exp_f32 v70, v70
    v_exp_f32 v71, v71
    v_mfma_f32_16x16x32_bf16 v[112:115], v[220:223], v[32:35], v[112:115]
    v_cvt_pk_bf16_f32 v66, v68, v69
    v_exp_f32 v72, v72
    v_exp_f32 v73, v73
    v_mfma_f32_32x32x16_bf16 v[192:207], v[184:187], v[36:39], v[192:207]
    v_cvt_pk_bf16_f32 v67, v70, v71
    v_exp_f32 v74, v74
    v_exp_f32 v75, v75
    v_cvt_pk_bf16_f32 v68, v72, v73
    v_exp_f32 v76, v76
    v_mfma_f32_16x16x32_bf16 v[112:115], v[220:223], v[36:39], v[112:115]
    v_exp_f32 v77, v77
    v_cvt_pk_bf16_f32 v69, v74, v75
    v_exp_f32 v78, v78
    v_exp_f32 v79, v79
    v_cvt_pk_bf16_f32 v70, v76, v77
    v_cvt_pk_bf16_f32 v71, v78, v79
    s_waitcnt vmcnt(9)
    v_add3_u32 v252, v176, v177, s61
    v_add3_u32 v252, v178, v179, v252
    v_add3_u32 v252, v180, v181, v252
    v_add3_u32 v252, v182, v183, v252
    v_cmp_ne_u32 vcc, v252, v250
    v_exp_f32 v16, v16
    v_mfma_f32_32x32x16_bf16 v[32:47], v[136:139], v[120:123], v[80:95]
    v_exp_f32 v17, v17
    v_exp_f32 v18, v18
    v_exp_f32 v19, v19
    s_cbranch_vccnz L_rv2b
L_gv2b:
    v_mfma_f32_32x32x16_bf16 v[48:63], v[180:183], v[224:227], v[48:63]
    v_cvt_pk_bf16_f32 v16, v16, v17
    v_exp_f32 v20, v20
    v_exp_f32 v21, v21
    v_mfma_f32_16x16x32_bf16 v[112:115], v[216:219], v[224:227], v[112:115]
    v_cvt_pk_bf16_f32 v17, v18, v19
    v_exp_f32 v22, v22
    v_mfma_f32_32x32x16_bf16 v[192:207], v[180:183], v[228:231], v[192:207]
    v_exp_f32 v23, v23
    v_cvt_pk_bf16_f32 v18, v20, v21
    v_exp_f32 v24, v24
    v_mfma_f32_16x16x32_bf16 v[112:115], v[216:219], v[228:231], v[112:115]
    v_exp_f32 v25, v25
    v_cvt_pk_bf16_f32 v19, v22, v23
    v_mfma_f32_32x32x16_bf16 v[48:63], v[176:179], v[64:67], v[48:63]
    v_exp_f32 v26, v26
    v_exp_f32 v27, v27
    v_cvt_pk_bf16_f32 v20, v24, v25
    v_mfma_f32_16x16x32_bf16 v[112:115], v[216:219], v[64:67], v[112:115]
    v_exp_f32 v28, v28
    v_exp_f32 v29, v29
    v_mfma_f32_32x32x16_bf16 v[192:207], v[176:179], v[68:71], v[192:207]
    v_cvt_pk_bf16_f32 v21, v26, v27
    v_exp_f32 v30, v30
    v_exp_f32 v31, v31
    v_mfma_f32_16x16x32_bf16 v[112:115], v[216:219], v[68:71], v[112:115]
    v_cvt_pk_bf16_f32 v22, v28, v29
    v_cvt_pk_bf16_f32 v23, v30, v31
    v_exp_f32 v32, v32
    s_waitcnt vmcnt(6)
    v_add3_u32 v252, v128, v129, s59
    v_add3_u32 v252, v130, v131, v252
    v_add3_u32 v252, v132, v133, v252
    v_add3_u32 v252, v134, v135, v252
    v_cmp_ne_u32 vcc, v252, v254
    v_mfma_f32_32x32x16_bf16 v[224:239], v[96:99], v[120:123], v[80:95]
    v_exp_f32 v33, v33
    v_exp_f32 v34, v34
    v_exp_f32 v35, v35
    v_cvt_pk_bf16_f32 v32, v32, v33
    s_cbranch_vccnz L_rk0b
L_gk0b:
    v_mfma_f32_32x32x16_bf16 v[64:79], v[128:131], v[120:123], v[80:95]
    v_exp_f32 v36, v36
    s_waitcnt vmcnt(3)
    v_add3_u32 v252, v168, v169, s60
    v_add3_u32 v252, v170, v171, v252
    v_add3_u32 v252, v172, v173, v252
    v_add3_u32 v252, v174, v175, v252
    v_cmp_ne_u32 vcc, v252, v249
    v_exp_f32 v37, v37
    s_waitcnt lgkmcnt(0)
    v_readfirstlane_b32 s39, v2
    v_cvt_pk_bf16_f32 v33, v34, v35
    v_exp_f32 v38, v38
    v_exp_f32 v39, v39
    s_cbranch_vccnz L_rv1b
L_gv1b:
    v_mfma_f32_32x32x16_bf16 v[48:63], v[172:175], v[16:19], v[48:63]
    v_cvt_pk_bf16_f32 v34, v36, v37
    v_exp_f32 v40, v40
    v_exp_f32 v41, v41
    v_cvt_pk_bf16_f32 v35, v38, v39
    v_mfma_f32_16x16x32_bf16 v[112:115], v[212:215], v[16:19], v[112:115]
    v_exp_f32 v42, v42
    v_exp_f32 v43, v43
    v_cvt_pk_bf16_f32 v36, v40, v41
    v_mfma_f32_32x32x16_bf16 v[192:207], v[172:175], v[20:23], v[192:207]
    v_exp_f32 v44, v44
    v_exp_f32 v45, v45
    v_cvt_pk_bf16_f32 v37, v42, v43
    v_exp_f32 v46, v46
    v_mfma_f32_16x16x32_bf16 v[112:115], v[212:215], v[20:23], v[112:115]
    v_exp_f32 v47, v47
    v_cvt_pk_bf16_f32 v38, v44, v45
    v_cvt_pk_bf16_f32 v39, v46, v47
    v_cndmask_b32 v224, v64, v224, s[64:65]
    v_mfma_f32_32x32x16_bf16 v[48:63], v[168:171], v[32:35], v[48:63]
    v_cndmask_b32 v225, v65, v225, s[66:67]
    v_cndmask_b32 v226, v66, v226, s[68:69]
    v_cndmask_b32 v227, v67, v227, s[70:71]
    v_cndmask_b32 v228, v68, v228, s[82:83]
    v_cndmask_b32 v229, v69, v229, s[84:85]
    v_cndmask_b32 v230, v70, v230, s[86:87]
    v_cndmask_b32 v231, v71, v231, s[88:89]
    v_cndmask_b32 v232, v72, v232, s[90:91]
    v_cndmask_b32 v233, v73, v233, s[92:93]
    v_mfma_f32_16x16x32_bf16 v[112:115], v[212:215], v[32:35], v[112:115]
    v_cndmask_b32 v234, v74, v234, s[94:95]
    v_cndmask_b32 v235, v75, v235, s[8:9]
    v_cndmask_b32 v236, v76, v236, s[10:11]
    v_cndmask_b32 v237, v77, v237, s[12:13]
    v_cndmask_b32 v238, v78, v238, s[14:15]
    v_mfma_f32_32x32x16_bf16 v[192:207], v[168:171], v[36:39], v[192:207]
    v_cndmask_b32 v239, v79, v239, s[16:17]
    v_exp_f32 v224, v224
    v_exp_f32 v225, v225
    v_exp_f32 v226, v226
    v_exp_f32 v227, v227
    v_cvt_pk_bf16_f32 v224, v224, v225
    v_exp_f32 v228, v228
    v_exp_f32 v229, v229
    v_cvt_pk_bf16_f32 v225, v226, v227
    v_mfma_f32_16x16x32_bf16 v[112:115], v[212:215], v[36:39], v[112:115]
    v_exp_f32 v230, v230
    v_exp_f32 v231, v231
    v_cvt_pk_bf16_f32 v226, v228, v229
    v_exp_f32 v232, v232
    v_exp_f32 v233, v233
    v_cvt_pk_bf16_f32 v227, v230, v231
    v_mfma_f32_32x32x16_bf16 v[16:31], v[132:135], v[120:123], v[80:95]
    v_exp_f32 v234, v234
    v_exp_f32 v235, v235
    v_cvt_pk_bf16_f32 v228, v232, v233
    v_exp_f32 v236, v236
    v_exp_f32 v237, v237
    v_cvt_pk_bf16_f32 v229, v234, v235
    v_exp_f32 v238, v238
    v_exp_f32 v239, v239
    v_cvt_pk_bf16_f32 v230, v236, v237
    v_cvt_pk_bf16_f32 v231, v238, v239
    v_bfi_b32 v232, v240, 0, v224
    v_bfi_b32 v233, v241, 0, v225
    v_bfi_b32 v234, v242, 0, v226
    v_bfi_b32 v235, v243, 0, v227
    v_bfi_b32 v236, v244, 0, v228
    v_bfi_b32 v237, v245, 0, v229
    v_bfi_b32 v238, v246, 0, v230
    v_bfi_b32 v239, v247, 0, v231
    v_and_b32 v224, v240, v224
    v_and_b32 v225, v241, v225
    v_and_b32 v226, v242, v226
    v_and_b32 v227, v243, v227
    v_and_b32 v228, v244, v228
    v_and_b32 v229, v245, v229
    v_and_b32 v230, v246, v230
    v_and_b32 v231, v247, v231
    v_exp_f32 v16, v16
    v_mov_b64 v[80:81], v[10:11]
    v_mfma_f32_32x32x16_bf16 v[48:63], v[104:107], v[224:227], v[48:63]
    v_exp_f32 v17, v17
    v_mov_b64 v[82:83], v[10:11]
    v_exp_f32 v18, v18
    v_mov_b64 v[84:85], v[10:11]
    s_addk_i32 s18, 0
    buffer_store_dword v12, v13, s[44:47], s18 offen sc1
    v_mfma_f32_16x16x32_bf16 v[112:115], v[116:119], v[224:227], v[112:115]
    v_exp_f32 v19, v19
    v_mov_b64 v[86:87], v[10:11]
    v_cvt_pk_bf16_f32 v16, v16, v17
    v_mov_b64 v[88:89], v[10:11]
    v_mfma_f32_32x32x16_bf16 v[192:207], v[104:107], v[228:231], v[192:207]
    v_exp_f32 v20, v20
    v_mov_b64 v[90:91], v[10:11]
    v_exp_f32 v21, v21
    s_waitcnt vmcnt(1)
    v_add3_u32 v252, v160, v161, s59
    v_add3_u32 v252, v162, v163, v252
    v_add3_u32 v252, v164, v165, v252
    v_add3_u32 v252, v166, v167, v252
    v_cmp_ne_u32 vcc, v252, v248
    v_mov_b64 v[92:93], v[10:11]
    v_mfma_f32_16x16x32_bf16 v[112:115], v[116:119], v[228:231], v[112:115]
    v_cvt_pk_bf16_f32 v17, v18, v19
    v_mov_b64 v[94:95], v[10:11]
    v_exp_f32 v22, v22
    s_cbranch_vccnz L_rv0b
L_gv0b:
    v_mfma_f32_32x32x16_bf16 v[48:63], v[160:163], v[232:235], v[48:63]
    v_exp_f32 v23, v23
    v_cvt_pk_bf16_f32 v18, v20, v21
    v_mfma_f32_16x16x32_bf16 v[112:115], v[208:211], v[232:235], v[112:115]
    v_exp_f32 v24, v24
    v_exp_f32 v25, v25
    v_mfma_f32_32x32x16_bf16 v[64:79], v[96:99], v[124:127], v[80:95]
    v_cvt_pk_bf16_f32 v19, v22, v23
    v_exp_f32 v26, v26
    v_mfma_f32_32x32x16_bf16 v[192:207], v[160:163], v[236:239], v[192:207]
    v_exp_f32 v27, v27
    v_cvt_pk_bf16_f32 v20, v24, v25
    v_exp_f32 v28, v28
    v_mfma_f32_16x16x32_bf16 v[112:115], v[208:211], v[236:239], v[112:115]
    v_exp_f32 v29, v29
    v_mfma_f32_32x32x16_bf16 v[48:63], v[164:167], v[16:19], v[48:63]
    v_cvt_pk_bf16_f32 v21, v26, v27
    v_exp_f32 v30, v30
    v_exp_f32 v31, v31
    v_mfma_f32_16x16x32_bf16 v[112:115], v[208:211], v[16:19], v[112:115]
    v_cvt_pk_bf16_f32 v22, v28, v29
    v_cvt_pk_bf16_f32 v23, v30, v31
    s_nop 1
    v_mfma_f32_16x16x32_bf16 v[112:115], v[208:211], v[20:23], v[112:115]
    v_mfma_f32_32x32x16_bf16 v[192:207], v[164:167], v[20:23], v[192:207]
    v_exp_f32 v64, v64
    v_exp_f32 v65, v65
    v_exp_f32 v66, v66
    v_exp_f32 v67, v67
    v_cvt_pk_bf16_f32 v64, v64, v65
    v_exp_f32 v68, v68
    s_nop 0
    v_cmp_ngt_f32 vcc, s32, v112
    s_mov_b32 s33, 0
    v_exp_f32 v69, v69
    v_mfma_f32_32x32x16_bf16 v[32:47], v[100:103], v[124:127], v[80:95]
    v_cvt_pk_bf16_f32 v65, v66, v67
    v_exp_f32 v70, v70
    v_exp_f32 v71, v71
    v_rcp_f32 v56, v112
    s_add_u32 s57, s81, 0
    s_add_u32 s58, s19, 0
    v_pk_add_f32 v[48:49], v[48:49], v[200:201]
    v_pk_add_f32 v[50:51], v[50:51], v[202:203]
    v_pk_add_f32 v[52:53], v[52:53], v[204:205]
    v_pk_add_f32 v[54:55], v[54:55], v[206:207]
    v_pk_mul_f32 v[48:49], v[48:49], v[56:57] op_sel_hi:[1,0]
    v_pk_mul_f32 v[50:51], v[50:51], v[56:57] op_sel_hi:[1,0]
    v_pk_mul_f32 v[52:53], v[52:53], v[56:57] op_sel_hi:[1,0]
    v_pk_mul_f32 v[54:55], v[54:55], v[56:57] op_sel_hi:[1,0]
    v_cvt_pk_bf16_f32 v60, v48, v49
    v_cvt_pk_bf16_f32 v61, v50, v51
    v_cvt_pk_bf16_f32 v62, v52, v53
    v_cvt_pk_bf16_f32 v63, v54, v55
    s_cbranch_vccnz L_exact
    buffer_store_dwordx4 v[60:63], v1, s[44:47], s57 offen sc1
    v_cvt_pk_bf16_f32 v66, v68, v69
    v_mfma_f32_32x32x16_bf16 v[224:239], v[132:135], v[124:127], v[80:95]
    v_exp_f32 v72, v72
    v_exp_f32 v73, v73
    v_cvt_pk_bf16_f32 v67, v70, v71
    v_exp_f32 v74, v74
    v_exp_f32 v75, v75
    v_add3_u32 v56, v60, v61, s56
    v_add3_u32 v56, v62, v63, v56
    buffer_store_dword v56, v14, s[44:47], s58 offen sc1
    v_cvt_pk_bf16_f32 v68, v72, v73
    v_exp_f32 v76, v76
    v_exp_f32 v77, v77
    v_cvt_pk_bf16_f32 v69, v74, v75
    v_exp_f32 v78, v78
    v_exp_f32 v79, v79
    v_cvt_pk_bf16_f32 v70, v76, v77
    v_cvt_pk_bf16_f32 v71, v78, v79
    v_cndmask_b32 v32, v224, v32, s[64:65]
    v_mfma_f32_32x32x16_bf16 v[48:63], v[104:107], v[64:67], 0
    v_cndmask_b32 v33, v225, v33, s[66:67]
    v_cndmask_b32 v34, v226, v34, s[68:69]
    v_cndmask_b32 v35, v227, v35, s[70:71]
    v_cndmask_b32 v36, v228, v36, s[82:83]
    v_cndmask_b32 v37, v229, v37, s[84:85]
    v_cndmask_b32 v38, v230, v38, s[86:87]
    v_cndmask_b32 v39, v231, v39, s[88:89]
    v_cndmask_b32 v40, v232, v40, s[90:91]
    v_cndmask_b32 v41, v233, v41, s[92:93]
    v_mfma_f32_16x16x32_bf16 v[112:115], v[116:119], v[64:67], 0
    v_cndmask_b32 v42, v234, v42, s[94:95]
    v_cndmask_b32 v43, v235, v43, s[8:9]
    v_cndmask_b32 v44, v236, v44, s[10:11]
    v_cndmask_b32 v45, v237, v45, s[12:13]
    v_cndmask_b32 v46, v238, v46, s[14:15]
    v_mfma_f32_32x32x16_bf16 v[192:207], v[104:107], v[68:71], 0
    v_cndmask_b32 v47, v239, v47, s[16:17]
    v_exp_f32 v32, v32
    v_exp_f32 v33, v33
    v_exp_f32 v34, v34
    v_exp_f32 v35, v35
    v_cvt_pk_bf16_f32 v32, v32, v33
    v_exp_f32 v36, v36
    v_exp_f32 v37, v37
    v_cvt_pk_bf16_f32 v33, v34, v35
    v_mfma_f32_16x16x32_bf16 v[112:115], v[116:119], v[68:71], v[112:115]
    v_exp_f32 v38, v38
    v_exp_f32 v39, v39
    v_cvt_pk_bf16_f32 v34, v36, v37
    v_exp_f32 v40, v40
    v_exp_f32 v41, v41
    v_cvt_pk_bf16_f32 v35, v38, v39
    v_mfma_f32_32x32x16_bf16 v[16:31], v[156:159], v[124:127], v[80:95]
    v_exp_f32 v42, v42
    v_exp_f32 v43, v43
    v_cvt_pk_bf16_f32 v36, v40, v41
    v_exp_f32 v44, v44
    v_exp_f32 v45, v45
    v_cvt_pk_bf16_f32 v37, v42, v43
    v_exp_f32 v46, v46
    v_exp_f32 v47, v47
    v_cvt_pk_bf16_f32 v38, v44, v45
    v_cvt_pk_bf16_f32 v39, v46, v47
    v_bfi_b32 v40, v240, 0, v32
    v_bfi_b32 v41, v241, 0, v33
    v_bfi_b32 v42, v242, 0, v34
    v_bfi_b32 v43, v243, 0, v35
    v_bfi_b32 v44, v244, 0, v36
    v_bfi_b32 v45, v245, 0, v37
    v_bfi_b32 v46, v246, 0, v38
    v_bfi_b32 v47, v247, 0, v39
    v_and_b32 v32, v240, v32
    v_and_b32 v33, v241, v33
    v_and_b32 v34, v242, v34
    v_and_b32 v35, v243, v35
    v_and_b32 v36, v244, v36
    v_and_b32 v37, v245, v37
    v_and_b32 v38, v246, v38
    v_and_b32 v39, v247, v39
    v_exp_f32 v16, v16
    v_mfma_f32_32x32x16_bf16 v[224:239], v[152:155], v[124:127], v[80:95]
    v_exp_f32 v17, v17
    v_exp_f32 v18, v18
    v_exp_f32 v19, v19
    v_cvt_pk_bf16_f32 v16, v16, v17
    v_mfma_f32_32x32x16_bf16 v[48:63], v[108:111], v[32:35], v[48:63]
    v_exp_f32 v20, v20
    v_exp_f32 v21, v21
    v_cvt_pk_bf16_f32 v17, v18, v19
    v_exp_f32 v22, v22
    v_exp_f32 v23, v23
    v_mfma_f32_16x16x32_bf16 v[112:115], v[116:119], v[32:35], v[112:115]
    v_cvt_pk_bf16_f32 v18, v20, v21
    v_exp_f32 v24, v24
    v_exp_f32 v25, v25
    v_mfma_f32_32x32x16_bf16 v[192:207], v[108:111], v[36:39], v[192:207]
    v_cvt_pk_bf16_f32 v19, v22, v23
    v_exp_f32 v26, v26
    v_exp_f32 v27, v27
    v_cvt_pk_bf16_f32 v20, v24, v25
    v_exp_f32 v28, v28
    v_mfma_f32_16x16x32_bf16 v[112:115], v[116:119], v[36:39], v[112:115]
    v_exp_f32 v29, v29
    v_cvt_pk_bf16_f32 v21, v26, v27
    v_exp_f32 v30, v30
    v_exp_f32 v31, v31
    v_cvt_pk_bf16_f32 v22, v28, v29
    v_cvt_pk_bf16_f32 v23, v30, v31
    v_exp_f32 v224, v224
    v_mfma_f32_32x32x16_bf16 v[64:79], v[148:151], v[124:127], v[80:95]
    v_exp_f32 v225, v225
    v_exp_f32 v226, v226
    v_exp_f32 v227, v227
    v_cvt_pk_bf16_f32 v224, v224, v225
    v_mfma_f32_32x32x16_bf16 v[48:63], v[188:191], v[16:19], v[48:63]
    v_exp_f32 v228, v228
    v_exp_f32 v229, v229
    v_cvt_pk_bf16_f32 v225, v226, v227
    v_exp_f32 v230, v230
    v_mfma_f32_16x16x32_bf16 v[112:115], v[220:223], v[16:19], v[112:115]
    v_exp_f32 v231, v231
    v_cvt_pk_bf16_f32 v226, v228, v229
    v_mfma_f32_32x32x16_bf16 v[192:207], v[188:191], v[20:23], v[192:207]
    v_exp_f32 v232, v232
    v_exp_f32 v233, v233
    v_cvt_pk_bf16_f32 v227, v230, v231
    v_exp_f32 v234, v234
    v_mfma_f32_16x16x32_bf16 v[112:115], v[220:223], v[20:23], v[112:115]
    v_exp_f32 v235, v235
    v_cvt_pk_bf16_f32 v228, v232, v233
    v_mfma_f32_32x32x16_bf16 v[48:63], v[164:167], v[40:43], v[48:63]
    v_exp_f32 v236, v236
    v_exp_f32 v237, v237
    v_cvt_pk_bf16_f32 v229, v234, v235
    v_exp_f32 v238, v238
    v_mfma_f32_16x16x32_bf16 v[112:115], v[208:211], v[40:43], v[112:115]
    v_exp_f32 v239, v239
    v_cvt_pk_bf16_f32 v230, v236, v237
    v_cvt_pk_bf16_f32 v231, v238, v239
    v_exp_f32 v64, v64
    v_mfma_f32_32x32x16_bf16 v[16:31], v[144:147], v[124:127], v[80:95]
    v_exp_f32 v65, v65
    v_exp_f32 v66, v66
    v_exp_f32 v67, v67
    v_cvt_pk_bf16_f32 v64, v64, v65
    v_mfma_f32_32x32x16_bf16 v[48:63], v[184:187], v[224:227], v[48:63]
    v_exp_f32 v68, v68
    v_exp_f32 v69, v69
    v_cvt_pk_bf16_f32 v65, v66, v67
    v_exp_f32 v70, v70
    v_mfma_f32_16x16x32_bf16 v[112:115], v[220:223], v[224:227], v[112:115]
    v_exp_f32 v71, v71
    v_cvt_pk_bf16_f32 v66, v68, v69
    v_mfma_f32_32x32x16_bf16 v[192:207], v[184:187], v[228:231], v[192:207]
    v_exp_f32 v72, v72
    v_exp_f32 v73, v73
    v_cvt_pk_bf16_f32 v67, v70, v71
    v_exp_f32 v74, v74
    v_mfma_f32_16x16x32_bf16 v[112:115], v[220:223], v[228:231], v[112:115]
    v_exp_f32 v75, v75
    v_cvt_pk_bf16_f32 v68, v72, v73
    v_mfma_f32_32x32x16_bf16 v[192:207], v[164:167], v[44:47], v[192:207]
    v_exp_f32 v76, v76
    v_exp_f32 v77, v77
    v_cvt_pk_bf16_f32 v69, v74, v75
    v_exp_f32 v78, v78
    v_mfma_f32_16x16x32_bf16 v[112:115], v[208:211], v[44:47], v[112:115]
    v_exp_f32 v79, v79
    v_cvt_pk_bf16_f32 v70, v76, v77
    v_cvt_pk_bf16_f32 v71, v78, v79
    v_exp_f32 v16, v16
    v_mfma_f32_32x32x16_bf16 v[224:239], v[140:143], v[124:127], v[80:95]
    v_exp_f32 v17, v17
    v_exp_f32 v18, v18
    v_exp_f32 v19, v19
    v_cvt_pk_bf16_f32 v16, v16, v17
    v_mfma_f32_32x32x16_bf16 v[48:63], v[180:183], v[64:67], v[48:63]
    v_exp_f32 v20, v20
    v_exp_f32 v21, v21
    v_cvt_pk_bf16_f32 v17, v18, v19
    v_exp_f32 v22, v22
    v_exp_f32 v23, v23
    v_mfma_f32_16x16x32_bf16 v[112:115], v[216:219], v[64:67], v[112:115]
    v_cvt_pk_bf16_f32 v18, v20, v21
    v_exp_f32 v24, v24
    v_exp_f32 v25, v25
    v_mfma_f32_32x32x16_bf16 v[192:207], v[180:183], v[68:71], v[192:207]
    v_cvt_pk_bf16_f32 v19, v22, v23
    v_exp_f32 v26, v26
    v_exp_f32 v27, v27
    v_cvt_pk_bf16_f32 v20, v24, v25
    v_exp_f32 v28, v28
    v_mfma_f32_16x16x32_bf16 v[112:115], v[216:219], v[68:71], v[112:115]
    v_exp_f32 v29, v29
    v_cvt_pk_bf16_f32 v21, v26, v27
    v_exp_f32 v30, v30
    v_exp_f32 v31, v31
    v_cvt_pk_bf16_f32 v22, v28, v29
    v_cvt_pk_bf16_f32 v23, v30, v31
    v_exp_f32 v224, v224
    v_mfma_f32_32x32x16_bf16 v[32:47], v[136:139], v[124:127], v[80:95]
    v_exp_f32 v225, v225
    v_exp_f32 v226, v226
    v_exp_f32 v227, v227
    v_cvt_pk_bf16_f32 v224, v224, v225
    v_mfma_f32_32x32x16_bf16 v[48:63], v[176:179], v[16:19], v[48:63]
    v_exp_f32 v228, v228
    v_exp_f32 v229, v229
    v_cvt_pk_bf16_f32 v225, v226, v227
    v_exp_f32 v230, v230
    v_exp_f32 v231, v231
    v_mfma_f32_16x16x32_bf16 v[112:115], v[216:219], v[16:19], v[112:115]
    v_cvt_pk_bf16_f32 v226, v228, v229
    v_exp_f32 v232, v232
    v_exp_f32 v233, v233
    v_mfma_f32_32x32x16_bf16 v[192:207], v[176:179], v[20:23], v[192:207]
    v_cvt_pk_bf16_f32 v227, v230, v231
    v_exp_f32 v234, v234
    v_exp_f32 v235, v235
    v_cvt_pk_bf16_f32 v228, v232, v233
    v_exp_f32 v236, v236
    v_mfma_f32_16x16x32_bf16 v[112:115], v[216:219], v[20:23], v[112:115]
    v_exp_f32 v237, v237
    v_cvt_pk_bf16_f32 v229, v234, v235
    v_exp_f32 v238, v238
    v_exp_f32 v239, v239
    v_cvt_pk_bf16_f32 v230, v236, v237
    v_cvt_pk_bf16_f32 v231, v238, v239
    v_exp_f32 v32, v32
    v_mfma_f32_32x32x16_bf16 v[48:63], v[172:175], v[224:227], v[48:63]
    v_exp_f32 v33, v33
    v_exp_f32 v34, v34
    v_exp_f32 v35, v35
    v_cvt_pk_bf16_f32 v32, v32, v33
    v_mfma_f32_16x16x32_bf16 v[112:115], v[212:215], v[224:227], v[112:115]
    v_exp_f32 v36, v36
    v_exp_f32 v37, v37
    v_cvt_pk_bf16_f32 v33, v34, v35
    v_mfma_f32_32x32x16_bf16 v[192:207], v[172:175], v[228:231], v[192:207]
    v_exp_f32 v38, v38
    v_exp_f32 v39, v39
    v_cvt_pk_bf16_f32 v34, v36, v37
    v_exp_f32 v40, v40
    v_exp_f32 v41, v41
    v_mfma_f32_16x16x32_bf16 v[112:115], v[212:215], v[228:231], v[112:115]
    v_cvt_pk_bf16_f32 v35, v38, v39
    v_exp_f32 v42, v42
    s_nop 0
    v_mfma_f32_32x32x16_bf16 v[48:63], v[168:171], v[32:35], v[48:63]
    v_exp_f32 v43, v43
    v_cvt_pk_bf16_f32 v36, v40, v41
    v_exp_f32 v44, v44
    v_exp_f32 v45, v45
    v_cvt_pk_bf16_f32 v37, v42, v43
    v_mfma_f32_16x16x32_bf16 v[112:115], v[212:215], v[32:35], v[112:115]
    v_exp_f32 v46, v46
    v_exp_f32 v47, v47
    v_cvt_pk_bf16_f32 v38, v44, v45
    v_cvt_pk_bf16_f32 v39, v46, v47
    s_nop 1
    v_mfma_f32_16x16x32_bf16 v[112:115], v[212:215], v[36:39], v[112:115]
    v_mfma_f32_32x32x16_bf16 v[192:207], v[168:171], v[36:39], v[192:207]
    s_bfe_u32 s35, s2, 0x30003
    s_lshr_b32 s57, s2, 6
    s_lshl2_add_u32 s35, s35, s57
    s_and_b32 s38, s2, 7
    s_mul_i32 s38, s38, 14
    s_add_u32 s38, s38, s35
    v_lshrrev_b32 v2, 1, v4
    v_mul_u32_u24 v7, 3584, v2
    v_and_b32 v2, 1, v4
    v_lshl_add_u32 v7, v2, 4, v7
    v_cmp_ngt_f32 vcc, s32, v112
    s_mov_b32 s33, 1
    v_rcp_f32 v56, v112
    s_add_u32 s57, s81, 32768
    s_add_u32 s58, s101, 8192
    s_add_u32 s57, s57, s39
    s_add_u32 s58, s58, s39
    s_cbranch_vccnz L_exact
    v_pk_add_f32 v[48:49], v[48:49], v[200:201]
    v_pk_add_f32 v[50:51], v[50:51], v[202:203]
    v_pk_add_f32 v[52:53], v[52:53], v[204:205]
    v_pk_add_f32 v[54:55], v[54:55], v[206:207]
    v_pk_mul_f32 v[48:49], v[48:49], v[56:57] op_sel_hi:[1,0]
    v_pk_mul_f32 v[50:51], v[50:51], v[56:57] op_sel_hi:[1,0]
    v_pk_mul_f32 v[52:53], v[52:53], v[56:57] op_sel_hi:[1,0]
    v_pk_mul_f32 v[54:55], v[54:55], v[56:57] op_sel_hi:[1,0]
    v_cvt_pk_bf16_f32 v60, v48, v49
    v_cvt_pk_bf16_f32 v61, v50, v51
    v_cvt_pk_bf16_f32 v62, v52, v53
    v_cvt_pk_bf16_f32 v63, v54, v55
L_p2e:
    s_cmp_eq_u32 s39, 0
    s_cbranch_scc1 L_ofar
    buffer_store_dwordx4 v[60:63], v1, s[44:47], s57 offen
    v_add3_u32 v56, v60, v61, s56
    v_add3_u32 v56, v62, v63, v56
    buffer_store_dword v56, v1, s[44:47], s58 offen
L_odone:
    s_cmp_lt_u32 s35, 14
    s_cbranch_scc0 L_not5
    s_mul_i32 s58, s52, 458752
    s_lshl_b32 s59, s38, 5
    s_add_u32 s58, s58, s59
    s_lshl_b32 s59, s52, 13
    buffer_load_dwordx4 v[128:131], v7, s[20:23], s58 offen
    s_barrier
    v_bfe_u32 v2, v4, 2, 2
    v_and_b32 v11, 3, v4
    v_lshrrev_b32 v8, 4, v4
    v_lshlrev_b32 v9, 8, v2
    v_lshl_add_u32 v9, v11, 3, v9
    v_lshl_add_u32 v9, v8, 5, v9
    s_lshl_b32 s60, s52, 12
    s_add_u32 s60, s60, 90112
    v_add_u32 v9, s60, v9
    s_mov_b32 s73, s60
    v_and_b32 v12, 15, v4
    v_lshlrev_b32 v12, 4, v12
    v_lshl_add_u32 v12, v8, 10, v12
    s_lshl_b32 s72, s38, 14
    s_lshl_b32 s60, s52, 8
    s_add_u32 s72, s72, s60
    v_lshl_add_u32 v10, v8, 3, v2
    v_lshlrev_b32 v10, 5, v10
    v_lshl_add_u32 v10, v11, 3, v10
    s_add_u32 s60, s59, 106496
    v_add_u32 v10, s60, v10
    v_and_b32 v57, 15, v4
    v_lshlrev_b32 v57, 4, v57
    s_lshl_b32 s60, s52, 8
    s_add_u32 s60, s60, 4096
    v_add_u32 v58, s60, v57
    v_bfe_u32 v2, v4, 4, 1
    v_lshl_add_u32 v57, v2, 3, v57
    s_lshl_b32 s75, s38, 12
    s_lshl_b32 s60, s52, 10
    s_add_u32 s75, s75, s60
    s_add_u32 s75, s75, 413696
    v_lshlrev_b32 v59, 3, v4
    v_and_b32 v60, 1, v4
    v_cmp_eq_u32 s[64:65], 1, v60
    v_lshlrev_b32 v60, 4, v60
    v_lshrrev_b32 v60, v60, s56
    v_lshrrev_b32 v61, 8, v60
    v_mov_b32 v62, 0xff
    v_bfe_u32 v63, v4, 1, 3
    v_cmp_eq_u32 s[78:79], 0, v63
    v_lshlrev_b32 v63, 26, v63
    v_lshl_add_u32 v63, v8, 4, v63
    s_lshl_b32 s76, s52, 8
    s_add_u32 s76, s76, 1048576
    s_lshl_b32 s77, s52, 6
    s_add_u32 s77, s77, 1049600
    s_add_u32 s60, s59, 106496
    v_add_u32 v11, s60, v1
    s_barrier
    buffer_load_dwordx4 v[144:147], v7, s[24:27], s58 offen
    s_add_u32 s58, s58, 114688
    buffer_load_dwordx4 v[132:135], v7, s[20:23], s58 offen
    buffer_load_dwordx4 v[148:151], v7, s[24:27], s58 offen
    s_add_u32 s58, s58, 114688
    buffer_load_dwordx4 v[136:139], v7, s[20:23], s58 offen
    buffer_load_dwordx4 v[152:155], v7, s[24:27], s58 offen
    s_add_u32 s58, s58, 114688
    buffer_load_dwordx4 v[140:143], v7, s[20:23], s58 offen
    s_barrier
    s_waitcnt vmcnt(6)
    ds_write_b128 v11, v[128:131] offset:0
    s_waitcnt vmcnt(5)
    ds_write_b128 v11, v[144:147] offset:4096
    s_waitcnt vmcnt(4)
    ds_write_b128 v11, v[132:135] offset:1024
    s_waitcnt vmcnt(3)
    ds_write_b128 v11, v[148:151] offset:5120
    s_waitcnt vmcnt(2)
    ds_write_b128 v11, v[136:139] offset:2048
    s_waitcnt vmcnt(1)
    ds_write_b128 v11, v[152:155] offset:6144
    s_waitcnt vmcnt(0)
    ds_write_b128 v11, v[140:143] offset:3072
    ds_read_b64_tr_b16 v[96:97], v10 offset:0
    ds_read_b64_tr_b16 v[98:99], v10 offset:128
    ds_read_b64_tr_b16 v[112:113], v10 offset:4096
    ds_read_b64_tr_b16 v[114:115], v10 offset:4224
    ds_read_b64_tr_b16 v[100:101], v10 offset:1024
    ds_read_b64_tr_b16 v[102:103], v10 offset:1152
    ds_read_b64_tr_b16 v[116:117], v10 offset:5120
    ds_read_b64_tr_b16 v[118:119], v10 offset:5248
    ds_read_b64_tr_b16 v[104:105], v10 offset:2048
    ds_read_b64_tr_b16 v[106:107], v10 offset:2176
    ds_read_b64_tr_b16 v[120:121], v10 offset:6144
    ds_read_b64_tr_b16 v[122:123], v10 offset:6272
    ds_read_b64_tr_b16 v[108:109], v10 offset:3072
    ds_read_b64_tr_b16 v[110:111], v10 offset:3200
    s_barrier
    buffer_load_dwordx4 v[156:159], v7, s[24:27], s58 offen
    s_add_u32 s58, s58, 114688
    s_add_u32 m0, s73, 0
    s_nop 0
    buffer_load_dwordx4 v12, s[28:31], s72 offen nt lds
    s_addk_i32 s72, 4096
    s_add_u32 m0, s73, 1024
    s_nop 0
    buffer_load_dwordx4 v12, s[28:31], s72 offen nt lds
    s_addk_i32 s72, 4096
    s_add_u32 m0, s73, 2048
    s_nop 0
    buffer_load_dwordx4 v12, s[28:31], s72 offen nt lds
    s_addk_i32 s72, 4096
    s_add_u32 m0, s73, 3072
    s_nop 0
    buffer_load_dwordx4 v12, s[28:31], s72 offen nt lds
    s_addk_i32 s72, 4096
    s_waitcnt vmcnt(4)
    ds_write_b128 v11, v[156:159] offset:7168
    ds_read_b64_tr_b16 v[124:125], v10 offset:7168
    ds_read_b64_tr_b16 v[126:127], v10 offset:7296
    s_cmp_eq_u32 s52, 0
    s_cbranch_scc1 L_poller
L_s5go:
    v_mov_b32 v2, 0
    s_waitcnt lgkmcnt(0)
    s_barrier
    ds_read_b64 v[16:17], v2 offset:128
    s_waitcnt lgkmcnt(0)
    v_readfirstlane_b32 s66, v16
    v_readfirstlane_b32 s67, v17
    s_bfe_u32 s70, s66, 0xb0001
    s_sub_u32 s70, 2047, s70
    s_bfe_u32 s71, s67, 0xb0001
    s_sub_u32 s71, 2047, s71
    s_lshr_b32 s68, s70, 7
    s_bfe_u32 s60, s70, 0x30003
    s_lshl3_add_u32 s68, s68, s60
    s_and_b32 s60, s66, 1
    s_lshl1_add_u32 s68, s68, s60
    s_lshl_b32 s68, s68, 12
    s_lshr_b32 s69, s71, 7
    s_bfe_u32 s60, s71, 0x30003
    s_lshl3_add_u32 s69, s69, s60
    s_and_b32 s60, s67, 1
    s_lshl1_add_u32 s69, s69, s60
    s_lshl_b32 s69, s69, 12
    v_mov_b32 v2, s68
    v_mov_b32 v56, s69
    v_cndmask_b32 v56, v2, v56, s[64:65]
    v_add_u32 v56, v56, v63
    buffer_load_dwordx4 v[16:19], v56, s[44:47], s76 offen offset:0 sc1
    buffer_load_dwordx4 v[20:23], v56, s[44:47], s76 offen offset:64 sc1
    buffer_load_dwordx4 v[24:27], v56, s[44:47], s76 offen offset:128 sc1
    buffer_load_dwordx4 v[28:31], v56, s[44:47], s76 offen offset:192 sc1
    buffer_load_dwordx4 v[32:35], v56, s[44:47], s77 offen sc1
    s_waitcnt vmcnt(5)
    ds_read_b64_tr_b16 v[64:65], v9 offset:0
    ds_read_b64_tr_b16 v[66:67], v9 offset:1024
    ds_read_b64_tr_b16 v[68:69], v9 offset:2048
    ds_read_b64_tr_b16 v[70:71], v9 offset:3072
    ds_read_b64_tr_b16 v[72:73], v9 offset:128
    ds_read_b64_tr_b16 v[74:75], v9 offset:1152
    ds_read_b64_tr_b16 v[76:77], v9 offset:2176
    ds_read_b64_tr_b16 v[78:79], v9 offset:3200
L_xs_c:
    s_waitcnt vmcnt(4)
    v_mfma_f32_16x16x32_bf16 v[40:43], v[16:19], v[96:99], 0
    v_mfma_f32_16x16x32_bf16 v[44:47], v[16:19], v[112:115], 0
    v_add3_u32 v36, v16, v17, s56
    v_add3_u32 v36, v18, v19, v36
    s_waitcnt vmcnt(3)
    v_mfma_f32_16x16x32_bf16 v[40:43], v[20:23], v[100:103], v[40:43]
    v_mfma_f32_16x16x32_bf16 v[44:47], v[20:23], v[116:119], v[44:47]
    v_add3_u32 v37, v20, v21, s56
    v_add3_u32 v37, v22, v23, v37
    s_waitcnt vmcnt(2)
    v_mfma_f32_16x16x32_bf16 v[40:43], v[24:27], v[104:107], v[40:43]
    v_mfma_f32_16x16x32_bf16 v[44:47], v[24:27], v[120:123], v[44:47]
    v_add3_u32 v38, v24, v25, s56
    v_add3_u32 v38, v26, v27, v38
    s_waitcnt vmcnt(1)
    v_mfma_f32_16x16x32_bf16 v[40:43], v[28:31], v[108:111], v[40:43]
    v_mfma_f32_16x16x32_bf16 v[44:47], v[28:31], v[124:127], v[44:47]
    v_add3_u32 v39, v28, v29, s56
    v_add3_u32 v39, v30, v31, v39
    s_waitcnt vmcnt(0)
    v_xor_b32 v2, v36, v32
    v_bitop3_b32 v2, v2, v37, v33 bitop3:0xf6
    v_bitop3_b32 v2, v2, v38, v34 bitop3:0xf6
    v_bitop3_b32 v2, v2, v39, v35 bitop3:0xf6
    v_cmp_ne_u32 vcc, 0, v2
    s_nop 0
    s_and_b64 vcc, vcc, s[78:79]
    s_cmp_lg_u64 vcc, 0
    s_cbranch_scc1 L_xs_p
L_xs_o:
    v_mov_b32 v42, v41
    v_mov_b32 v41, v44
    v_mov_b32 v43, v45
    s_mov_b64 exec, 0xffff
    ds_write_b128 v58, v[40:43]
    s_mov_b64 exec, -1
    s_waitcnt lgkmcnt(0)
    s_barrier
    ds_read_b64 v[40:41], v57 offset:4096
    ds_read_b64 v[42:43], v57 offset:4352
    ds_read_b64 v[44:45], v57 offset:4608
    ds_read_b64 v[46:47], v57 offset:4864
    s_waitcnt lgkmcnt(2)
    v_pk_add_f32 v[40:41], v[40:41], v[42:43]
    s_waitcnt lgkmcnt(0)
    v_pk_add_f32 v[44:45], v[44:45], v[46:47]
    v_pk_add_f32 v[40:41], v[40:41], v[44:45]
    v_cvt_pk_bf16_f32 v41, v40, v41
    v_lshlrev_b32 v40, 16, v41
    v_mul_f32 v42, 0xbfb8aa3b, v40
    v_exp_f32 v42, v42
    v_and_b32 v41, 0xffff0000, v41
    v_add_f32 v42, 1.0, v42
    v_rcp_f32 v42, v42
    s_nop 0
    v_mul_f32 v40, v40, v42
    v_cvt_pk_bf16_f32 v40, v40, v40
    v_and_b32 v40, 0xffff0000, v40
    v_mul_f32 v40, v40, v41
    s_nop 1
    v_mov_b32_dpp v41, v40 quad_perm:[1,0,3,2] row_mask:0xf bank_mask:0xf
    v_cvt_pk_bf16_f32 v40, v40, v41
    s_nop 0
    v_readlane_b32 s80, v40, 0
    v_readlane_b32 s88, v40, 16
    v_readlane_b32 s81, v40, 2
    v_readlane_b32 s89, v40, 18
    v_readlane_b32 s82, v40, 4
    v_readlane_b32 s90, v40, 20
    v_readlane_b32 s83, v40, 6
    v_readlane_b32 s91, v40, 22
    v_readlane_b32 s84, v40, 8
    v_readlane_b32 s92, v40, 24
    v_readlane_b32 s85, v40, 10
    v_readlane_b32 s93, v40, 26
    v_readlane_b32 s86, v40, 12
    v_readlane_b32 s94, v40, 28
    v_readlane_b32 s87, v40, 14
    v_readlane_b32 s95, v40, 30
    v_dot2_f32_bf16 v48, v64, s80, 0
    v_dot2_f32_bf16 v49, v64, s88, 0
    v_dot2_f32_bf16 v50, v72, s80, 0
    v_dot2_f32_bf16 v51, v72, s88, 0
    v_dot2_f32_bf16 v48, v65, s81, v48
    v_dot2_f32_bf16 v49, v65, s89, v49
    v_dot2_f32_bf16 v50, v73, s81, v50
    v_dot2_f32_bf16 v51, v73, s89, v51
    v_dot2_f32_bf16 v48, v66, s82, v48
    v_dot2_f32_bf16 v49, v66, s90, v49
    v_dot2_f32_bf16 v50, v74, s82, v50
    v_dot2_f32_bf16 v51, v74, s90, v51
    v_dot2_f32_bf16 v48, v67, s83, v48
    v_dot2_f32_bf16 v49, v67, s91, v49
    v_dot2_f32_bf16 v50, v75, s83, v50
    v_dot2_f32_bf16 v51, v75, s91, v51
    v_dot2_f32_bf16 v48, v68, s84, v48
    v_dot2_f32_bf16 v49, v68, s92, v49
    v_dot2_f32_bf16 v50, v76, s84, v50
    v_dot2_f32_bf16 v51, v76, s92, v51
    v_dot2_f32_bf16 v48, v69, s85, v48
    v_dot2_f32_bf16 v49, v69, s93, v49
    v_dot2_f32_bf16 v50, v77, s85, v50
    v_dot2_f32_bf16 v51, v77, s93, v51
    v_dot2_f32_bf16 v48, v70, s86, v48
    v_dot2_f32_bf16 v49, v70, s94, v49
    v_dot2_f32_bf16 v50, v78, s86, v50
    v_dot2_f32_bf16 v51, v78, s94, v51
    v_dot2_f32_bf16 v48, v71, s87, v48
    v_dot2_f32_bf16 v49, v71, s95, v49
    v_dot2_f32_bf16 v50, v79, s87, v50
    v_dot2_f32_bf16 v51, v79, s95, v51
    v_bfi_b32 v48, v62, v60, v48
    v_bfi_b32 v49, v62, v61, v49
    buffer_store_dwordx2 v[48:49], v59, s[44:47], s75 offen offset:0 sc1
    v_bfi_b32 v50, v62, v60, v50
    v_bfi_b32 v51, v62, v61, v51
    buffer_store_dwordx2 v[50:51], v59, s[44:47], s75 offen offset:512 sc1
    s_endpgm
L_not5:
    s_cmp_eq_u32 s52, 0
    s_cbranch_scc0 L_fin
    s_barrier
    s_barrier
    s_barrier
    s_barrier
L_poller:
    s_mov_b32 s61, 86016
    v_lshlrev_b32 v2, 8, v4
    s_mov_b32 exec_hi, 0
    buffer_load_dwordx3 v[16:18], v2, s[44:47], s61 offen sc1
    s_waitcnt vmcnt(0)
L_a2_c:
    v_cmp_ne_u32 vcc, s56, v18
    s_nop 0
    s_cmp_lg_u64 vcc, 0
    s_cbranch_scc1 L_a2_p
L_a2_o:
    v_min_u32_dpp v18, v16, v16 quad_perm:[1,0,3,2] row_mask:0xf bank_mask:0xf
    v_max_u32_dpp v19, v17, v17 quad_perm:[1,0,3,2] row_mask:0xf bank_mask:0xf
    v_max_u32_dpp v16, v16, v16 quad_perm:[1,0,3,2] row_mask:0xf bank_mask:0xf
    v_max_u32 v17, v18, v19
    s_nop 0
    v_min_u32_dpp v18, v16, v16 quad_perm:[2,3,0,1] row_mask:0xf bank_mask:0xf
    v_max_u32_dpp v19, v17, v17 quad_perm:[2,3,0,1] row_mask:0xf bank_mask:0xf
    v_max_u32_dpp v16, v16, v16 quad_perm:[2,3,0,1] row_mask:0xf bank_mask:0xf
    v_max_u32 v17, v18, v19
    s_nop 0
    v_min_u32_dpp v18, v16, v16 row_half_mirror row_mask:0xf bank_mask:0xf
    v_max_u32_dpp v19, v17, v17 row_half_mirror row_mask:0xf bank_mask:0xf
    v_max_u32_dpp v16, v16, v16 row_half_mirror row_mask:0xf bank_mask:0xf
    v_max_u32 v17, v18, v19
    s_nop 0
    v_min_u32_dpp v18, v16, v16 row_mirror row_mask:0xf bank_mask:0xf
    v_max_u32_dpp v19, v17, v17 row_mirror row_mask:0xf bank_mask:0xf
    v_max_u32_dpp v16, v16, v16 row_mirror row_mask:0xf bank_mask:0xf
    v_max_u32 v17, v18, v19
    s_nop 0
    v_min_u32_dpp v18, v16, v16 row_bcast:15 row_mask:0xa bank_mask:0xf
    v_max_u32_dpp v19, v17, v17 row_bcast:15 row_mask:0xa bank_mask:0xf
    v_max_u32_dpp v16, v16, v16 row_bcast:15 row_mask:0xa bank_mask:0xf
    v_max_u32 v17, v18, v19
    s_mov_b64 exec, -1
    v_mov_b32 v2, 0
    s_lshl_b64 exec, 1, 31
    ds_write_b64 v2, v[16:17] offset:128
    s_mov_b64 exec, -1
    s_cmp_lt_u32 s35, 14
    s_cbranch_scc1 L_s5go
    s_waitcnt lgkmcnt(0)
    s_barrier
L_fin:
    s_endpgm
.p2align 6
L_helper:
    buffer_load_dwordx4 v[104:107], v24, s[4:7], s73 offen
    buffer_load_dwordx4 v[108:111], v25, s[4:7], s73 offen
    s_mul_i32 s57, s52, 49152
    s_lshl_b32 s58, s54, 7
    s_add_u32 s57, s57, s58
    v_mul_u32_u24 v1, 3072, v5
    v_add_u32 v1, s57, v1
    s_and_b32 s58, s52, 2
    s_lshl_b32 s58, s58, 1
    v_xor_b32 v2, s58, v6
    v_lshl_add_u32 v10, v2, 4, v1
    v_xor_b32 v2, 2, v2
    v_lshl_add_u32 v11, v2, 4, v1
    v_add_u32 v11, 23552, v11
    v_add_u32 v32, 1024, v10
    v_add_u32 v33, 1024, v11
    v_add_u32 v34, 2048, v10
    v_add_u32 v35, 2048, v11
    s_lshl_b32 s62, s52, 11
    s_mov_b32 s61, 196608
    s_add_u32 s58, s55, 0
    s_and_b32 s58, s58, 7
    s_mul_i32 s64, s58, s61
    s_mov_b32 s10, 1572864
    s_mov_b32 s11, 0x20000
    s_mov_b64 s[80:81], s[48:49]
    s_mov_b32 s82, L_code_end-L_pc
    s_mov_b32 s83, 0x20000
    s_lshl_b32 s84, s2, 8
    s_and_b32 s84, s84, 0xf800
    v_lshlrev_b32 v3, 3, v0
    s_add_u32 s58, s55, 1
    s_and_b32 s58, s58, 7
    s_mul_i32 s65, s58, s61
    s_add_u32 s58, s55, 2
    s_and_b32 s58, s58, 7
    s_mul_i32 s66, s58, s61
    s_add_u32 s58, s55, 3
    s_and_b32 s58, s58, 7
    s_mul_i32 s67, s58, s61
    s_add_u32 s58, s55, 4
    s_and_b32 s58, s58, 7
    s_mul_i32 s68, s58, s61
    s_add_u32 s58, s55, 5
    s_and_b32 s58, s58, 7
    s_mul_i32 s69, s58, s61
    s_add_u32 s58, s55, 6
    s_and_b32 s58, s58, 7
    s_mul_i32 s70, s58, s61
    s_add_u32 s58, s55, 7
    s_and_b32 s58, s58, 7
    s_mul_i32 s71, s58, s61
    v_mul_u32_u24 v39, 3072, v4
    v_add_u32 v39, s57, v39
    v_lshrrev_b32 v1, 4, v4
    v_lshl_or_b32 v39, v1, 26, v39
    s_lshl_b32 s57, s2, 4
    s_and_b32 s57, s57, 0x380
    v_lshl_add_u32 v63, v6, 4, s57
    s_sub_u32 s78, s2, 64
    s_cmpk_ge_u32 s2, 128
    s_cselect_b32 s78, s78, 0
    s_cselect_b32 s59, 0, 1073741824
    v_mul_u32_u24 v7, 24576, v5
    v_lshl_add_u32 v7, v6, 4, v7
    v_or_b32 v7, s59, v7
    v_lshlrev_b32 v8, 3, v5
    s_lshr_b32 s87, s2, 6
    s_lshl2_add_u32 s87, s52, s87
    s_lshl_b32 s87, s87, 15
    s_lshl_b32 s58, s2, 4
    s_and_b32 s58, s58, 0x380
    s_add_u32 s87, s87, s58
    v_lshrrev_b32 v9, 5, v4
    v_lshlrev_b32 v9, 26, v9
    v_lshl_add_u32 v9, v4, 10, v9
    s_and_b32 s85, s78, 3
    s_lshl2_add_u32 s85, s85, s52
    s_lshl_b32 s86, s85, 6
    s_mul_i32 s85, s85, 196608
    s_lshr_b32 s59, s78, 2
    s_lshl_b32 s59, s59, 7
    s_add_u32 s85, s85, s59
    s_load_dwordx2 s[12:13], s[0:1], 16
    s_load_dwordx2 s[16:17], s[0:1], 32
    s_load_dwordx2 s[20:21], s[0:1], 40
    s_load_dwordx2 s[24:25], s[0:1], 48
    s_load_dwordx2 s[40:41], s[0:1], 80
    s_mov_b32 s46, 23068672
    s_mov_b32 s47, s7
    s_mov_b32 s14, 524288
    s_mov_b32 s15, s7
    s_mov_b32 s18, 1024
    s_mov_b32 s19, s7
    s_mov_b32 s22, 1835008
    s_mov_b32 s23, s7
    s_mov_b32 s26, 1835008
    s_mov_b32 s27, s7
    s_mov_b32 s42, 2097152
    s_mov_b32 s43, s7
    s_mov_b32 s63, 0
    v_mov_b32 v29, 0x3f803f80
    s_lshl_b32 s57, s96, 11
    s_add_u32 s57, s57, 155648
    v_lshl_add_u32 v28, v6, 5, s57
    s_lshl1_add_u32 s57, s52, s96
    s_lshl_b32 s57, s57, 7
    s_add_u32 s57, s57, 159744
    v_lshl_add_u32 v30, v5, 4, s57
    v_xor_b32 v31, 128, v30
    buffer_load_dwordx4 v[112:115], v24, s[4:7], s74 offen
    buffer_load_dwordx4 v[116:119], v25, s[4:7], s74 offen
    buffer_load_dwordx4 v[120:123], v24, s[4:7], s75 offen
    buffer_load_dwordx4 v[124:127], v25, s[4:7], s75 offen
    s_waitcnt lgkmcnt(0)
    s_mul_i32 s56, s97, 1664525
    s_add_u32 s56, s56, 1013904223
    s_and_b32 s0, s56, 0xff
    s_bfe_u32 s98, s56, 0x80008
    s_bfe_u32 s99, s56, 0x80010
    s_lshr_b32 s3, s56, 24
    s_getreg_b32 s88, hwreg(HW_REG_XCC_ID, 0, 4)
    s_and_b32 s89, s2, 7
    s_lshl_b32 s89, s89, 12
    s_add_u32 s89, s89, 872448
    s_lshl_b32 s57, s2, 4
    s_and_b32 s57, s57, 0xf80
    s_add_u32 s57, s57, s89
    s_waitcnt vmcnt(8)
    v_mov_b32 v204, s88
    v_mov_b32 v205, s56
    v_and_b32 v2, 0xff, v0
    v_cmp_ne_u32 vcc, 0, v2
    v_mov_b32 v206, 1073741824
    s_nop 0
    v_cndmask_b32 v207, 0, v206, vcc
    buffer_store_dwordx2 v[204:205], v207, s[44:47], s57 offen sc1
    s_waitcnt vmcnt(8)
    v_dot2_f32_bf16 v16, v96, v29, 0
    v_lshlrev_b32 v128, 16, v96
    v_dot2_f32_bf16 v17, v96, v96, 0
    v_and_b32 v129, 0xffff0000, v96
    v_dot2_f32_bf16 v16, v97, v29, v16
    v_lshlrev_b32 v130, 16, v97
    v_dot2_f32_bf16 v17, v97, v97, v17
    v_and_b32 v131, 0xffff0000, v97
    v_dot2_f32_bf16 v16, v98, v29, v16
    v_lshlrev_b32 v132, 16, v98
    v_dot2_f32_bf16 v17, v98, v98, v17
    v_and_b32 v133, 0xffff0000, v98
    v_dot2_f32_bf16 v16, v99, v29, v16
    v_lshlrev_b32 v134, 16, v99
    v_dot2_f32_bf16 v17, v99, v99, v17
    v_and_b32 v135, 0xffff0000, v99
    s_waitcnt vmcnt(7)
    v_dot2_f32_bf16 v18, v100, v29, 0
    v_lshlrev_b32 v136, 16, v100
    v_dot2_f32_bf16 v19, v100, v100, 0
    v_and_b32 v137, 0xffff0000, v100
    v_dot2_f32_bf16 v18, v101, v29, v18
    v_lshlrev_b32 v138, 16, v101
    v_dot2_f32_bf16 v19, v101, v101, v19
    v_and_b32 v139, 0xffff0000, v101
    v_dot2_f32_bf16 v18, v102, v29, v18
    v_lshlrev_b32 v140, 16, v102
    v_dot2_f32_bf16 v19, v102, v102, v19
    v_and_b32 v141, 0xffff0000, v102
    v_dot2_f32_bf16 v18, v103, v29, v18
    v_lshlrev_b32 v142, 16, v103
    v_dot2_f32_bf16 v19, v103, v103, v19
    v_and_b32 v143, 0xffff0000, v103
    s_barrier
    s_add_u32 m0, s62, 0
    s_nop 0
    buffer_load_dwordx4 v32, s[8:11], s64 offen lds
    buffer_load_dwordx4 v33, s[8:11], s64 offen offset:1024 lds
    s_add_u32 m0, s62, 8192
    s_nop 0
    buffer_load_dwordx4 v34, s[8:11], s64 offen lds
    buffer_load_dwordx4 v35, s[8:11], s64 offen offset:1024 lds
    buffer_load_dwordx2 v[60:61], v3, s[80:83], s84 offen
    s_waitcnt vmcnt(11)
    v_dot2_f32_bf16 v16, v104, v29, v16
    v_lshlrev_b32 v144, 16, v104
    v_dot2_f32_bf16 v17, v104, v104, v17
    v_and_b32 v145, 0xffff0000, v104
    v_dot2_f32_bf16 v16, v105, v29, v16
    v_lshlrev_b32 v146, 16, v105
    v_dot2_f32_bf16 v17, v105, v105, v17
    v_and_b32 v147, 0xffff0000, v105
    v_dot2_f32_bf16 v16, v106, v29, v16
    v_lshlrev_b32 v148, 16, v106
    v_dot2_f32_bf16 v17, v106, v106, v17
    v_and_b32 v149, 0xffff0000, v106
    v_dot2_f32_bf16 v16, v107, v29, v16
    v_lshlrev_b32 v150, 16, v107
    v_dot2_f32_bf16 v17, v107, v107, v17
    v_and_b32 v151, 0xffff0000, v107
    s_waitcnt vmcnt(10)
    v_dot2_f32_bf16 v18, v108, v29, v18
    v_lshlrev_b32 v152, 16, v108
    v_dot2_f32_bf16 v19, v108, v108, v19
    v_and_b32 v153, 0xffff0000, v108
    v_dot2_f32_bf16 v18, v109, v29, v18
    v_lshlrev_b32 v154, 16, v109
    v_dot2_f32_bf16 v19, v109, v109, v19
    v_and_b32 v155, 0xffff0000, v109
    v_dot2_f32_bf16 v18, v110, v29, v18
    v_lshlrev_b32 v156, 16, v110
    v_dot2_f32_bf16 v19, v110, v110, v19
    v_and_b32 v157, 0xffff0000, v110
    v_dot2_f32_bf16 v18, v111, v29, v18
    v_lshlrev_b32 v158, 16, v111
    v_dot2_f32_bf16 v19, v111, v111, v19
    v_and_b32 v159, 0xffff0000, v111
    s_waitcnt vmcnt(9)
    v_dot2_f32_bf16 v16, v112, v29, v16
    v_lshlrev_b32 v160, 16, v112
    v_dot2_f32_bf16 v17, v112, v112, v17
    v_and_b32 v161, 0xffff0000, v112
    v_dot2_f32_bf16 v16, v113, v29, v16
    v_lshlrev_b32 v162, 16, v113
    v_dot2_f32_bf16 v17, v113, v113, v17
    v_and_b32 v163, 0xffff0000, v113
    v_dot2_f32_bf16 v16, v114, v29, v16
    v_lshlrev_b32 v164, 16, v114
    v_dot2_f32_bf16 v17, v114, v114, v17
    v_and_b32 v165, 0xffff0000, v114
    v_dot2_f32_bf16 v16, v115, v29, v16
    v_lshlrev_b32 v166, 16, v115
    v_dot2_f32_bf16 v17, v115, v115, v17
    v_and_b32 v167, 0xffff0000, v115
    s_waitcnt vmcnt(8)
    v_dot2_f32_bf16 v18, v116, v29, v18
    v_lshlrev_b32 v168, 16, v116
    v_dot2_f32_bf16 v19, v116, v116, v19
    v_and_b32 v169, 0xffff0000, v116
    v_dot2_f32_bf16 v18, v117, v29, v18
    v_lshlrev_b32 v170, 16, v117
    v_dot2_f32_bf16 v19, v117, v117, v19
    v_and_b32 v171, 0xffff0000, v117
    v_dot2_f32_bf16 v18, v118, v29, v18
    v_lshlrev_b32 v172, 16, v118
    v_dot2_f32_bf16 v19, v118, v118, v19
    v_and_b32 v173, 0xffff0000, v118
    v_dot2_f32_bf16 v18, v119, v29, v18
    v_lshlrev_b32 v174, 16, v119
    v_dot2_f32_bf16 v19, v119, v119, v19
    v_and_b32 v175, 0xffff0000, v119
    s_waitcnt vmcnt(7)
    v_dot2_f32_bf16 v16, v120, v29, v16
    v_lshlrev_b32 v176, 16, v120
    v_dot2_f32_bf16 v17, v120, v120, v17
    v_and_b32 v177, 0xffff0000, v120
    v_dot2_f32_bf16 v16, v121, v29, v16
    v_lshlrev_b32 v178, 16, v121
    v_dot2_f32_bf16 v17, v121, v121, v17
    v_and_b32 v179, 0xffff0000, v121
    v_dot2_f32_bf16 v16, v122, v29, v16
    v_lshlrev_b32 v180, 16, v122
    v_dot2_f32_bf16 v17, v122, v122, v17
    v_and_b32 v181, 0xffff0000, v122
    v_dot2_f32_bf16 v16, v123, v29, v16
    v_lshlrev_b32 v182, 16, v123
    v_dot2_f32_bf16 v17, v123, v123, v17
    v_and_b32 v183, 0xffff0000, v123
    s_waitcnt vmcnt(6)
    v_dot2_f32_bf16 v18, v124, v29, v18
    v_lshlrev_b32 v184, 16, v124
    v_dot2_f32_bf16 v19, v124, v124, v19
    v_and_b32 v185, 0xffff0000, v124
    v_dot2_f32_bf16 v18, v125, v29, v18
    v_lshlrev_b32 v186, 16, v125
    v_dot2_f32_bf16 v19, v125, v125, v19
    v_and_b32 v187, 0xffff0000, v125
    v_dot2_f32_bf16 v18, v126, v29, v18
    v_lshlrev_b32 v188, 16, v126
    v_dot2_f32_bf16 v19, v126, v126, v19
    v_and_b32 v189, 0xffff0000, v126
    v_dot2_f32_bf16 v18, v127, v29, v18
    v_lshlrev_b32 v190, 16, v127
    v_dot2_f32_bf16 v19, v127, v127, v19
    v_and_b32 v191, 0xffff0000, v127
    s_add_u32 m0, s62, 16384
    s_nop 0
    buffer_load_dwordx4 v32, s[8:11], s65 offen lds
    buffer_load_dwordx4 v33, s[8:11], s65 offen offset:1024 lds
    s_add_u32 m0, s62, 24576
    s_nop 0
    buffer_load_dwordx4 v34, s[8:11], s65 offen lds
    buffer_load_dwordx4 v35, s[8:11], s65 offen offset:1024 lds
    v_add_f32_dpp v16, v16, v16 quad_perm:[1,0,3,2] row_mask:0xf bank_mask:0xf
    v_add_f32_dpp v17, v17, v17 quad_perm:[1,0,3,2] row_mask:0xf bank_mask:0xf
    v_add_f32_dpp v18, v18, v18 quad_perm:[1,0,3,2] row_mask:0xf bank_mask:0xf
    v_add_f32_dpp v19, v19, v19 quad_perm:[1,0,3,2] row_mask:0xf bank_mask:0xf
    v_add_f32_dpp v16, v16, v16 quad_perm:[2,3,0,1] row_mask:0xf bank_mask:0xf
    v_add_f32_dpp v17, v17, v17 quad_perm:[2,3,0,1] row_mask:0xf bank_mask:0xf
    v_add_f32_dpp v18, v18, v18 quad_perm:[2,3,0,1] row_mask:0xf bank_mask:0xf
    v_add_f32_dpp v19, v19, v19 quad_perm:[2,3,0,1] row_mask:0xf bank_mask:0xf
    v_add_f32_dpp v16, v16, v16 row_half_mirror row_mask:0xf bank_mask:0xf
    v_add_f32_dpp v17, v17, v17 row_half_mirror row_mask:0xf bank_mask:0xf
    v_add_f32_dpp v18, v18, v18 row_half_mirror row_mask:0xf bank_mask:0xf
    v_add_f32_dpp v19, v19, v19 row_half_mirror row_mask:0xf bank_mask:0xf
    ds_write_b128 v30, v[16:19]
    s_waitcnt lgkmcnt(0)
    s_barrier
    ds_read_b128 v[20:23], v31
    s_waitcnt lgkmcnt(0)
    v_add_f32 v16, v16, v20
    v_add_f32 v17, v17, v21
    v_add_f32 v18, v18, v22
    v_add_f32 v19, v19, v23
    v_mul_f32 v16, 0xbb000000, v16
    v_mul_f32 v18, 0xbb000000, v18
    v_mul_f32 v17, 0x3b000000, v17
    v_mul_f32 v19, 0x3b000000, v19
    v_fma_f32 v17, -v16, v16, v17
    v_fma_f32 v19, -v18, v18, v19
    v_max_f32 v17, 0, v17
    v_max_f32 v19, 0, v19
    v_add_f32 v17, 0x3727c5ac, v17
    v_add_f32 v19, 0x3727c5ac, v19
    v_rsq_f32 v20, v17
    v_rsq_f32 v22, v19
    v_mul_f32 v21, v16, v20
    v_mul_f32 v23, v18, v22
    v_pk_fma_f32 v[128:129], v[128:129], v[20:21], v[20:21] op_sel:[0,0,1] op_sel_hi:[1,0,1]
    v_pk_fma_f32 v[130:131], v[130:131], v[20:21], v[20:21] op_sel:[0,0,1] op_sel_hi:[1,0,1]
    v_pk_fma_f32 v[132:133], v[132:133], v[20:21], v[20:21] op_sel:[0,0,1] op_sel_hi:[1,0,1]
    v_pk_fma_f32 v[134:135], v[134:135], v[20:21], v[20:21] op_sel:[0,0,1] op_sel_hi:[1,0,1]
    v_pk_fma_f32 v[136:137], v[136:137], v[22:23], v[22:23] op_sel:[0,0,1] op_sel_hi:[1,0,1]
    v_pk_fma_f32 v[138:139], v[138:139], v[22:23], v[22:23] op_sel:[0,0,1] op_sel_hi:[1,0,1]
    v_pk_fma_f32 v[140:141], v[140:141], v[22:23], v[22:23] op_sel:[0,0,1] op_sel_hi:[1,0,1]
    v_pk_fma_f32 v[142:143], v[142:143], v[22:23], v[22:23] op_sel:[0,0,1] op_sel_hi:[1,0,1]
    v_pk_fma_f32 v[144:145], v[144:145], v[20:21], v[20:21] op_sel:[0,0,1] op_sel_hi:[1,0,1]
    v_pk_fma_f32 v[146:147], v[146:147], v[20:21], v[20:21] op_sel:[0,0,1] op_sel_hi:[1,0,1]
    v_pk_fma_f32 v[148:149], v[148:149], v[20:21], v[20:21] op_sel:[0,0,1] op_sel_hi:[1,0,1]
    v_pk_fma_f32 v[150:151], v[150:151], v[20:21], v[20:21] op_sel:[0,0,1] op_sel_hi:[1,0,1]
    v_pk_fma_f32 v[152:153], v[152:153], v[22:23], v[22:23] op_sel:[0,0,1] op_sel_hi:[1,0,1]
    v_pk_fma_f32 v[154:155], v[154:155], v[22:23], v[22:23] op_sel:[0,0,1] op_sel_hi:[1,0,1]
    v_pk_fma_f32 v[156:157], v[156:157], v[22:23], v[22:23] op_sel:[0,0,1] op_sel_hi:[1,0,1]
    v_pk_fma_f32 v[158:159], v[158:159], v[22:23], v[22:23] op_sel:[0,0,1] op_sel_hi:[1,0,1]
    v_pk_fma_f32 v[160:161], v[160:161], v[20:21], v[20:21] op_sel:[0,0,1] op_sel_hi:[1,0,1]
    v_pk_fma_f32 v[162:163], v[162:163], v[20:21], v[20:21] op_sel:[0,0,1] op_sel_hi:[1,0,1]
    v_pk_fma_f32 v[164:165], v[164:165], v[20:21], v[20:21] op_sel:[0,0,1] op_sel_hi:[1,0,1]
    v_pk_fma_f32 v[166:167], v[166:167], v[20:21], v[20:21] op_sel:[0,0,1] op_sel_hi:[1,0,1]
    v_pk_fma_f32 v[168:169], v[168:169], v[22:23], v[22:23] op_sel:[0,0,1] op_sel_hi:[1,0,1]
    v_pk_fma_f32 v[170:171], v[170:171], v[22:23], v[22:23] op_sel:[0,0,1] op_sel_hi:[1,0,1]
    v_pk_fma_f32 v[172:173], v[172:173], v[22:23], v[22:23] op_sel:[0,0,1] op_sel_hi:[1,0,1]
    v_pk_fma_f32 v[174:175], v[174:175], v[22:23], v[22:23] op_sel:[0,0,1] op_sel_hi:[1,0,1]
    v_pk_fma_f32 v[176:177], v[176:177], v[20:21], v[20:21] op_sel:[0,0,1] op_sel_hi:[1,0,1]
    v_pk_fma_f32 v[178:179], v[178:179], v[20:21], v[20:21] op_sel:[0,0,1] op_sel_hi:[1,0,1]
    v_pk_fma_f32 v[180:181], v[180:181], v[20:21], v[20:21] op_sel:[0,0,1] op_sel_hi:[1,0,1]
    v_pk_fma_f32 v[182:183], v[182:183], v[20:21], v[20:21] op_sel:[0,0,1] op_sel_hi:[1,0,1]
    v_pk_fma_f32 v[184:185], v[184:185], v[22:23], v[22:23] op_sel:[0,0,1] op_sel_hi:[1,0,1]
    v_pk_fma_f32 v[186:187], v[186:187], v[22:23], v[22:23] op_sel:[0,0,1] op_sel_hi:[1,0,1]
    v_pk_fma_f32 v[188:189], v[188:189], v[22:23], v[22:23] op_sel:[0,0,1] op_sel_hi:[1,0,1]
    v_pk_fma_f32 v[190:191], v[190:191], v[22:23], v[22:23] op_sel:[0,0,1] op_sel_hi:[1,0,1]
    s_barrier
    s_setprio 0
    v_and_b32 v206, 31, v4
    v_lshlrev_b32 v206, 7, v206
    buffer_load_dwordx2 v[204:205], v206, s[44:47], s89 offen sc1
    buffer_load_dword v62, v39, s[8:11], s64 offen
    buffer_load_dwordx4 v[200:203], v63, s[16:19], 0 offen
    buffer_load_dwordx2 v[224:225], v8, s[32:35], s86 offen
    buffer_load_dwordx4 v[208:211], v7, s[36:39], s85 offen nt
    s_addk_i32 s85, 6144
    buffer_load_dwordx4 v[212:215], v7, s[36:39], s85 offen nt
    s_addk_i32 s85, 6144
    buffer_load_dwordx4 v[216:219], v7, s[36:39], s85 offen nt
    s_addk_i32 s85, 6144
    buffer_load_dwordx4 v[220:223], v7, s[36:39], s85 offen nt
    s_addk_i32 s85, 6144
    s_bfe_u32 s76, s2, 0x30003
    s_and_b32 s77, s2, 6
    s_lshr_b32 s57, s2, 6
    s_lshl1_add_u32 s77, s77, s57
    s_and_b32 s57, s2, 1
    s_lshl2_add_u32 s55, s77, s57
    s_lshl1_add_u32 s77, s77, s57
    v_lshrrev_b32 v2, 4, v4
    v_and_b32 v192, 15, v4
    v_lshlrev_b32 v193, 4, v192
    v_lshrrev_b32 v194, 5, v4
    v_lshl_add_u32 v12, v194, 14, v193
    v_and_b32 v194, 1, v2
    v_lshl_add_u32 v12, v194, 8, v12
    v_and_b32 v192, 3, v4
    v_bfe_u32 v193, v4, 2, 2
    v_lshrrev_b32 v195, 5, v4
    v_lshl_add_u32 v196, v195, 2, v193
    v_lshlrev_b32 v196, 7, v196
    v_lshrrev_b32 v193, 1, v193
    v_lshl_add_u32 v196, v193, 6, v196
    v_lshl_add_u32 v196, v194, 5, v196
    v_lshl_add_u32 v196, v192, 3, v196
    s_mul_i32 s80, s52, 20480
    s_add_u32 s80, s80, 8192
    v_add_u32 v254, s80, v196
    v_xor_b32 v255, 64, v254
    v_lshrrev_b32 v196, 2, v6
    v_mul_u32_u24 v196, 5120, v196
    v_lshl_add_u32 v196, v195, 7, v196
    v_lshl_add_u32 v196, v192, 5, v196
    v_and_b32 v195, 1, v5
    v_mul_u32_u24 v195, 272, v195
    v_mul_u32_u24 v193, 640, v194
    v_add3_u32 v196, v196, v195, v193
    s_mul_i32 s57, s52, 1280
    s_add_u32 s57, s57, 8192
    v_add_u32 v252, s57, v196
    v_add_u32 v253, 10240, v252
    v_lshlrev_b32 v195, 4, v6
    v_lshl_add_u32 v13, v5, 10, v195
    s_barrier
    s_add_u32 m0, s62, 98304
    s_nop 0
    buffer_load_dwordx4 v32, s[8:11], s66 offen lds
    buffer_load_dwordx4 v33, s[8:11], s66 offen offset:1024 lds
    s_add_u32 m0, s62, 106496
    s_nop 0
    buffer_load_dwordx4 v34, s[8:11], s66 offen lds
    buffer_load_dwordx4 v35, s[8:11], s66 offen offset:1024 lds
    ds_read_b128 v[64:67], v28 offset:0
    ds_read_b128 v[68:71], v28 offset:16
    ds_read_b128 v[72:75], v28 offset:256
    ds_read_b128 v[76:79], v28 offset:272
    ds_read_b128 v[80:83], v28 offset:512
    ds_read_b128 v[84:87], v28 offset:528
    ds_read_b128 v[88:91], v28 offset:768
    ds_read_b128 v[92:95], v28 offset:784
    ds_read_b128 v[96:99], v28 offset:1024
    ds_read_b128 v[100:103], v28 offset:1040
    ds_read_b128 v[104:107], v28 offset:1280
    ds_read_b128 v[108:111], v28 offset:1296
    ds_read_b128 v[112:115], v28 offset:1536
    ds_read_b128 v[116:119], v28 offset:1552
    ds_read_b128 v[120:123], v28 offset:1792
    ds_read_b128 v[124:127], v28 offset:1808
    s_waitcnt lgkmcnt(13)
    v_pk_fma_f32 v[128:129], v[128:129], v[72:73], v[64:65]
    v_pk_fma_f32 v[130:131], v[130:131], v[74:75], v[66:67]
    s_waitcnt lgkmcnt(12)
    v_pk_fma_f32 v[132:133], v[132:133], v[76:77], v[68:69]
    v_pk_fma_f32 v[134:135], v[134:135], v[78:79], v[70:71]
    v_cvt_pk_bf16_f32 v128, v128, v129
    v_cvt_pk_bf16_f32 v129, v130, v131
    v_cvt_pk_bf16_f32 v130, v132, v133
    v_cvt_pk_bf16_f32 v131, v134, v135
    v_pk_fma_f32 v[136:137], v[136:137], v[72:73], v[64:65]
    v_pk_fma_f32 v[138:139], v[138:139], v[74:75], v[66:67]
    v_pk_fma_f32 v[140:141], v[140:141], v[76:77], v[68:69]
    v_pk_fma_f32 v[142:143], v[142:143], v[78:79], v[70:71]
    v_cvt_pk_bf16_f32 v136, v136, v137
    v_cvt_pk_bf16_f32 v137, v138, v139
    v_cvt_pk_bf16_f32 v138, v140, v141
    v_cvt_pk_bf16_f32 v139, v142, v143
    buffer_load_dword v59, v9, s[12:15], s87 offen
    s_waitcnt lgkmcnt(9)
    v_pk_fma_f32 v[144:145], v[144:145], v[88:89], v[80:81]
    v_pk_fma_f32 v[146:147], v[146:147], v[90:91], v[82:83]
    s_waitcnt lgkmcnt(8)
    v_pk_fma_f32 v[148:149], v[148:149], v[92:93], v[84:85]
    v_pk_fma_f32 v[150:151], v[150:151], v[94:95], v[86:87]
    v_cvt_pk_bf16_f32 v144, v144, v145
    v_cvt_pk_bf16_f32 v145, v146, v147
    v_cvt_pk_bf16_f32 v146, v148, v149
    v_cvt_pk_bf16_f32 v147, v150, v151
    v_pk_fma_f32 v[152:153], v[152:153], v[88:89], v[80:81]
    v_pk_fma_f32 v[154:155], v[154:155], v[90:91], v[82:83]
    v_pk_fma_f32 v[156:157], v[156:157], v[92:93], v[84:85]
    v_pk_fma_f32 v[158:159], v[158:159], v[94:95], v[86:87]
    v_cvt_pk_bf16_f32 v152, v152, v153
    v_cvt_pk_bf16_f32 v153, v154, v155
    v_cvt_pk_bf16_f32 v154, v156, v157
    v_cvt_pk_bf16_f32 v155, v158, v159
    s_waitcnt lgkmcnt(5)
    v_pk_fma_f32 v[160:161], v[160:161], v[104:105], v[96:97]
    v_pk_fma_f32 v[162:163], v[162:163], v[106:107], v[98:99]
    s_waitcnt lgkmcnt(4)
    v_pk_fma_f32 v[164:165], v[164:165], v[108:109], v[100:101]
    v_pk_fma_f32 v[166:167], v[166:167], v[110:111], v[102:103]
    v_cvt_pk_bf16_f32 v160, v160, v161
    v_cvt_pk_bf16_f32 v161, v162, v163
    v_cvt_pk_bf16_f32 v162, v164, v165
    v_cvt_pk_bf16_f32 v163, v166, v167
    v_pk_fma_f32 v[168:169], v[168:169], v[104:105], v[96:97]
    v_pk_fma_f32 v[170:171], v[170:171], v[106:107], v[98:99]
    v_pk_fma_f32 v[172:173], v[172:173], v[108:109], v[100:101]
    v_pk_fma_f32 v[174:175], v[174:175], v[110:111], v[102:103]
    v_cvt_pk_bf16_f32 v168, v168, v169
    v_cvt_pk_bf16_f32 v169, v170, v171
    v_cvt_pk_bf16_f32 v170, v172, v173
    v_cvt_pk_bf16_f32 v171, v174, v175
    s_waitcnt lgkmcnt(1)
    v_pk_fma_f32 v[176:177], v[176:177], v[120:121], v[112:113]
    v_pk_fma_f32 v[178:179], v[178:179], v[122:123], v[114:115]
    s_waitcnt lgkmcnt(0)
    v_pk_fma_f32 v[180:181], v[180:181], v[124:125], v[116:117]
    v_pk_fma_f32 v[182:183], v[182:183], v[126:127], v[118:119]
    v_cvt_pk_bf16_f32 v176, v176, v177
    v_cvt_pk_bf16_f32 v177, v178, v179
    v_cvt_pk_bf16_f32 v178, v180, v181
    v_cvt_pk_bf16_f32 v179, v182, v183
    v_pk_fma_f32 v[184:185], v[184:185], v[120:121], v[112:113]
    v_pk_fma_f32 v[186:187], v[186:187], v[122:123], v[114:115]
    v_pk_fma_f32 v[188:189], v[188:189], v[124:125], v[116:117]
    v_pk_fma_f32 v[190:191], v[190:191], v[126:127], v[118:119]
    v_cvt_pk_bf16_f32 v184, v184, v185
    v_cvt_pk_bf16_f32 v185, v186, v187
    v_cvt_pk_bf16_f32 v186, v188, v189
    v_cvt_pk_bf16_f32 v187, v190, v191
    s_lshl2_add_u32 s57, s96, s52
    s_lshl_b32 m0, s57, 13
    s_nop 0
    ds_write_addtid_b32 v128 offset:32768
    ds_write_addtid_b32 v129 offset:33024
    ds_write_addtid_b32 v130 offset:33280
    ds_write_addtid_b32 v131 offset:33536
    ds_write_addtid_b32 v136 offset:33792
    ds_write_addtid_b32 v137 offset:34048
    ds_write_addtid_b32 v138 offset:34304
    ds_write_addtid_b32 v139 offset:34560
    ds_write_addtid_b32 v144 offset:34816
    ds_write_addtid_b32 v145 offset:35072
    ds_write_addtid_b32 v146 offset:35328
    ds_write_addtid_b32 v147 offset:35584
    ds_write_addtid_b32 v152 offset:35840
    ds_write_addtid_b32 v153 offset:36096
    ds_write_addtid_b32 v154 offset:36352
    ds_write_addtid_b32 v155 offset:36608
    ds_write_addtid_b32 v160 offset:36864
    ds_write_addtid_b32 v161 offset:37120
    ds_write_addtid_b32 v162 offset:37376
    ds_write_addtid_b32 v163 offset:37632
    ds_write_addtid_b32 v168 offset:37888
    ds_write_addtid_b32 v169 offset:38144
    ds_write_addtid_b32 v170 offset:38400
    ds_write_addtid_b32 v171 offset:38656
    ds_write_addtid_b32 v176 offset:38912
    ds_write_addtid_b32 v177 offset:39168
    ds_write_addtid_b32 v178 offset:39424
    ds_write_addtid_b32 v179 offset:39680
    ds_write_addtid_b32 v184 offset:39936
    ds_write_addtid_b32 v185 offset:40192
    ds_write_addtid_b32 v186 offset:40448
    ds_write_addtid_b32 v187 offset:40704
    s_setprio 2
    s_add_u32 m0, s62, 114688
    s_nop 0
    buffer_load_dwordx4 v32, s[8:11], s67 offen lds
    buffer_load_dwordx4 v33, s[8:11], s67 offen offset:1024 lds
    s_add_u32 m0, s62, 122880
    s_nop 0
    buffer_load_dwordx4 v34, s[8:11], s67 offen lds
    buffer_load_dwordx4 v35, s[8:11], s67 offen offset:1024 lds
    s_waitcnt vmcnt(17)
    s_waitcnt lgkmcnt(0)
    s_barrier
    s_add_u32 m0, s62, 131072
    s_nop 0
    buffer_load_dwordx4 v32, s[8:11], s68 offen lds
    buffer_load_dwordx4 v33, s[8:11], s68 offen offset:1024 lds
    s_add_u32 m0, s62, 139264
    s_nop 0
    buffer_load_dwordx4 v32, s[8:11], s69 offen lds
    buffer_load_dwordx4 v33, s[8:11], s69 offen offset:1024 lds
    s_add_u32 m0, s62, 147456
    s_nop 0
    buffer_load_dwordx4 v32, s[8:11], s70 offen lds
    buffer_load_dwordx4 v33, s[8:11], s70 offen offset:1024 lds
    s_add_u32 m0, s62, 155648
    s_nop 0
    buffer_load_dwordx4 v32, s[8:11], s71 offen lds
    buffer_load_dwordx4 v33, s[8:11], s71 offen offset:1024 lds
    s_waitcnt vmcnt(8)
    s_barrier
    s_barrier
    s_add_u32 m0, s62, 0
    s_waitcnt vmcnt(7)
    buffer_load_dwordx4 v34, s[8:11], s68 offen lds
    buffer_load_dwordx4 v35, s[8:11], s68 offen offset:1024 lds
    s_add_u32 m0, s62, 8192
    s_waitcnt vmcnt(7)
    buffer_load_dwordx4 v34, s[8:11], s69 offen lds
    buffer_load_dwordx4 v35, s[8:11], s69 offen offset:1024 lds
    s_add_u32 m0, s62, 16384
    s_waitcnt vmcnt(7)
    buffer_load_dwordx4 v34, s[8:11], s70 offen lds
    buffer_load_dwordx4 v35, s[8:11], s70 offen offset:1024 lds
    s_add_u32 m0, s62, 24576
    s_waitcnt vmcnt(7)
    buffer_load_dwordx4 v34, s[8:11], s71 offen lds
    buffer_load_dwordx4 v35, s[8:11], s71 offen offset:1024 lds
    s_waitcnt vmcnt(8)
    s_barrier
    s_barrier
    s_add_u32 m0, s62, 98304
    s_waitcnt vmcnt(7)
    buffer_load_dwordx4 v10, s[8:11], s68 offen lds
    buffer_load_dwordx4 v11, s[8:11], s68 offen offset:1024 lds
    s_add_u32 m0, s62, 106496
    s_waitcnt vmcnt(7)
    buffer_load_dwordx4 v10, s[8:11], s64 offen lds
    buffer_load_dwordx4 v11, s[8:11], s64 offen offset:1024 lds
    s_add_u32 m0, s62, 114688
    s_waitcnt vmcnt(7)
    buffer_load_dwordx4 v10, s[8:11], s69 offen lds
    buffer_load_dwordx4 v11, s[8:11], s69 offen offset:1024 lds
    s_add_u32 m0, s62, 122880
    s_waitcnt vmcnt(7)
    buffer_load_dwordx4 v10, s[8:11], s65 offen lds
    buffer_load_dwordx4 v11, s[8:11], s65 offen offset:1024 lds
    s_waitcnt vmcnt(8)
    s_barrier
    s_barrier
    s_add_u32 m0, s62, 131072
    s_waitcnt vmcnt(4)
    buffer_load_dwordx4 v10, s[8:11], s70 offen lds
    buffer_load_dwordx4 v11, s[8:11], s70 offen offset:1024 lds
    s_add_u32 m0, s62, 139264
    s_waitcnt vmcnt(4)
    buffer_load_dwordx4 v10, s[8:11], s66 offen lds
    buffer_load_dwordx4 v11, s[8:11], s66 offen offset:1024 lds
    s_add_u32 m0, s62, 147456
    s_waitcnt vmcnt(4)
    buffer_load_dwordx4 v10, s[8:11], s71 offen lds
    buffer_load_dwordx4 v11, s[8:11], s71 offen offset:1024 lds
    s_add_u32 m0, s62, 155648
    s_waitcnt vmcnt(4)
    buffer_load_dwordx4 v10, s[8:11], s67 offen lds
    buffer_load_dwordx4 v11, s[8:11], s67 offen offset:1024 lds
    s_barrier
    v_mov_b32 v2, 0
    v_mov_b32 v184, 0
    v_mov_b32 v185, 0
    v_lshrrev_b32 v114, 4, v4
    v_lshlrev_b32 v114, 3, v114
    v_lshl_add_u32 v114, v6, 5, v114
    s_lshl_b32 s57, s52, 8
    s_add_u32 s57, s57, 1024
    v_add_u32 v114, s57, v114
    v_lshlrev_b32 v115, 2, v4
    v_add_u32 v116, 1024, v115
    v_and_b32 v117, 3, v4
    v_lshlrev_b32 v117, 3, v117
    v_mov_b32 v118, 0xff
    v_mov_b32 v119, 0
    s_lshr_b32 s57, s78, 6
    s_lshl_b32 s57, s57, 14
    s_and_b32 s58, s78, 31
    s_lshl_b32 s58, s58, 9
    s_add_u32 s57, s57, s58
    s_and_b32 s58, s78, 32
    s_lshl3_add_u32 s57, s58, s57
    s_add_u32 s74, s57, 4096
    s_waitcnt vmcnt(0)
    ds_write_b64 v2, v[184:185] offset:0
    s_waitcnt lgkmcnt(0)
    s_barrier
    s_cmp_eq_u32 s78, 0
    s_cbranch_scc1 L_mod2done
    s_setprio 0
    v_lshlrev_b32 v120, 16, v224
    v_and_b32 v121, 0xffff0000, v224
    v_lshlrev_b32 v122, 16, v225
    v_and_b32 v123, 0xffff0000, v225
    v_mul_f32 v124, 0xbfb8aa3b, v120
    v_mul_f32 v125, 0xbfb8aa3b, v121
    v_mul_f32 v126, 0xbfb8aa3b, v122
    v_mul_f32 v127, 0xbfb8aa3b, v123
    v_exp_f32 v124, v124
    v_exp_f32 v125, v125
    v_exp_f32 v126, v126
    v_exp_f32 v127, v127
    v_add_f32 v124, 1.0, v124
    v_add_f32 v125, 1.0, v125
    v_add_f32 v126, 1.0, v126
    v_add_f32 v127, 1.0, v127
    v_rcp_f32 v124, v124
    v_rcp_f32 v125, v125
    v_rcp_f32 v126, v126
    v_rcp_f32 v127, v127
    v_mul_f32 v120, v120, v124
    v_mul_f32 v121, v121, v125
    v_mul_f32 v122, v122, v126
    v_mul_f32 v123, v123, v127
    v_cvt_pk_bf16_f32 v128, v120, 0
    v_cvt_pk_bf16_f32 v129, 0, v120
    v_cvt_pk_bf16_f32 v130, v121, 0
    v_cvt_pk_bf16_f32 v131, 0, v121
    v_cvt_pk_bf16_f32 v132, v122, 0
    v_cvt_pk_bf16_f32 v133, 0, v122
    v_cvt_pk_bf16_f32 v134, v123, 0
    v_cvt_pk_bf16_f32 v135, 0, v123
    v_dot2_f32_bf16 v136, v208, v128, 0
    v_dot2_f32_bf16 v137, v208, v129, 0
    v_dot2_f32_bf16 v138, v209, v128, 0
    v_dot2_f32_bf16 v139, v209, v129, 0
    v_dot2_f32_bf16 v140, v210, v128, 0
    v_dot2_f32_bf16 v141, v210, v129, 0
    v_dot2_f32_bf16 v142, v211, v128, 0
    v_dot2_f32_bf16 v143, v211, v129, 0
    v_dot2_f32_bf16 v136, v212, v130, v136
    v_dot2_f32_bf16 v137, v212, v131, v137
    v_dot2_f32_bf16 v138, v213, v130, v138
    v_dot2_f32_bf16 v139, v213, v131, v139
    v_dot2_f32_bf16 v140, v214, v130, v140
    v_dot2_f32_bf16 v141, v214, v131, v141
    v_dot2_f32_bf16 v142, v215, v130, v142
    v_dot2_f32_bf16 v143, v215, v131, v143
    v_dot2_f32_bf16 v136, v216, v132, v136
    v_dot2_f32_bf16 v137, v216, v133, v137
    v_dot2_f32_bf16 v138, v217, v132, v138
    v_dot2_f32_bf16 v139, v217, v133, v139
    v_dot2_f32_bf16 v140, v218, v132, v140
    v_dot2_f32_bf16 v141, v218, v133, v141
    v_dot2_f32_bf16 v142, v219, v132, v142
    v_dot2_f32_bf16 v143, v219, v133, v143
    v_dot2_f32_bf16 v136, v220, v134, v136
    v_dot2_f32_bf16 v137, v220, v135, v137
    v_dot2_f32_bf16 v138, v221, v134, v138
    v_dot2_f32_bf16 v139, v221, v135, v139
    v_dot2_f32_bf16 v140, v222, v134, v140
    v_dot2_f32_bf16 v141, v222, v135, v141
    v_dot2_f32_bf16 v142, v223, v134, v142
    v_dot2_f32_bf16 v143, v223, v135, v143
    v_mov_b32 v120, 1
    v_lshrrev_b32 v117, v117, s56
    v_permlane32_swap_b32 v136, v140
    v_permlane32_swap_b32 v137, v141
    v_permlane32_swap_b32 v138, v142
    v_permlane32_swap_b32 v139, v143
    v_add_f32 v136, v136, v140
    v_add_f32 v137, v137, v141
    v_add_f32 v138, v138, v142
    v_add_f32 v139, v139, v143
    s_nop 0
    v_permlane16_swap_b32 v136, v138
    v_permlane16_swap_b32 v137, v139
    v_add_f32 v136, v136, v138
    v_add_f32 v137, v137, v139
    s_nop 0
    v_add_f32_dpp v136, v136, v136 row_ror:8 row_mask:0xf bank_mask:0xf
    v_add_f32_dpp v137, v137, v137 row_ror:8 row_mask:0xf bank_mask:0xf
    ds_write_b64 v114, v[136:137]
    s_mov_b64 exec, 1
    ds_add_rtn_u32 v120, v119, v120
    s_mov_b64 exec, -1
    ds_read2st64_b32 v[136:137], v116 offset0:0 offset1:1
    ds_read2st64_b32 v[138:139], v116 offset0:2 offset1:3
    s_waitcnt lgkmcnt(2)
    v_readfirstlane_b32 s58, v120
    s_waitcnt lgkmcnt(1)
    v_add_f32 v136, v136, v137
    s_waitcnt lgkmcnt(0)
    v_add_f32 v138, v138, v139
    s_cmp_lg_u32 s58, 3
    s_cselect_b32 s58, 1073741824, 0
    v_add_f32 v136, v136, v138
    v_or_b32 v115, s58, v115
    v_bfi_b32 v136, v118, v117, v136
    buffer_store_dword v136, v115, s[44:47], s74 offen sc1
    s_branch L_mod2done
L_mod2done:
    s_setprio 0
L_xb_c:
    v_cmp_ne_u32 vcc, s56, v205
    s_nop 0
    s_cmp_lg_u64 vcc, 0
    s_cbranch_scc1 L_xb_p
L_xb_o:
    v_cmp_ne_u32 vcc, s88, v204
    v_mov_b32 v2, 0
    s_cmp_eq_u64 vcc, 0
    s_cselect_b32 s101, 16777216, 0
    v_mov_b32 v204, s101
    ds_write_b32 v2, v204 offset:192
    s_lshl_b32 s83, s76, 7
    s_lshl2_add_u32 s81, s55, s52
    s_lshl_b32 s81, s81, 13
    s_add_u32 s81, s81, s83
    s_add_u32 s82, s81, 65536
    v_and_b32 v186, 2, v5
    v_lshlrev_b32 v186, 1, v186
    v_xor_b32 v186, v186, v6
    v_lshlrev_b32 v186, 4, v186
    v_lshl_add_u32 v1, v5, 10, v186
    s_and_b32 s69, s2, 1
    s_xor_b32 s69, s69, 1
    s_lshl2_add_u32 s69, s69, s52
    s_lshl_b32 s69, s69, 16
    s_add_u32 s69, s69, s83
    s_xor_b32 s71, s69, 0x40000
    s_lshr_b32 s75, s2, 3
    s_mul_i32 s75, s75, 57344
    v_mul_u32_u24 v9, 3584, v4
    v_lshrrev_b32 v2, 4, v4
    v_lshl_or_b32 v9, v2, 26, v9
    s_and_b32 s58, s2, 7
    s_mul_i32 s58, s58, 448
    s_and_b32 s58, s58, 0xff80
    s_add_u32 s75, s75, s58
    s_lshl_b32 s58, s52, 7
    s_add_u32 s75, s75, s58
    v_lshlrev_b32 v224, 16, v200
    v_and_b32 v225, 0xffff0000, v200
    v_lshlrev_b32 v226, 16, v201
    v_and_b32 v227, 0xffff0000, v201
    v_lshlrev_b32 v228, 16, v202
    v_and_b32 v229, 0xffff0000, v202
    v_lshlrev_b32 v230, 16, v203
    v_and_b32 v231, 0xffff0000, v203
    s_lshl_b32 s57, s76, 7
    s_lshl_b32 s84, s76, 11
    s_add_u32 s84, s84, 20480
    s_and_b32 s59, s2, 1
    s_xor_b32 s59, s59, 1
    s_lshl1_add_u32 s58, s55, s59
    s_lshl2_add_u32 s58, s58, s52
    s_lshl_b32 s85, s58, 12
    s_add_u32 s85, s85, 4194304
    s_add_u32 s86, s85, 65536
    s_lshl_b32 s87, s58, 10
    s_add_u32 s87, s87, 2097152
    s_add_u32 s72, s87, 16384
    s_lshl_b32 s70, s58, 10
    s_add_u32 s70, s70, 3145728
    s_lshl_b32 s88, s77, 10
    s_add_u32 s88, s88, 53248
    s_add_u32 s89, s88, s57
    s_lshl_b32 s90, s77, 13
    s_lshl_b32 s58, s52, 10
    s_add_u32 s90, s90, s58
    s_add_u32 s90, s90, 151552
    s_add_u32 s91, s90, 4096
    s_lshl4_add_u32 s92, s76, s90
    s_lshl4_add_u32 s93, s76, s91
    s_lshl2_add_u32 s58, s77, s52
    s_lshl_b32 s94, s58, 13
    s_add_u32 s94, s94, 1048576
    s_lshl_b32 s95, s77, 8
    s_add_u32 s95, s95, 86016
    v_lshrrev_b32 v2, 4, v4
    v_cmp_eq_u32 vcc, 2, v2
    v_lshlrev_b32 v10, 4, v4
    v_lshlrev_b32 v11, 2, v4
    v_cndmask_b32 v243, 0, 1.0, vcc
    v_lshlrev_b32 v14, 5, v6
    v_lshlrev_b32 v244, 7, v5
    s_lshl2_add_u32 s57, s55, s52
    s_lshl_b32 s57, s57, 3
    v_add_u32 v246, s57, v5
    v_mov_b32 v242, s56
    v_lshlrev_b32 v8, 7, v6
    v_mov_b32 v247, 0
    s_lshl1_add_u32 s57, s53, s55
    s_and_b32 s58, s55, -2
    s_sub_u32 s57, s57, s58
    s_lshl3_add_u32 s57, s57, s54
    s_lshl2_add_u32 s57, s57, s52
    s_lshl_b32 s58, s57, 10
    s_add_u32 s58, s58, 20971520
    v_lshrrev_b32 v153, 3, v4
    v_lshlrev_b32 v153, 27, v153
    v_add3_u32 v153, v153, v8, s58
    s_lshl_b32 s58, s57, 8
    s_add_u32 s58, s58, 18874368
    v_writelane_b32 v153, s58, 8
    s_addk_i32 s58, 128
    v_writelane_b32 v153, s58, 9
    s_and_b32 s58, s57, -4
    s_lshl_b32 s58, s58, 8
    s_add_u32 s58, s58, 3145728
    v_writelane_b32 v153, s58, 14
    v_and_b32 v251, 1, v4
    v_lshlrev_b32 v251, 14, v251
    s_add_u32 s58, s90, s83
    v_writelane_b32 v153, s58, 10
    s_add_u32 s58, s91, s83
    v_writelane_b32 v153, s58, 11
    v_and_b32 v191, 3, v6
    v_lshlrev_b32 v191, 8, v191
    v_lshrrev_b32 v2, 2, v6
    v_lshl_add_u32 v191, v2, 14, v191
    s_lshl_b32 s57, s2, 5
    s_and_b32 s57, s57, 0x1f00
    s_add_u32 s57, s57, 86016
    v_writelane_b32 v153, s57, 13
    s_and_b32 s64, s2, 7
    s_lshr_b32 s57, s2, 6
    s_lshl2_add_u32 s64, s64, s57
    s_lshl_b32 s65, s76, 5
    s_add_u32 s65, s65, s64
    s_lshl_b32 s65, s65, 4
    s_lshl2_add_u32 s57, s57, s52
    s_mul_i32 s57, s57, 28672
    s_add_u32 s57, s57, s65
    s_add_u32 s57, s57, 348160
    s_waitcnt lgkmcnt(0)
    s_barrier
    s_setprio 2
    s_waitcnt vmcnt(8)
    s_add_u32 m0, s80, 0
    s_nop 0
    buffer_load_dwordx4 v1, s[12:15], s69 offen lds
    s_addk_i32 s69, 8192
    s_waitcnt vmcnt(8)
    s_add_u32 m0, s80, 1024
    s_nop 0
    buffer_load_dwordx4 v1, s[12:15], s69 offen lds
    s_addk_i32 s69, 8192
    s_waitcnt vmcnt(8)
    s_add_u32 m0, s80, 2048
    s_nop 0
    buffer_load_dwordx4 v1, s[12:15], s69 offen lds
    s_addk_i32 s69, 8192
    s_waitcnt vmcnt(8)
    s_add_u32 m0, s80, 3072
    s_nop 0
    buffer_load_dwordx4 v1, s[12:15], s69 offen lds
    s_addk_i32 s69, 8192
    s_waitcnt vmcnt(8)
    s_add_u32 m0, s80, 4096
    s_nop 0
    buffer_load_dwordx4 v1, s[12:15], s69 offen lds
    s_addk_i32 s69, 8192
    s_waitcnt vmcnt(8)
    s_add_u32 m0, s80, 5120
    s_nop 0
    buffer_load_dwordx4 v1, s[12:15], s69 offen lds
    s_addk_i32 s69, 8192
    s_waitcnt vmcnt(8)
    s_add_u32 m0, s80, 6144
    s_nop 0
    buffer_load_dwordx4 v1, s[12:15], s69 offen lds
    s_addk_i32 s69, 8192
    s_waitcnt vmcnt(8)
    s_add_u32 m0, s80, 7168
    s_nop 0
    buffer_load_dwordx4 v1, s[12:15], s69 offen lds
    s_addk_i32 s69, 8192
    s_waitcnt vmcnt(8)
    s_add_u32 m0, s80, 8192
    s_nop 0
    buffer_load_dwordx4 v1, s[12:15], s71 offen lds
    s_addk_i32 s71, 8192
    s_waitcnt vmcnt(8)
    s_add_u32 m0, s80, 9216
    s_nop 0
    buffer_load_dwordx4 v1, s[12:15], s71 offen lds
    s_addk_i32 s71, 8192
    s_waitcnt vmcnt(8)
    s_add_u32 m0, s80, 10240
    s_nop 0
    buffer_load_dwordx4 v1, s[12:15], s71 offen lds
    s_addk_i32 s71, 8192
    s_waitcnt vmcnt(8)
    s_add_u32 m0, s80, 11264
    s_nop 0
    buffer_load_dwordx4 v1, s[12:15], s71 offen lds
    s_addk_i32 s71, 8192
    s_waitcnt vmcnt(8)
    s_add_u32 m0, s80, 12288
    s_nop 0
    buffer_load_dwordx4 v1, s[12:15], s71 offen lds
    s_addk_i32 s71, 8192
    s_waitcnt vmcnt(8)
    s_add_u32 m0, s80, 13312
    s_nop 0
    buffer_load_dwordx4 v1, s[12:15], s71 offen lds
    s_addk_i32 s71, 8192
    s_waitcnt vmcnt(8)
    s_add_u32 m0, s80, 14336
    s_nop 0
    buffer_load_dwordx4 v1, s[12:15], s71 offen lds
    s_addk_i32 s71, 8192
    s_waitcnt vmcnt(8)
    s_add_u32 m0, s80, 15360
    s_nop 0
    buffer_load_dwordx4 v1, s[12:15], s71 offen lds
    s_addk_i32 s71, 8192
    s_waitcnt vmcnt(6)
    buffer_load_dwordx4 v[160:163], v12, s[44:47], s84 offen offset:0 sc1
    buffer_load_dwordx4 v[164:167], v12, s[44:47], s84 offen offset:512 sc1
    buffer_load_dwordx4 v[168:171], v12, s[44:47], s84 offen offset:1024 sc1
    buffer_load_dwordx4 v[172:175], v12, s[44:47], s84 offen offset:1536 sc1
    s_waitcnt vmcnt(5)
    buffer_load_dword v153, v153, s[44:47], 0 offen sc1
    buffer_load_dword v158, v9, s[20:23], s75 offen
    buffer_load_dword v159, v9, s[24:27], s75 offen
    s_xor_b32 s68, s85, 16384
    s_xor_b32 s69, s86, 16384
    s_xor_b32 s71, s87, 4096
    s_xor_b32 s73, s72, 4096
    s_add_u32 s68, s68, s101
    s_add_u32 s69, s69, s101
    s_add_u32 s71, s71, s101
    s_add_u32 s73, s73, s101
    s_mov_b32 s62, 0xffff0000
    v_sub_u32 v124, 2047, v246
    v_lshlrev_b32 v124, 1, v124
    v_and_b32 v125, 4, v6
    v_lshl_add_u32 v244, v125, 10, v244
    v_lshlrev_b32 v125, 5, v125
    v_sub_u32 v124, v124, v125
    s_cmp_lg_u32 s76, 7
    s_cselect_b32 s60, 1073741824, 0
    v_mov_b32 v9, s60
    v_mov_b32 v126, 1073741824
    v_mov_b32 v127, 4096
    s_lshl_b32 s60, s52, 3
    v_mov_b32 v121, s60
    v_mov_b32 v122, 1
    v_and_b32 v123, 3, v4
    v_lshlrev_b32 v7, 4, v123
    v_lshlrev_b32 v123, 3, v123
    v_lshl_add_u32 v3, v6, 4, s83
    v_lshlrev_b32 v245, 1, v3
    v_lshrrev_b32 v2, 2, v6
    v_lshl_add_u32 v7, v2, 2, v7
    s_lshr_b32 s60, s76, 1
    s_lshl_b32 s60, s60, 6
    s_and_b32 s61, s76, 1
    s_lshl3_add_u32 s60, s61, s60
    v_add_u32 v7, s60, v7
    s_waitcnt vmcnt(7)
    ds_read_b64_tr_b16 v[16:17], v254 offset:0
    ds_read_b64_tr_b16 v[18:19], v254 offset:1024
    ds_read_b64_tr_b16 v[20:21], v255 offset:0
    ds_read_b64_tr_b16 v[22:23], v255 offset:1024
    ds_read_b64_tr_b16 v[24:25], v254 offset:2048
    ds_read_b64_tr_b16 v[26:27], v254 offset:3072
    ds_read_b64_tr_b16 v[28:29], v255 offset:2048
    ds_read_b64_tr_b16 v[30:31], v255 offset:3072
    ds_read_b64_tr_b16 v[32:33], v254 offset:4096
    ds_read_b64_tr_b16 v[34:35], v254 offset:5120
    ds_read_b64_tr_b16 v[36:37], v255 offset:4096
    ds_read_b64_tr_b16 v[38:39], v255 offset:5120
    ds_read_b64_tr_b16 v[40:41], v254 offset:6144
    ds_read_b64_tr_b16 v[42:43], v254 offset:7168
    ds_read_b64_tr_b16 v[44:45], v255 offset:6144
    ds_read_b64_tr_b16 v[46:47], v255 offset:7168
    ds_read_b64_tr_b16 v[48:49], v254 offset:8192
    ds_read_b64_tr_b16 v[50:51], v254 offset:9216
    ds_read_b64_tr_b16 v[52:53], v255 offset:8192
    ds_read_b64_tr_b16 v[54:55], v255 offset:9216
    ds_read_b64_tr_b16 v[56:57], v254 offset:10240
    ds_read_b64_tr_b16 v[58:59], v254 offset:11264
    ds_read_b64_tr_b16 v[60:61], v255 offset:10240
    ds_read_b64_tr_b16 v[62:63], v255 offset:11264
    ds_read_b64_tr_b16 v[64:65], v254 offset:12288
    ds_read_b64_tr_b16 v[66:67], v254 offset:13312
    ds_read_b64_tr_b16 v[68:69], v255 offset:12288
    ds_read_b64_tr_b16 v[70:71], v255 offset:13312
    ds_read_b64_tr_b16 v[72:73], v254 offset:14336
    ds_read_b64_tr_b16 v[74:75], v254 offset:15360
    ds_read_b64_tr_b16 v[76:77], v255 offset:14336
    ds_read_b64_tr_b16 v[78:79], v255 offset:15360
    s_waitcnt vmcnt(3)
L_b2_c:
    v_xor_b32 v160, s0, v160
    v_xor_b32 v161, s98, v161
    v_or_b32 v2, v160, v161
    v_xor_b32 v162, s99, v162
    v_xor_b32 v163, s3, v163
    v_or3_b32 v2, v162, v163, v2
    v_xor_b32 v164, s0, v164
    v_xor_b32 v165, s98, v165
    v_or3_b32 v2, v164, v165, v2
    v_xor_b32 v166, s99, v166
    v_xor_b32 v167, s3, v167
    v_or3_b32 v2, v166, v167, v2
    v_xor_b32 v168, s0, v168
    v_xor_b32 v169, s98, v169
    v_or3_b32 v2, v168, v169, v2
    v_xor_b32 v170, s99, v170
    v_xor_b32 v171, s3, v171
    v_or3_b32 v2, v170, v171, v2
    v_xor_b32 v172, s0, v172
    v_xor_b32 v173, s98, v173
    v_or3_b32 v2, v172, v173, v2
    v_xor_b32 v174, s99, v174
    v_xor_b32 v175, s3, v175
    v_or3_b32 v2, v174, v175, v2
    v_and_b32 v2, 0xff, v2
    v_cmp_ne_u32 vcc, 0, v2
    s_nop 0
    s_cmp_lg_u64 vcc, 0
    s_cbranch_scc1 L_b2_p
L_b2_o:
    buffer_load_dword v120, v191, s[44:47], s70 offen sc1
    v_pk_add_f32 v[160:161], v[160:161], v[164:165]
    v_pk_add_f32 v[168:169], v[168:169], v[172:173]
    v_pk_add_f32 v[162:163], v[162:163], v[166:167]
    v_pk_add_f32 v[170:171], v[170:171], v[174:175]
    v_pk_add_f32 v[160:161], v[160:161], v[168:169]
    v_pk_add_f32 v[162:163], v[162:163], v[170:171]
    v_cvt_pk_bf16_f32 v164, v160, v161
    v_cvt_pk_bf16_f32 v165, v162, v163
    v_lshlrev_b32 v160, 16, v164
    v_and_b32 v161, 0xffff0000, v164
    v_lshlrev_b32 v162, 16, v165
    v_and_b32 v163, 0xffff0000, v165
    v_add_f32 v160, v160, v243
    v_add_f32 v161, v161, v243
    v_add_f32 v162, v162, v243
    v_add_f32 v163, v163, v243
    v_cvt_pk_bf16_f32 v164, v160, v161
    v_cvt_pk_bf16_f32 v165, v162, v163
    v_lshlrev_b32 v160, 16, v164
    v_and_b32 v161, 0xffff0000, v164
    v_lshlrev_b32 v162, 16, v165
    v_and_b32 v163, 0xffff0000, v165
    ds_write_b128 v10, v[160:163] offset:2048
    ds_read_b128 v[200:203], v14 offset:2304
    ds_read_b128 v[204:207], v14 offset:2320
    ds_read_b128 v[208:211], v14 offset:2560
    ds_read_b128 v[212:215], v14 offset:2576
    s_waitcnt lgkmcnt(3)
    v_mul_f32 v241, v200, v224
    v_fmac_f32 v241, v201, v225
    v_fmac_f32 v241, v202, v226
    v_fmac_f32 v241, v203, v227
    s_waitcnt lgkmcnt(2)
    v_fmac_f32 v241, v204, v228
    v_fmac_f32 v241, v205, v229
    v_fmac_f32 v241, v206, v230
    v_fmac_f32 v241, v207, v231
    s_waitcnt lgkmcnt(1)
    v_mul_f32 v224, v224, v208
    v_mul_f32 v225, v225, v209
    v_mul_f32 v226, v226, v210
    v_mul_f32 v227, v227, v211
    s_waitcnt lgkmcnt(0)
    v_mul_f32 v228, v228, v212
    v_mul_f32 v229, v229, v213
    v_mul_f32 v230, v230, v214
    v_mul_f32 v231, v231, v215
    v_add_f32 v240, v224, v225
    v_add_f32 v240, v240, v226
    v_add_f32 v240, v240, v227
    v_add_f32 v240, v240, v228
    v_add_f32 v240, v240, v229
    v_add_f32 v240, v240, v230
    v_add_f32 v240, v240, v231
    s_nop 1
    v_add_f32_dpp v240, v240, v240 quad_perm:[1,0,3,2] row_mask:0xf bank_mask:0xf
    v_add_f32_dpp v241, v241, v241 quad_perm:[1,0,3,2] row_mask:0xf bank_mask:0xf
    s_nop 0
    v_add_f32_dpp v240, v240, v240 quad_perm:[2,3,0,1] row_mask:0xf bank_mask:0xf
    v_add_f32_dpp v241, v241, v241 quad_perm:[2,3,0,1] row_mask:0xf bank_mask:0xf
    s_nop 0
    v_add_f32_dpp v240, v240, v240 row_half_mirror row_mask:0xf bank_mask:0xf
    v_add_f32_dpp v241, v241, v241 row_half_mirror row_mask:0xf bank_mask:0xf
    buffer_store_dwordx3 v[240:242], v247, s[44:47], s89 offen sc1
    s_waitcnt vmcnt(1)
L_f0_c:
    v_cmp_ne_u32 vcc, s56, v120
    s_nop 0
    s_cmp_lg_u64 vcc, 0
    s_cbranch_scc1 L_f0_p
L_f0_o:
    buffer_load_dword v112, v11, s[44:47], s87 offen offset:0 sc1
    buffer_load_dwordx4 v[80:83], v10, s[44:47], s85 offen offset:0 sc1
    buffer_load_dword v113, v11, s[44:47], s87 offen offset:256 sc1
    buffer_load_dwordx4 v[84:87], v10, s[44:47], s85 offen offset:1024 sc1
    buffer_load_dword v114, v11, s[44:47], s87 offen offset:512 sc1
    buffer_load_dwordx4 v[88:91], v10, s[44:47], s85 offen offset:2048 sc1
    buffer_load_dword v115, v11, s[44:47], s87 offen offset:768 sc1
    buffer_load_dwordx4 v[92:95], v10, s[44:47], s85 offen offset:3072 sc1
    buffer_load_dword v116, v11, s[44:47], s72 offen offset:0 sc1
    buffer_load_dwordx4 v[96:99], v10, s[44:47], s86 offen offset:0 sc1
    buffer_load_dword v117, v11, s[44:47], s72 offen offset:256 sc1
    buffer_load_dwordx4 v[100:103], v10, s[44:47], s86 offen offset:1024 sc1
    buffer_load_dword v118, v11, s[44:47], s72 offen offset:512 sc1
    buffer_load_dwordx4 v[104:107], v10, s[44:47], s86 offen offset:2048 sc1
    buffer_load_dword v119, v11, s[44:47], s72 offen offset:768 sc1
    buffer_load_dwordx4 v[108:111], v10, s[44:47], s86 offen offset:3072 sc1
L_o0_c:
    s_waitcnt vmcnt(14)
    v_add3_u32 v120, v80, v81, s56
    v_add3_u32 v120, v82, v83, v120
    v_xor_b32 v2, v120, v112
    s_waitcnt vmcnt(12)
    v_add3_u32 v120, v84, v85, s56
    v_add3_u32 v120, v86, v87, v120
    v_bitop3_b32 v2, v2, v120, v113 bitop3:0xf6
    s_waitcnt vmcnt(10)
    v_add3_u32 v120, v88, v89, s56
    v_add3_u32 v120, v90, v91, v120
    v_bitop3_b32 v2, v2, v120, v114 bitop3:0xf6
    s_waitcnt vmcnt(8)
    v_add3_u32 v120, v92, v93, s56
    v_add3_u32 v120, v94, v95, v120
    v_bitop3_b32 v2, v2, v120, v115 bitop3:0xf6
    s_waitcnt vmcnt(6)
    v_add3_u32 v120, v96, v97, s56
    v_add3_u32 v120, v98, v99, v120
    v_bitop3_b32 v2, v2, v120, v116 bitop3:0xf6
    s_waitcnt vmcnt(4)
    v_add3_u32 v120, v100, v101, s56
    v_add3_u32 v120, v102, v103, v120
    v_bitop3_b32 v2, v2, v120, v117 bitop3:0xf6
    s_waitcnt vmcnt(2)
    v_add3_u32 v120, v104, v105, s56
    v_add3_u32 v120, v106, v107, v120
    v_bitop3_b32 v2, v2, v120, v118 bitop3:0xf6
    s_waitcnt vmcnt(0)
    v_add3_u32 v120, v108, v109, s56
    v_add3_u32 v120, v110, v111, v120
    v_bitop3_b32 v2, v2, v120, v119 bitop3:0xf6
    v_cmp_ne_u32 vcc, 0, v2
    s_nop 0
    s_cmp_lg_u64 vcc, 0
    s_cbranch_scc1 L_o0_p
L_o0_o:
    s_barrier
    v_mfma_f32_32x32x16_bf16 v[128:143], v[80:83], v[16:19], 0
    v_mfma_f32_32x32x16_bf16 v[128:143], v[84:87], v[24:27], v[128:143]
    v_mfma_f32_32x32x16_bf16 v[128:143], v[88:91], v[32:35], v[128:143]
    v_mfma_f32_32x32x16_bf16 v[128:143], v[92:95], v[40:43], v[128:143]
    buffer_load_dwordx4 v[232:235], v10, s[44:47], s71 offen sc1
    v_mfma_f32_32x32x16_bf16 v[144:159], v[80:83], v[20:23], 0
    buffer_load_dwordx4 v[192:195], v10, s[44:47], s68 offen offset:0 sc1
    v_mfma_f32_32x32x16_bf16 v[144:159], v[84:87], v[28:31], v[144:159]
    buffer_load_dwordx4 v[196:199], v10, s[44:47], s68 offen offset:1024 sc1
    v_mfma_f32_32x32x16_bf16 v[144:159], v[88:91], v[36:39], v[144:159]
    buffer_load_dwordx4 v[200:203], v10, s[44:47], s68 offen offset:2048 sc1
    v_mfma_f32_32x32x16_bf16 v[144:159], v[92:95], v[44:47], v[144:159]
    buffer_load_dwordx4 v[204:207], v10, s[44:47], s68 offen offset:3072 sc1
    v_mfma_f32_32x32x16_bf16 v[160:175], v[96:99], v[16:19], 0
    buffer_load_dwordx4 v[236:239], v10, s[44:47], s73 offen sc1
    v_mfma_f32_32x32x16_bf16 v[160:175], v[100:103], v[24:27], v[160:175]
    buffer_load_dwordx4 v[208:211], v10, s[44:47], s69 offen offset:0 sc1
    v_mfma_f32_32x32x16_bf16 v[160:175], v[104:107], v[32:35], v[160:175]
    buffer_load_dwordx4 v[212:215], v10, s[44:47], s69 offen offset:1024 sc1
    v_mfma_f32_32x32x16_bf16 v[160:175], v[108:111], v[40:43], v[160:175]
    buffer_load_dwordx4 v[216:219], v10, s[44:47], s69 offen offset:2048 sc1
    v_mfma_f32_32x32x16_bf16 v[176:191], v[96:99], v[20:23], 0
    buffer_load_dwordx4 v[220:223], v10, s[44:47], s69 offen offset:3072 sc1
    v_mfma_f32_32x32x16_bf16 v[176:191], v[100:103], v[28:31], v[176:191]
    buffer_load_dwordx4 v[112:115], v13, s[4:7], s81 offen
    v_mfma_f32_32x32x16_bf16 v[176:191], v[104:107], v[36:39], v[176:191]
    buffer_load_dwordx4 v[116:119], v13, s[4:7], s82 offen
    v_mfma_f32_32x32x16_bf16 v[176:191], v[108:111], v[44:47], v[176:191]
L_o1_c:
    s_waitcnt vmcnt(10)
    v_add3_u32 v120, v192, v193, s56
    v_add3_u32 v120, v194, v195, v120
    v_xor_b32 v2, v120, v232
    s_waitcnt vmcnt(9)
    v_add3_u32 v120, v196, v197, s56
    v_add3_u32 v120, v198, v199, v120
    v_bitop3_b32 v2, v2, v120, v233 bitop3:0xf6
    s_waitcnt vmcnt(8)
    v_add3_u32 v120, v200, v201, s56
    v_add3_u32 v120, v202, v203, v120
    v_bitop3_b32 v2, v2, v120, v234 bitop3:0xf6
    s_waitcnt vmcnt(7)
    v_add3_u32 v120, v204, v205, s56
    v_add3_u32 v120, v206, v207, v120
    v_bitop3_b32 v2, v2, v120, v235 bitop3:0xf6
    s_waitcnt vmcnt(5)
    v_add3_u32 v120, v208, v209, s56
    v_add3_u32 v120, v210, v211, v120
    v_bitop3_b32 v2, v2, v120, v236 bitop3:0xf6
    s_waitcnt vmcnt(4)
    v_add3_u32 v120, v212, v213, s56
    v_add3_u32 v120, v214, v215, v120
    v_bitop3_b32 v2, v2, v120, v237 bitop3:0xf6
    s_waitcnt vmcnt(3)
    v_add3_u32 v120, v216, v217, s56
    v_add3_u32 v120, v218, v219, v120
    v_bitop3_b32 v2, v2, v120, v238 bitop3:0xf6
    s_waitcnt vmcnt(2)
    v_add3_u32 v120, v220, v221, s56
    v_add3_u32 v120, v222, v223, v120
    v_bitop3_b32 v2, v2, v120, v239 bitop3:0xf6
    v_cmp_ne_u32 vcc, 0, v2
    s_nop 0
    s_cmp_lg_u64 vcc, 0
    s_cbranch_scc1 L_o1_p
L_o1_o:
    buffer_load_dwordx3 v[240:242], v8, s[44:47], s88 offen sc1
    s_barrier
    v_mfma_f32_32x32x16_bf16 v[128:143], v[192:195], v[48:51], v[128:143]
    v_mfma_f32_32x32x16_bf16 v[128:143], v[196:199], v[56:59], v[128:143]
    v_mfma_f32_32x32x16_bf16 v[128:143], v[200:203], v[64:67], v[128:143]
    s_mul_i32 m0, s52, 20480
    v_mov_b32 v11, 0xff
    s_waitcnt vmcnt(2)
    v_lshlrev_b32 v80, 16, v112
    v_and_b32 v81, 0xffff0000, v112
    v_lshlrev_b32 v82, 16, v113
    v_mfma_f32_32x32x16_bf16 v[128:143], v[204:207], v[72:75], v[128:143]
    v_and_b32 v83, 0xffff0000, v113
    v_lshlrev_b32 v84, 16, v114
    v_and_b32 v85, 0xffff0000, v114
    v_lshlrev_b32 v86, 16, v115
    v_and_b32 v87, 0xffff0000, v115
    v_mfma_f32_32x32x16_bf16 v[144:159], v[192:195], v[52:55], v[144:159]
    s_waitcnt vmcnt(1)
    v_lshlrev_b32 v88, 16, v116
    v_and_b32 v89, 0xffff0000, v116
    v_lshlrev_b32 v90, 16, v117
    v_and_b32 v91, 0xffff0000, v117
    v_lshlrev_b32 v92, 16, v118
    v_mfma_f32_32x32x16_bf16 v[144:159], v[196:199], v[60:63], v[144:159]
    v_and_b32 v93, 0xffff0000, v118
    v_lshlrev_b32 v94, 16, v119
    v_and_b32 v95, 0xffff0000, v119
    v_mfma_f32_32x32x16_bf16 v[144:159], v[200:203], v[68:71], v[144:159]
    ds_write_addtid_b32 v128 offset:8192
    ds_write_addtid_b32 v129 offset:8464
    ds_write_addtid_b32 v130 offset:8832
    ds_write_addtid_b32 v131 offset:9104
    v_mfma_f32_32x32x16_bf16 v[144:159], v[204:207], v[76:79], v[144:159]
    ds_write_addtid_b32 v132 offset:9472
    ds_write_addtid_b32 v133 offset:9744
    ds_write_addtid_b32 v134 offset:10112
    ds_write_addtid_b32 v135 offset:10384
    v_mfma_f32_32x32x16_bf16 v[160:175], v[208:211], v[48:51], v[160:175]
    ds_write_addtid_b32 v136 offset:10752
    ds_write_addtid_b32 v137 offset:11024
    ds_write_addtid_b32 v138 offset:11392
    ds_write_addtid_b32 v139 offset:11664
    v_mfma_f32_32x32x16_bf16 v[160:175], v[212:215], v[56:59], v[160:175]
    ds_write_addtid_b32 v140 offset:12032
    ds_write_addtid_b32 v141 offset:12304
    ds_write_addtid_b32 v142 offset:12672
    ds_write_addtid_b32 v143 offset:12944
    v_mfma_f32_32x32x16_bf16 v[160:175], v[216:219], v[64:67], v[160:175]
    ds_write_addtid_b32 v144 offset:13312
    ds_write_addtid_b32 v145 offset:13584
    ds_write_addtid_b32 v146 offset:13952
    ds_write_addtid_b32 v147 offset:14224
    v_mfma_f32_32x32x16_bf16 v[160:175], v[220:223], v[72:75], v[160:175]
    ds_write_addtid_b32 v148 offset:14592
    ds_write_addtid_b32 v149 offset:14864
    ds_write_addtid_b32 v150 offset:15232
    ds_write_addtid_b32 v151 offset:15504
    v_mfma_f32_32x32x16_bf16 v[176:191], v[208:211], v[52:55], v[176:191]
    ds_write_addtid_b32 v152 offset:15872
    ds_write_addtid_b32 v153 offset:16144
    ds_write_addtid_b32 v154 offset:16512
    ds_write_addtid_b32 v155 offset:16784
    v_mfma_f32_32x32x16_bf16 v[176:191], v[212:215], v[60:63], v[176:191]
    ds_write_addtid_b32 v156 offset:17152
    ds_write_addtid_b32 v157 offset:17424
    ds_write_addtid_b32 v158 offset:17792
    ds_write_addtid_b32 v159 offset:18064
    v_mfma_f32_32x32x16_bf16 v[176:191], v[216:219], v[68:71], v[176:191]
    ds_write_addtid_b32 v160 offset:18432
    ds_write_addtid_b32 v161 offset:18704
    ds_write_addtid_b32 v162 offset:19072
    ds_write_addtid_b32 v163 offset:19344
    v_mfma_f32_32x32x16_bf16 v[176:191], v[220:223], v[76:79], v[176:191]
    ds_write_addtid_b32 v164 offset:19712
    ds_write_addtid_b32 v165 offset:19984
    ds_write_addtid_b32 v166 offset:20352
    ds_write_addtid_b32 v167 offset:20624
    ds_write_addtid_b32 v168 offset:20992
    ds_write_addtid_b32 v169 offset:21264
    ds_write_addtid_b32 v170 offset:21632
    ds_write_addtid_b32 v171 offset:21904
    ds_write_addtid_b32 v172 offset:22272
    ds_write_addtid_b32 v173 offset:22544
    ds_write_addtid_b32 v174 offset:22912
    ds_write_addtid_b32 v175 offset:23184
    ds_read_b128 v[200:203], v14 offset:2304
    ds_read_b128 v[204:207], v14 offset:2320
    ds_read_b128 v[208:211], v14 offset:2560
    ds_read_b128 v[212:215], v14 offset:2576
    ds_read_b128 v[192:195], v14 offset:2048
    ds_read_b128 v[196:199], v14 offset:2064
    ds_read_b128 v[216:219], v14 offset:2816
    ds_read_b128 v[220:223], v14 offset:2832
    ds_write_addtid_b32 v176 offset:23552
    ds_write_addtid_b32 v177 offset:23824
    ds_write_addtid_b32 v178 offset:24192
    ds_write_addtid_b32 v179 offset:24464
    ds_write_addtid_b32 v180 offset:24832
    ds_write_addtid_b32 v181 offset:25104
    ds_write_addtid_b32 v182 offset:25472
    ds_write_addtid_b32 v183 offset:25744
    ds_write_addtid_b32 v184 offset:26112
    ds_write_addtid_b32 v185 offset:26384
    ds_write_addtid_b32 v186 offset:26752
    ds_write_addtid_b32 v187 offset:27024
    ds_write_addtid_b32 v188 offset:27392
    ds_write_addtid_b32 v189 offset:27664
    ds_write_addtid_b32 v190 offset:28032
    ds_write_addtid_b32 v191 offset:28304
    s_waitcnt lgkmcnt(0)
    s_barrier
    ds_read_b128 v[16:19], v252 offset:0
    ds_read_b128 v[20:23], v252 offset:16
    ds_read_b128 v[24:27], v252 offset:20480
    ds_read_b128 v[28:31], v252 offset:20496
    ds_read_b128 v[32:35], v252 offset:40960
    ds_read_b128 v[36:39], v252 offset:40976
    ds_read_b128 v[40:43], v252 offset:61440
    ds_read_b128 v[44:47], v252 offset:61456
    ds_read_b128 v[48:51], v253 offset:0
    ds_read_b128 v[52:55], v253 offset:16
    ds_read_b128 v[56:59], v253 offset:20480
    ds_read_b128 v[60:63], v253 offset:20496
    ds_read_b128 v[64:67], v253 offset:40960
    ds_read_b128 v[68:71], v253 offset:40976
    ds_read_b128 v[72:75], v253 offset:61440
    ds_read_b128 v[76:79], v253 offset:61456
    s_waitcnt lgkmcnt(13)
    v_pk_add_f32 v[16:17], v[16:17], v[24:25]
    v_pk_add_f32 v[18:19], v[18:19], v[26:27]
    s_waitcnt lgkmcnt(12)
    v_pk_add_f32 v[20:21], v[20:21], v[28:29]
    v_pk_add_f32 v[22:23], v[22:23], v[30:31]
    s_waitcnt lgkmcnt(9)
    v_pk_add_f32 v[32:33], v[32:33], v[40:41]
    v_pk_add_f32 v[34:35], v[34:35], v[42:43]
    s_waitcnt lgkmcnt(8)
    v_pk_add_f32 v[36:37], v[36:37], v[44:45]
    v_pk_add_f32 v[38:39], v[38:39], v[46:47]
    v_pk_add_f32 v[16:17], v[16:17], v[32:33]
    v_pk_add_f32 v[18:19], v[18:19], v[34:35]
    v_pk_add_f32 v[20:21], v[20:21], v[36:37]
    v_pk_add_f32 v[22:23], v[22:23], v[38:39]
    v_pk_fma_f32 v[80:81], v[16:17], v[192:193], v[80:81]
    v_pk_fma_f32 v[82:83], v[18:19], v[194:195], v[82:83]
    v_pk_fma_f32 v[84:85], v[20:21], v[196:197], v[84:85]
    v_pk_fma_f32 v[86:87], v[22:23], v[198:199], v[86:87]
    v_pk_add_f32 v[96:97], v[80:81], v[82:83]
    v_pk_mul_f32 v[98:99], v[80:81], v[80:81]
    v_pk_mul_f32 v[100:101], v[80:81], v[224:225]
    v_pk_fma_f32 v[98:99], v[82:83], v[82:83], v[98:99]
    v_pk_fma_f32 v[100:101], v[82:83], v[226:227], v[100:101]
    v_pk_add_f32 v[96:97], v[96:97], v[84:85]
    v_pk_fma_f32 v[98:99], v[84:85], v[84:85], v[98:99]
    v_pk_fma_f32 v[100:101], v[84:85], v[228:229], v[100:101]
    v_pk_add_f32 v[96:97], v[96:97], v[86:87]
    v_pk_fma_f32 v[98:99], v[86:87], v[86:87], v[98:99]
    v_pk_fma_f32 v[100:101], v[86:87], v[230:231], v[100:101]
    v_add_f32 v96, v96, v97
    v_add_f32 v97, v98, v99
    v_add_f32 v98, v100, v101
    s_waitcnt lgkmcnt(5)
    v_pk_add_f32 v[48:49], v[48:49], v[56:57]
    v_pk_add_f32 v[50:51], v[50:51], v[58:59]
    s_waitcnt lgkmcnt(4)
    v_pk_add_f32 v[52:53], v[52:53], v[60:61]
    v_pk_add_f32 v[54:55], v[54:55], v[62:63]
    s_waitcnt lgkmcnt(1)
    v_pk_add_f32 v[64:65], v[64:65], v[72:73]
    v_pk_add_f32 v[66:67], v[66:67], v[74:75]
    s_waitcnt lgkmcnt(0)
    v_pk_add_f32 v[68:69], v[68:69], v[76:77]
    v_pk_add_f32 v[70:71], v[70:71], v[78:79]
    v_pk_add_f32 v[48:49], v[48:49], v[64:65]
    v_pk_add_f32 v[50:51], v[50:51], v[66:67]
    v_pk_add_f32 v[52:53], v[52:53], v[68:69]
    v_pk_add_f32 v[54:55], v[54:55], v[70:71]
    v_pk_fma_f32 v[88:89], v[48:49], v[192:193], v[88:89]
    v_pk_fma_f32 v[90:91], v[50:51], v[194:195], v[90:91]
    v_pk_fma_f32 v[92:93], v[52:53], v[196:197], v[92:93]
    v_pk_fma_f32 v[94:95], v[54:55], v[198:199], v[94:95]
    v_pk_add_f32 v[104:105], v[88:89], v[90:91]
    v_pk_mul_f32 v[106:107], v[88:89], v[88:89]
    v_pk_mul_f32 v[108:109], v[88:89], v[224:225]
    v_pk_fma_f32 v[106:107], v[90:91], v[90:91], v[106:107]
    v_pk_fma_f32 v[108:109], v[90:91], v[226:227], v[108:109]
    v_pk_add_f32 v[104:105], v[104:105], v[92:93]
    v_pk_fma_f32 v[106:107], v[92:93], v[92:93], v[106:107]
    v_pk_fma_f32 v[108:109], v[92:93], v[228:229], v[108:109]
    v_pk_add_f32 v[104:105], v[104:105], v[94:95]
    v_pk_fma_f32 v[106:107], v[94:95], v[94:95], v[106:107]
    v_pk_fma_f32 v[108:109], v[94:95], v[230:231], v[108:109]
    v_add_f32 v104, v104, v105
    v_add_f32 v105, v106, v107
    v_add_f32 v106, v108, v109
    v_mov_b32 v99, s56
    s_cmp_eq_u32 s101, 0
    v_add_f32_dpp v96, v96, v96 row_half_mirror row_mask:0xf bank_mask:0x5
    v_add_f32_dpp v97, v97, v97 row_half_mirror row_mask:0xf bank_mask:0x5
    v_add_f32_dpp v98, v98, v98 row_half_mirror row_mask:0xf bank_mask:0x5
    v_add_f32_dpp v96, v104, v104 row_half_mirror row_mask:0xf bank_mask:0xa
    v_add_f32_dpp v97, v105, v105 row_half_mirror row_mask:0xf bank_mask:0xa
    v_add_f32_dpp v98, v106, v106 row_half_mirror row_mask:0xf bank_mask:0xa
    v_add_f32_dpp v96, v96, v96 quad_perm:[1,0,3,2] row_mask:0xf bank_mask:0xf
    v_add_f32_dpp v97, v97, v97 quad_perm:[1,0,3,2] row_mask:0xf bank_mask:0xf
    v_add_f32_dpp v98, v98, v98 quad_perm:[1,0,3,2] row_mask:0xf bank_mask:0xf
    v_add_f32_dpp v96, v96, v96 quad_perm:[2,3,0,1] row_mask:0xf bank_mask:0xf
    v_add_f32_dpp v97, v97, v97 quad_perm:[2,3,0,1] row_mask:0xf bank_mask:0xf
    v_add_f32_dpp v98, v98, v98 quad_perm:[2,3,0,1] row_mask:0xf bank_mask:0xf
    s_cbranch_scc1 L_a1far
    buffer_store_dwordx4 v[96:99], v244, s[44:47], s92 offen
L_a1done:
    s_waitcnt vmcnt(1)
L_cc_c:
    v_cmp_ne_u32 vcc, s56, v242
    s_nop 0
    s_cmp_lg_u64 vcc, 0
    s_cbranch_scc1 L_cc_p
L_cc_o:
    v_add_f32_dpp v240, v240, v240 quad_perm:[1,0,3,2] row_mask:0xf bank_mask:0xf
    v_add_f32_dpp v241, v241, v241 quad_perm:[1,0,3,2] row_mask:0xf bank_mask:0xf
    s_nop 0
    v_add_f32_dpp v240, v240, v240 quad_perm:[2,3,0,1] row_mask:0xf bank_mask:0xf
    v_add_f32_dpp v241, v241, v241 quad_perm:[2,3,0,1] row_mask:0xf bank_mask:0xf
    s_nop 0
    v_add_f32_dpp v240, v240, v240 row_half_mirror row_mask:0xf bank_mask:0xf
    v_add_f32_dpp v241, v241, v241 row_half_mirror row_mask:0xf bank_mask:0xf
    s_sleep 1
    buffer_load_dwordx4 v[128:131], v10, s[44:47], s90 offen sc1
    buffer_load_dwordx4 v[160:163], v10, s[44:47], s91 offen sc1
    s_waitcnt vmcnt(0)
L_a1_c:
    v_xor_b32 v2, s56, v131
    v_bitop3_b32 v2, v2, v163, s56 bitop3:0xf6
    v_cmp_ne_u32 vcc, 0, v2
    s_nop 0
    s_cmp_lg_u64 vcc, 0
    s_cbranch_scc1 L_a1_p
L_a1_o:
    s_barrier
    v_add_f32_dpp v128, v128, v128 row_half_mirror row_mask:0xf bank_mask:0x5
    v_add_f32_dpp v129, v129, v129 row_half_mirror row_mask:0xf bank_mask:0x5
    v_add_f32_dpp v130, v130, v130 row_half_mirror row_mask:0xf bank_mask:0x5
    v_add_f32_dpp v128, v160, v160 row_half_mirror row_mask:0xf bank_mask:0xa
    v_add_f32_dpp v129, v161, v161 row_half_mirror row_mask:0xf bank_mask:0xa
    v_add_f32_dpp v130, v162, v162 row_half_mirror row_mask:0xf bank_mask:0xa
    v_add_f32_dpp v128, v128, v128 quad_perm:[1,0,3,2] row_mask:0xf bank_mask:0xf
    v_add_f32_dpp v129, v129, v129 quad_perm:[1,0,3,2] row_mask:0xf bank_mask:0xf
    v_add_f32_dpp v130, v130, v130 quad_perm:[1,0,3,2] row_mask:0xf bank_mask:0xf
    v_add_f32_dpp v128, v128, v128 quad_perm:[2,3,0,1] row_mask:0xf bank_mask:0xf
    v_add_f32_dpp v129, v129, v129 quad_perm:[2,3,0,1] row_mask:0xf bank_mask:0xf
    v_add_f32_dpp v130, v130, v130 quad_perm:[2,3,0,1] row_mask:0xf bank_mask:0xf
    v_mul_f32 v128, 0xbb000000, v128
    v_mul_f32 v129, 0x3b000000, v129
    v_fma_f32 v129, -v128, v128, v129
    v_max_f32 v129, 0, v129
    v_add_f32 v129, 0x3727c5ac, v129
    v_rsq_f32 v132, v129
    s_nop 0
    v_mul_f32 v133, v128, v132
    v_fma_f32 v130, v128, v240, v130
    v_mov_b64 v[164:165], v[132:133]
    v_fma_f32 v130, v130, v132, v241
    v_cvt_pk_bf16_f32 v130, v130, v130
    v_ashrrev_i32 v131, 31, v130
    v_or_b32 v131, 0x80000000, v131
    v_xor_b32 v131, v131, v130
    v_and_or_b32 v16, v131, s62, v124
    v_mov_b32 v124, v16
    v_mov_b32 v125, v16
    v_min_u32_dpp v17, v16, v16 row_half_mirror row_mask:0xf bank_mask:0xf
    v_max_u32_dpp v16, v16, v16 row_half_mirror row_mask:0xf bank_mask:0xf
    v_mov_b32_dpp v132, v132 row_half_mirror row_mask:0xf bank_mask:0xa
    v_mov_b32_dpp v133, v133 row_half_mirror row_mask:0xf bank_mask:0xa
    v_min_u32_dpp v18, v16, v16 row_ror:8 row_mask:0xf bank_mask:0xf
    v_max_u32_dpp v19, v17, v17 row_ror:8 row_mask:0xf bank_mask:0xf
    v_max_u32_dpp v16, v16, v16 row_ror:8 row_mask:0xf bank_mask:0xf
    v_max_u32 v17, v18, v19
    v_mov_b32_dpp v164, v164 row_half_mirror row_mask:0xf bank_mask:0x5
    v_min_u32_dpp v18, v16, v16 row_bcast:15 row_mask:0xa bank_mask:0xf
    v_max_u32_dpp v19, v17, v17 row_bcast:15 row_mask:0xa bank_mask:0xf
    v_max_u32_dpp v16, v16, v16 row_bcast:15 row_mask:0xa bank_mask:0xf
    v_max_u32 v17, v18, v19
    v_mov_b32_dpp v165, v165 row_half_mirror row_mask:0xf bank_mask:0x5
    v_min_u32_dpp v18, v16, v16 row_bcast:31 row_mask:0xc bank_mask:0xf
    v_max_u32_dpp v19, v17, v17 row_bcast:31 row_mask:0xc bank_mask:0xf
    v_max_u32_dpp v16, v16, v16 row_bcast:31 row_mask:0xc bank_mask:0xf
    v_max_u32 v17, v18, v19
    v_mov_b32_dpp v124, v124 row_half_mirror row_mask:0xf bank_mask:0xa
    v_or_b32 v19, 1, v17
    v_mov_b32 v18, v16
    s_lshl_b64 exec, 1, 63
    ds_write_b64 v121, v[18:19] offset:64
    ds_add_rtn_u32 v122, v247, v122 offset:4
    s_mov_b64 exec, -1
    ds_read_b64 v[20:21], v123 offset:64
    v_readlane_b32 s66, v16, 63
    v_readlane_b32 s67, v17, 63
    v_mov_b32 v22, s56
    v_mov_b32_dpp v125, v125 row_half_mirror row_mask:0xf bank_mask:0x5
    v_pk_fma_f32 v[136:137], v[80:81], v[132:133], v[132:133] op_sel:[0,0,1] op_sel_hi:[1,0,1]
    v_pk_fma_f32 v[138:139], v[82:83], v[132:133], v[132:133] op_sel:[0,0,1] op_sel_hi:[1,0,1]
    v_pk_fma_f32 v[140:141], v[84:85], v[132:133], v[132:133] op_sel:[0,0,1] op_sel_hi:[1,0,1]
    v_pk_fma_f32 v[142:143], v[86:87], v[132:133], v[132:133] op_sel:[0,0,1] op_sel_hi:[1,0,1]
    v_pk_fma_f32 v[136:137], v[136:137], v[208:209], v[200:201]
    v_pk_fma_f32 v[138:139], v[138:139], v[210:211], v[202:203]
    v_pk_fma_f32 v[140:141], v[140:141], v[212:213], v[204:205]
    v_pk_fma_f32 v[142:143], v[142:143], v[214:215], v[206:207]
    v_cvt_pk_bf16_f32 v144, v136, v137
    v_cvt_pk_bf16_f32 v145, v138, v139
    v_cvt_pk_bf16_f32 v146, v140, v141
    v_cvt_pk_bf16_f32 v147, v142, v143
    s_waitcnt lgkmcnt(1)
    v_readlane_b32 s57, v122, 63
    s_waitcnt lgkmcnt(0)
    v_min_u32_dpp v18, v20, v20 quad_perm:[1,0,3,2] row_mask:0xf bank_mask:0xf
    v_max_u32_dpp v19, v21, v21 quad_perm:[1,0,3,2] row_mask:0xf bank_mask:0xf
    v_max_u32_dpp v20, v20, v20 quad_perm:[1,0,3,2] row_mask:0xf bank_mask:0xf
    v_max_u32 v21, v18, v19
    v_add3_u32 v135, v144, v145, s56
    v_min_u32_dpp v18, v20, v20 quad_perm:[2,3,0,1] row_mask:0xf bank_mask:0xf
    v_max_u32_dpp v19, v21, v21 quad_perm:[2,3,0,1] row_mask:0xf bank_mask:0xf
    v_max_u32_dpp v20, v20, v20 quad_perm:[2,3,0,1] row_mask:0xf bank_mask:0xf
    v_max_u32 v21, v18, v19
    v_add3_u32 v135, v146, v147, v135
    s_cmp_lg_u32 s57, 3
    s_cselect_b32 s57, 1073741824, 0
    v_or_b32 v9, s57, v9
    buffer_store_dwordx3 v[20:22], v9, s[44:47], s95 offen sc1
    v_cmp_eq_u32 vcc, s67, v124
    v_cmp_eq_u32 s[60:61], s66, v124
    v_pk_fma_f32 v[168:169], v[88:89], v[164:165], v[164:165] op_sel:[0,0,1] op_sel_hi:[1,0,1]
    v_cndmask_b32 v24, v126, v127, vcc
    v_cndmask_b32 v24, v24, 0, s[60:61]
    v_add_u32 v26, v24, v3
    v_add_u32 v27, v24, v7
    buffer_store_dwordx4 v[144:147], v26, s[44:47], s94 offen sc1
    buffer_store_dword v135, v27, s[44:47], s94 offen offset:1024 sc1
    v_cmp_eq_u32 vcc, s67, v125
    v_cmp_eq_u32 s[60:61], s66, v125
    v_pk_fma_f32 v[170:171], v[90:91], v[164:165], v[164:165] op_sel:[0,0,1] op_sel_hi:[1,0,1]
    v_cndmask_b32 v25, v126, v127, vcc
    v_cndmask_b32 v25, v25, 0, s[60:61]
    v_pk_fma_f32 v[172:173], v[92:93], v[164:165], v[164:165] op_sel:[0,0,1] op_sel_hi:[1,0,1]
    v_pk_fma_f32 v[174:175], v[94:95], v[164:165], v[164:165] op_sel:[0,0,1] op_sel_hi:[1,0,1]
    v_pk_fma_f32 v[168:169], v[168:169], v[208:209], v[200:201]
    v_pk_fma_f32 v[170:171], v[170:171], v[210:211], v[202:203]
    v_pk_fma_f32 v[172:173], v[172:173], v[212:213], v[204:205]
    v_pk_fma_f32 v[174:175], v[174:175], v[214:215], v[206:207]
    v_cvt_pk_bf16_f32 v176, v168, v169
    v_cvt_pk_bf16_f32 v177, v170, v171
    v_cvt_pk_bf16_f32 v178, v172, v173
    v_cvt_pk_bf16_f32 v179, v174, v175
    v_add3_u32 v167, v176, v177, s56
    v_add3_u32 v167, v178, v179, v167
    v_add_u32 v26, v25, v3
    v_add_u32 v27, v25, v7
    buffer_store_dwordx4 v[176:179], v26, s[44:47], s94 offen sc1
    buffer_store_dword v167, v27, s[44:47], s94 offen offset:1024 sc1
    v_pk_fma_f32 v[152:153], v[136:137], v[216:217], v[80:81]
    v_pk_fma_f32 v[154:155], v[138:139], v[218:219], v[82:83]
    v_pk_fma_f32 v[156:157], v[140:141], v[220:221], v[84:85]
    v_pk_fma_f32 v[158:159], v[142:143], v[222:223], v[86:87]
    v_cvt_pk_bf16_f32 v148, v152, v153
    v_cvt_pk_bf16_f32 v149, v154, v155
    v_cvt_pk_bf16_f32 v150, v156, v157
    v_cvt_pk_bf16_f32 v151, v158, v159
    v_bfi_b32 v152, v11, s0, v152
    v_bfi_b32 v153, v11, s98, v153
    v_bfi_b32 v154, v11, s99, v154
    v_bfi_b32 v155, v11, s3, v155
    v_bfi_b32 v156, v11, s0, v156
    v_bfi_b32 v157, v11, s98, v157
    v_bfi_b32 v158, v11, s99, v158
    v_bfi_b32 v159, v11, s3, v159
    v_add_u32 v24, v24, v245
    buffer_store_dwordx4 v[152:155], v24, s[44:47], s94 offen offset:2048 sc1
    buffer_store_dwordx4 v[156:159], v24, s[44:47], s94 offen offset:2064 sc1
    v_pk_fma_f32 v[184:185], v[168:169], v[216:217], v[88:89]
    v_pk_fma_f32 v[186:187], v[170:171], v[218:219], v[90:91]
    v_pk_fma_f32 v[188:189], v[172:173], v[220:221], v[92:93]
    v_pk_fma_f32 v[190:191], v[174:175], v[222:223], v[94:95]
    v_cvt_pk_bf16_f32 v180, v184, v185
    v_cvt_pk_bf16_f32 v181, v186, v187
    v_cvt_pk_bf16_f32 v182, v188, v189
    v_cvt_pk_bf16_f32 v183, v190, v191
    v_bfi_b32 v184, v11, s0, v184
    v_bfi_b32 v185, v11, s98, v185
    v_bfi_b32 v186, v11, s99, v186
    v_bfi_b32 v187, v11, s3, v187
    v_bfi_b32 v188, v11, s0, v188
    v_bfi_b32 v189, v11, s98, v189
    v_bfi_b32 v190, v11, s99, v190
    v_bfi_b32 v191, v11, s3, v191
    v_add_u32 v25, v25, v245
    buffer_store_dwordx4 v[184:187], v25, s[44:47], s94 offen offset:2048 sc1
    buffer_store_dwordx4 v[188:191], v25, s[44:47], s94 offen offset:2064 sc1
    v_mov_b32 v2, 0
    s_waitcnt lgkmcnt(0)
    s_barrier
    ds_read_b64 v[16:17], v2 offset:128
    s_waitcnt lgkmcnt(0)
    v_readfirstlane_b32 s66, v16
    v_readfirstlane_b32 s67, v17
    s_bfe_u32 s70, s66, 0xb0001
    s_sub_u32 s70, 2047, s70
    s_bfe_u32 s71, s67, 0xb0001
    s_sub_u32 s71, 2047, s71
    v_mov_b32 v2, 1073741824
    v_cmp_eq_u32 vcc, s70, v246
    v_cmp_eq_u32 s[60:61], s71, v246
    s_nop 0
    s_or_b64 vcc, vcc, s[60:61]
    v_cndmask_b32 v16, v13, v2, vcc
    buffer_store_dwordx4 v[148:151], v16, s[40:43], s81 offen nt
    v_add_u32 v246, 64, v246
    v_cmp_eq_u32 vcc, s70, v246
    v_cmp_eq_u32 s[60:61], s71, v246
    s_nop 0
    s_or_b64 vcc, vcc, s[60:61]
    v_cndmask_b32 v17, v13, v2, vcc
    buffer_store_dwordx4 v[180:183], v17, s[40:43], s82 offen nt
    s_cmp_eq_u32 s52, 0
    s_cbranch_scc0 L_hfin
    s_lshr_b32 s68, s70, 7
    s_bfe_u32 s60, s70, 0x30003
    s_lshl3_add_u32 s68, s68, s60
    s_and_b32 s60, s66, 1
    s_lshl1_add_u32 s68, s68, s60
    s_lshl_b32 s68, s68, 12
    s_lshr_b32 s69, s71, 7
    s_bfe_u32 s60, s71, 0x30003
    s_lshl3_add_u32 s69, s69, s60
    s_and_b32 s60, s67, 1
    s_lshl1_add_u32 s69, s69, s60
    s_lshl_b32 s69, s69, 12
    v_cmp_gt_u32 vcc, 32, v4
    v_bfe_u32 v40, v4, 4, 1
    s_lshl3_add_u32 s61, s64, 2816
    v_lshl_add_u32 v41, v40, 2, s61
    ds_read_b32 v41, v41
    v_mov_b32 v42, s69
    v_mov_b32 v2, s68
    v_cndmask_b32 v42, v42, v2, vcc
    v_mov_b32 v43, s67
    v_mov_b32 v2, s66
    v_cndmask_b32 v43, v43, v2, vcc
    v_mov_b32 v44, s71
    v_mov_b32 v2, s70
    v_cndmask_b32 v44, v44, v2, vcc
    v_lshl_add_u32 v42, v40, 2, v42
    v_and_b32 v43, 0xffff0000, v43
    v_ashrrev_i32 v2, 31, v43
    v_not_b32 v2, v2
    v_or_b32 v2, 0x80000000, v2
    v_xor_b32 v43, v43, v2
    v_and_b32 v43, 0xffff0000, v43
    v_mul_f32 v43, 0xbfb8aa3b, v43
    v_exp_f32 v43, v43
    v_lshlrev_b32 v44, 10, v44
    v_add_f32 v43, 1.0, v43
    v_rcp_f32 v43, v43
    v_lshl_add_u32 v44, v40, 1, v44
    v_cvt_pk_bf16_f32 v43, v43, v43
    v_and_b32 v43, 0xffff0000, v43
    s_waitcnt lgkmcnt(0)
    v_mul_f32 v43, v43, v41
    s_lshr_b32 s72, s65, 1
    s_add_u32 s72, s72, 1050624
    s_lshr_b32 s73, s65, 2
    s_add_u32 s65, s65, 413696
    s_and_b32 s61, s64, 1
    s_lshl_b32 s61, s61, 4
    v_lshl_add_u32 v45, v40, 3, s61
    v_lshrrev_b32 v45, v45, s56
    v_and_b32 v45, 0xff, v45
    v_lshlrev_b32 v46, 12, v4
    v_cmp_gt_u32 vcc, 48, v4
    v_add_u32 v47, 262144, v46
    v_mov_b32 v2, 1073741824
    v_cndmask_b32 v47, v2, v47, vcc
    s_lshr_b32 s57, s2, 6
    s_lshl2_add_u32 s57, s76, s57
    s_cmp_lt_u32 s57, 14
    s_cbranch_scc1 L_x4
    s_sleep 14
L_x4:
    s_barrier
    buffer_load_dword v48, v42, s[44:47], s72 offen sc1
    s_waitcnt vmcnt(0)
L_bs_c:
    v_xor_b32 v48, v48, v45
    v_and_b32 v2, 0xff, v48
    v_cmp_ne_u32 vcc, 0, v2
    s_nop 0
    s_cmp_lg_u64 vcc, 0
    s_cbranch_scc1 L_bs_p
L_bs_o:
    s_sleep 19
    buffer_load_dwordx4 v[32:35], v46, s[44:47], s65 offen sc1
    buffer_load_dwordx4 v[36:39], v47, s[44:47], s65 offen sc1
    s_waitcnt vmcnt(0)
L_y_c:
    v_xor_b32 v32, s0, v32
    v_xor_b32 v33, s98, v33
    v_xor_b32 v34, s99, v34
    v_xor_b32 v35, s3, v35
    v_or3_b32 v2, v32, v33, v34
    s_mov_b32 exec_hi, 0xffff
    v_xor_b32 v36, s0, v36
    v_xor_b32 v37, s98, v37
    v_xor_b32 v38, s99, v38
    v_xor_b32 v39, s3, v39
    s_mov_b32 exec_hi, -1
    v_or3_b32 v2, v2, v35, v36
    v_pk_add_f32 v[32:33], v[32:33], v[36:37]
    v_or3_b32 v2, v2, v37, v38
    v_pk_add_f32 v[34:35], v[34:35], v[38:39]
    v_or_b32 v2, v2, v39
    v_and_b32 v2, 0xff, v2
    v_cmp_ne_u32 vcc, 0, v2
    s_nop 0
    s_cmp_lg_u64 vcc, 0
    s_cbranch_scc1 L_y_p
L_y_o:
    v_permlane32_swap_b32 v32, v33
    v_permlane32_swap_b32 v34, v35
    v_add_f32 v32, v32, v33
    v_add_f32 v34, v34, v35
    s_nop 1
    v_permlane16_swap_b32 v32, v34
    v_add_f32 v32, v32, v34
    s_nop 1
    v_add_f32_dpp v32, v32, v32 quad_perm:[1,0,3,2] row_mask:0xf bank_mask:0xf
    s_nop 1
    v_add_f32_dpp v32, v32, v32 quad_perm:[2,3,0,1] row_mask:0xf bank_mask:0xf
    s_nop 1
    v_add_f32_dpp v32, v32, v32 row_half_mirror row_mask:0xf bank_mask:0xf
    s_nop 1
    v_add_f32_dpp v32, v32, v32 row_mirror row_mask:0xf bank_mask:0xf
    v_cvt_pk_bf16_f32 v32, v32, v32
    v_and_b32 v32, 0xffff0000, v32
    v_fma_f32 v32, v32, v43, v48
    v_cvt_pk_bf16_f32 v32, v32, v32
    buffer_store_short v32, v44, s[40:43], s73 offen
    s_cmp_lg_u32 s2, 0
    s_cbranch_scc1 L_hfin
    v_mov_b32 v2, 0
    v_mov_b32 v3, s56
    buffer_store_dword v3, v2, s[44:47], 0 offen offset:0 sc1
L_hfin:
    s_endpgm
L_rk3a:
    s_add_u32 s63, s63, 1
    s_cmp_ge_u32 s63, 65536
    s_cbranch_scc1 L_gk3a
    s_sleep 2
    buffer_load_dwordx4 v[152:155], v1, s[76:79], 0 offen offset:0 sc1
    buffer_load_dwordx4 v[156:159], v1, s[76:79], 0 offen offset:1024 sc1
    buffer_load_dword v115, v14, s[76:79], 0 offen offset:2048 sc1
    s_waitcnt vmcnt(0)
    v_add3_u32 v252, v152, v153, s62
    v_add3_u32 v252, v154, v155, v252
    v_add3_u32 v252, v156, v157, v252
    v_add3_u32 v252, v158, v159, v252
    v_cmp_ne_u32 vcc, v252, v115
    s_nop 4
    s_cbranch_vccnz L_rk3a
    s_nop 1
    s_branch L_gk3a
L_rk2a:
    s_add_u32 s63, s63, 1
    s_cmp_ge_u32 s63, 65536
    s_cbranch_scc1 L_gk2a
    s_sleep 2
    buffer_load_dwordx4 v[144:147], v1, s[72:75], 0 offen offset:0 sc1
    buffer_load_dwordx4 v[148:151], v1, s[72:75], 0 offen offset:1024 sc1
    buffer_load_dword v114, v14, s[72:75], 0 offen offset:2048 sc1
    s_waitcnt vmcnt(0)
    v_add3_u32 v252, v144, v145, s61
    v_add3_u32 v252, v146, v147, v252
    v_add3_u32 v252, v148, v149, v252
    v_add3_u32 v252, v150, v151, v252
    v_cmp_ne_u32 vcc, v252, v114
    s_nop 4
    s_cbranch_vccnz L_rk2a
    s_nop 1
    s_branch L_gk2a
L_rv3a:
    s_add_u32 s63, s63, 1
    s_cmp_ge_u32 s63, 65536
    s_cbranch_scc1 L_gv3a
    s_sleep 2
    buffer_load_dwordx4 v[184:187], v1, s[76:79], 0 offen offset:2560 sc1
    buffer_load_dwordx4 v[188:191], v1, s[76:79], 0 offen offset:3584 sc1
    buffer_load_dword v251, v14, s[76:79], 0 offen offset:2304 sc1
    s_waitcnt vmcnt(0)
    v_add3_u32 v252, v184, v185, s62
    v_add3_u32 v252, v186, v187, v252
    v_add3_u32 v252, v188, v189, v252
    v_add3_u32 v252, v190, v191, v252
    v_cmp_ne_u32 vcc, v252, v251
    s_nop 4
    s_cbranch_vccnz L_rv3a
    s_nop 1
    s_branch L_gv3a
L_rk1a:
    s_add_u32 s63, s63, 1
    s_cmp_ge_u32 s63, 65536
    s_cbranch_scc1 L_gk1a
    s_sleep 2
    buffer_load_dwordx4 v[136:139], v1, s[40:43], 0 offen offset:0 sc1
    buffer_load_dwordx4 v[140:143], v1, s[40:43], 0 offen offset:1024 sc1
    buffer_load_dword v253, v14, s[40:43], 0 offen offset:2048 sc1
    s_waitcnt vmcnt(0)
    v_add3_u32 v252, v136, v137, s60
    v_add3_u32 v252, v138, v139, v252
    v_add3_u32 v252, v140, v141, v252
    v_add3_u32 v252, v142, v143, v252
    v_cmp_ne_u32 vcc, v252, v253
    s_nop 4
    s_cbranch_vccnz L_rk1a
    s_nop 1
    s_branch L_gk1a
L_rv2a:
    s_add_u32 s63, s63, 1
    s_cmp_ge_u32 s63, 65536
    s_cbranch_scc1 L_gv2a
    s_sleep 2
    buffer_load_dwordx4 v[176:179], v1, s[72:75], 0 offen offset:2560 sc1
    buffer_load_dwordx4 v[180:183], v1, s[72:75], 0 offen offset:3584 sc1
    buffer_load_dword v250, v14, s[72:75], 0 offen offset:2304 sc1
    s_waitcnt vmcnt(0)
    v_add3_u32 v252, v176, v177, s61
    v_add3_u32 v252, v178, v179, v252
    v_add3_u32 v252, v180, v181, v252
    v_add3_u32 v252, v182, v183, v252
    v_cmp_ne_u32 vcc, v252, v250
    s_nop 4
    s_cbranch_vccnz L_rv2a
    s_nop 1
    s_branch L_gv2a
L_rk0a:
    s_add_u32 s63, s63, 1
    s_cmp_ge_u32 s63, 65536
    s_cbranch_scc1 L_gk0a
    s_sleep 2
    buffer_load_dwordx4 v[128:131], v1, s[4:7], 0 offen offset:0 sc1
    buffer_load_dwordx4 v[132:135], v1, s[4:7], 0 offen offset:1024 sc1
    buffer_load_dword v254, v14, s[4:7], 0 offen offset:2048 sc1
    s_waitcnt vmcnt(0)
    v_add3_u32 v252, v128, v129, s59
    v_add3_u32 v252, v130, v131, v252
    v_add3_u32 v252, v132, v133, v252
    v_add3_u32 v252, v134, v135, v252
    v_cmp_ne_u32 vcc, v252, v254
    s_nop 4
    s_cbranch_vccnz L_rk0a
    s_nop 1
    s_branch L_gk0a
L_rv1a:
    s_add_u32 s63, s63, 1
    s_cmp_ge_u32 s63, 65536
    s_cbranch_scc1 L_gv1a
    s_sleep 2
    buffer_load_dwordx4 v[168:171], v1, s[40:43], 0 offen offset:2560 sc1
    buffer_load_dwordx4 v[172:175], v1, s[40:43], 0 offen offset:3584 sc1
    buffer_load_dword v249, v14, s[40:43], 0 offen offset:2304 sc1
    s_waitcnt vmcnt(0)
    v_add3_u32 v252, v168, v169, s60
    v_add3_u32 v252, v170, v171, v252
    v_add3_u32 v252, v172, v173, v252
    v_add3_u32 v252, v174, v175, v252
    v_cmp_ne_u32 vcc, v252, v249
    s_nop 4
    s_cbranch_vccnz L_rv1a
    s_nop 1
    s_branch L_gv1a
L_rv0a:
    s_add_u32 s63, s63, 1
    s_cmp_ge_u32 s63, 65536
    s_cbranch_scc1 L_gv0a
    s_sleep 2
    buffer_load_dwordx4 v[160:163], v1, s[4:7], 0 offen offset:2560 sc1
    buffer_load_dwordx4 v[164:167], v1, s[4:7], 0 offen offset:3584 sc1
    buffer_load_dword v248, v14, s[4:7], 0 offen offset:2304 sc1
    s_waitcnt vmcnt(0)
    v_add3_u32 v252, v160, v161, s59
    v_add3_u32 v252, v162, v163, v252
    v_add3_u32 v252, v164, v165, v252
    v_add3_u32 v252, v166, v167, v252
    v_cmp_ne_u32 vcc, v252, v248
    s_nop 4
    s_cbranch_vccnz L_rv0a
    s_nop 1
    s_branch L_gv0a
L_rk3b:
    s_add_u32 s63, s63, 1
    s_cmp_ge_u32 s63, 65536
    s_cbranch_scc1 L_gk3b
    s_sleep 2
    buffer_load_dwordx4 v[152:155], v1, s[76:79], 0 offen offset:0 sc1
    buffer_load_dwordx4 v[156:159], v1, s[76:79], 0 offen offset:1024 sc1
    buffer_load_dword v115, v14, s[76:79], 0 offen offset:2048 sc1
    s_waitcnt vmcnt(0)
    v_add3_u32 v252, v152, v153, s62
    v_add3_u32 v252, v154, v155, v252
    v_add3_u32 v252, v156, v157, v252
    v_add3_u32 v252, v158, v159, v252
    v_cmp_ne_u32 vcc, v252, v115
    s_nop 4
    s_cbranch_vccnz L_rk3b
    s_nop 1
    s_branch L_gk3b
L_rk2b:
    s_add_u32 s63, s63, 1
    s_cmp_ge_u32 s63, 65536
    s_cbranch_scc1 L_gk2b
    s_sleep 2
    buffer_load_dwordx4 v[144:147], v1, s[72:75], 0 offen offset:0 sc1
    buffer_load_dwordx4 v[148:151], v1, s[72:75], 0 offen offset:1024 sc1
    buffer_load_dword v114, v14, s[72:75], 0 offen offset:2048 sc1
    s_waitcnt vmcnt(0)
    v_add3_u32 v252, v144, v145, s61
    v_add3_u32 v252, v146, v147, v252
    v_add3_u32 v252, v148, v149, v252
    v_add3_u32 v252, v150, v151, v252
    v_cmp_ne_u32 vcc, v252, v114
    s_nop 4
    s_cbranch_vccnz L_rk2b
    s_nop 1
    s_branch L_gk2b
L_rv3b:
    s_add_u32 s63, s63, 1
    s_cmp_ge_u32 s63, 65536
    s_cbranch_scc1 L_gv3b
    s_sleep 2
    buffer_load_dwordx4 v[184:187], v1, s[76:79], 0 offen offset:2560 sc1
    buffer_load_dwordx4 v[188:191], v1, s[76:79], 0 offen offset:3584 sc1
    buffer_load_dword v251, v14, s[76:79], 0 offen offset:2304 sc1
    s_waitcnt vmcnt(0)
    v_add3_u32 v252, v184, v185, s62
    v_add3_u32 v252, v186, v187, v252
    v_add3_u32 v252, v188, v189, v252
    v_add3_u32 v252, v190, v191, v252
    v_cmp_ne_u32 vcc, v252, v251
    s_nop 4
    s_cbranch_vccnz L_rv3b
    s_nop 1
    s_branch L_gv3b
L_rk1b:
    s_add_u32 s63, s63, 1
    s_cmp_ge_u32 s63, 65536
    s_cbranch_scc1 L_gk1b
    s_sleep 2
    buffer_load_dwordx4 v[136:139], v1, s[40:43], 0 offen offset:0 sc1
    buffer_load_dwordx4 v[140:143], v1, s[40:43], 0 offen offset:1024 sc1
    buffer_load_dword v253, v14, s[40:43], 0 offen offset:2048 sc1
    s_waitcnt vmcnt(0)
    v_add3_u32 v252, v136, v137, s60
    v_add3_u32 v252, v138, v139, v252
    v_add3_u32 v252, v140, v141, v252
    v_add3_u32 v252, v142, v143, v252
    v_cmp_ne_u32 vcc, v252, v253
    s_nop 4
    s_cbranch_vccnz L_rk1b
    s_nop 1
    s_branch L_gk1b
L_rv2b:
    s_add_u32 s63, s63, 1
    s_cmp_ge_u32 s63, 65536
    s_cbranch_scc1 L_gv2b
    s_sleep 2
    buffer_load_dwordx4 v[176:179], v1, s[72:75], 0 offen offset:2560 sc1
    buffer_load_dwordx4 v[180:183], v1, s[72:75], 0 offen offset:3584 sc1
    buffer_load_dword v250, v14, s[72:75], 0 offen offset:2304 sc1
    s_waitcnt vmcnt(0)
    v_add3_u32 v252, v176, v177, s61
    v_add3_u32 v252, v178, v179, v252
    v_add3_u32 v252, v180, v181, v252
    v_add3_u32 v252, v182, v183, v252
    v_cmp_ne_u32 vcc, v252, v250
    s_nop 4
    s_cbranch_vccnz L_rv2b
    s_nop 1
    s_branch L_gv2b
L_rk0b:
    s_add_u32 s63, s63, 1
    s_cmp_ge_u32 s63, 65536
    s_cbranch_scc1 L_gk0b
    s_sleep 2
    buffer_load_dwordx4 v[128:131], v1, s[4:7], 0 offen offset:0 sc1
    buffer_load_dwordx4 v[132:135], v1, s[4:7], 0 offen offset:1024 sc1
    buffer_load_dword v254, v14, s[4:7], 0 offen offset:2048 sc1
    s_waitcnt vmcnt(0)
    v_add3_u32 v252, v128, v129, s59
    v_add3_u32 v252, v130, v131, v252
    v_add3_u32 v252, v132, v133, v252
    v_add3_u32 v252, v134, v135, v252
    v_cmp_ne_u32 vcc, v252, v254
    s_nop 4
    s_cbranch_vccnz L_rk0b
    s_nop 1
    s_branch L_gk0b
L_rv1b:
    s_add_u32 s63, s63, 1
    s_cmp_ge_u32 s63, 65536
    s_cbranch_scc1 L_gv1b
    s_sleep 2
    buffer_load_dwordx4 v[168:171], v1, s[40:43], 0 offen offset:2560 sc1
    buffer_load_dwordx4 v[172:175], v1, s[40:43], 0 offen offset:3584 sc1
    buffer_load_dword v249, v14, s[40:43], 0 offen offset:2304 sc1
    s_waitcnt vmcnt(0)
    v_add3_u32 v252, v168, v169, s60
    v_add3_u32 v252, v170, v171, v252
    v_add3_u32 v252, v172, v173, v252
    v_add3_u32 v252, v174, v175, v252
    v_cmp_ne_u32 vcc, v252, v249
    s_nop 4
    s_cbranch_vccnz L_rv1b
    s_nop 1
    s_branch L_gv1b
L_rv0b:
    s_add_u32 s63, s63, 1
    s_cmp_ge_u32 s63, 65536
    s_cbranch_scc1 L_gv0b
    s_sleep 2
    buffer_load_dwordx4 v[160:163], v1, s[4:7], 0 offen offset:2560 sc1
    buffer_load_dwordx4 v[164:167], v1, s[4:7], 0 offen offset:3584 sc1
    buffer_load_dword v248, v14, s[4:7], 0 offen offset:2304 sc1
    s_waitcnt vmcnt(0)
    v_add3_u32 v252, v160, v161, s59
    v_add3_u32 v252, v162, v163, v252
    v_add3_u32 v252, v164, v165, v252
    v_add3_u32 v252, v166, v167, v252
    v_cmp_ne_u32 vcc, v252, v248
    s_nop 4
    s_cbranch_vccnz L_rv0b
    s_nop 1
    s_branch L_gv0b
L_ofar:
    buffer_store_dwordx4 v[60:63], v1, s[44:47], s57 offen sc1
    v_add3_u32 v56, v60, v61, s56
    v_add3_u32 v56, v62, v63, v56
    buffer_store_dword v56, v1, s[44:47], s58 offen sc1
    s_nop 1
    s_branch L_odone
L_a1far:
    buffer_store_dwordx4 v[96:99], v244, s[44:47], s92 offen sc1
    s_nop 1
    s_branch L_a1done
L_mod_p:
    s_add_u32 s63, s63, 1
    s_cmp_ge_u32 s63, 65536
    s_cbranch_scc1 L_mod_o
    s_nop 7
    s_sleep 1
    buffer_load_dwordx4 v[40:43], v38, s[44:47], s60 offen offset:0 sc1
    buffer_load_dwordx4 v[44:47], v38, s[44:47], s60 offen offset:512 sc1
    buffer_load_dwordx4 v[48:51], v38, s[44:47], s60 offen offset:1024 sc1
    buffer_load_dwordx4 v[52:55], v38, s[44:47], s60 offen offset:1536 sc1
    s_waitcnt vmcnt(0)
    s_branch L_mod_c
L_xs_p:
    s_add_u32 s63, s63, 1
    s_cmp_ge_u32 s63, 65536
    s_cbranch_scc1 L_xs_o
    s_nop 7
    s_sleep 1
    buffer_load_dwordx4 v[16:19], v56, s[44:47], s76 offen offset:0 sc1
    buffer_load_dwordx4 v[20:23], v56, s[44:47], s76 offen offset:64 sc1
    buffer_load_dwordx4 v[24:27], v56, s[44:47], s76 offen offset:128 sc1
    buffer_load_dwordx4 v[28:31], v56, s[44:47], s76 offen offset:192 sc1
    buffer_load_dwordx4 v[32:35], v56, s[44:47], s77 offen sc1
    s_waitcnt vmcnt(0)
    s_branch L_xs_c
L_a2_p:
    s_add_u32 s63, s63, 1
    s_cmp_ge_u32 s63, 65536
    s_cbranch_scc1 L_a2_o
    s_nop 7
    buffer_load_dwordx3 v[16:18], v2, s[44:47], s61 offen sc1
    s_waitcnt vmcnt(0)
    s_branch L_a2_c
L_xb_p:
    s_add_u32 s63, s63, 1
    s_cmp_ge_u32 s63, 65536
    s_cbranch_scc1 L_xb_o
    s_nop 7
    s_sleep 4
    buffer_load_dwordx2 v[204:205], v206, s[44:47], s89 offen sc1
    s_waitcnt vmcnt(0)
    s_branch L_xb_c
L_b2_p:
    s_add_u32 s63, s63, 1
    s_cmp_ge_u32 s63, 65536
    s_cbranch_scc1 L_b2_o
    s_nop 7
    s_sleep 4
    buffer_load_dwordx4 v[160:163], v12, s[44:47], s84 offen offset:0 sc1
    buffer_load_dwordx4 v[164:167], v12, s[44:47], s84 offen offset:512 sc1
    buffer_load_dwordx4 v[168:171], v12, s[44:47], s84 offen offset:1024 sc1
    buffer_load_dwordx4 v[172:175], v12, s[44:47], s84 offen offset:1536 sc1
    s_waitcnt vmcnt(0)
    s_branch L_b2_c
L_f0_p:
    s_add_u32 s63, s63, 1
    s_cmp_ge_u32 s63, 65536
    s_cbranch_scc1 L_f0_o
    s_nop 7
    s_sleep 1
    buffer_load_dword v120, v191, s[44:47], s70 offen sc1
    s_waitcnt vmcnt(0)
    s_branch L_f0_c
L_o0_p:
    s_add_u32 s63, s63, 1
    s_cmp_ge_u32 s63, 65536
    s_cbranch_scc1 L_o0_o
    s_nop 7
    s_sleep 8
    buffer_load_dword v112, v11, s[44:47], s87 offen offset:0 sc1
    buffer_load_dwordx4 v[80:83], v10, s[44:47], s85 offen offset:0 sc1
    buffer_load_dword v113, v11, s[44:47], s87 offen offset:256 sc1
    buffer_load_dwordx4 v[84:87], v10, s[44:47], s85 offen offset:1024 sc1
    buffer_load_dword v114, v11, s[44:47], s87 offen offset:512 sc1
    buffer_load_dwordx4 v[88:91], v10, s[44:47], s85 offen offset:2048 sc1
    buffer_load_dword v115, v11, s[44:47], s87 offen offset:768 sc1
    buffer_load_dwordx4 v[92:95], v10, s[44:47], s85 offen offset:3072 sc1
    buffer_load_dword v116, v11, s[44:47], s72 offen offset:0 sc1
    buffer_load_dwordx4 v[96:99], v10, s[44:47], s86 offen offset:0 sc1
    buffer_load_dword v117, v11, s[44:47], s72 offen offset:256 sc1
    buffer_load_dwordx4 v[100:103], v10, s[44:47], s86 offen offset:1024 sc1
    buffer_load_dword v118, v11, s[44:47], s72 offen offset:512 sc1
    buffer_load_dwordx4 v[104:107], v10, s[44:47], s86 offen offset:2048 sc1
    buffer_load_dword v119, v11, s[44:47], s72 offen offset:768 sc1
    buffer_load_dwordx4 v[108:111], v10, s[44:47], s86 offen offset:3072 sc1
    s_waitcnt vmcnt(0)
    s_branch L_o0_c
L_o1_p:
    s_add_u32 s63, s63, 1
    s_cmp_ge_u32 s63, 65536
    s_cbranch_scc1 L_o1_o
    s_nop 7
    buffer_load_dwordx4 v[232:235], v10, s[44:47], s71 offen sc1
    buffer_load_dwordx4 v[192:195], v10, s[44:47], s68 offen offset:0 sc1
    buffer_load_dwordx4 v[196:199], v10, s[44:47], s68 offen offset:1024 sc1
    buffer_load_dwordx4 v[200:203], v10, s[44:47], s68 offen offset:2048 sc1
    buffer_load_dwordx4 v[204:207], v10, s[44:47], s68 offen offset:3072 sc1
    buffer_load_dwordx4 v[236:239], v10, s[44:47], s73 offen sc1
    buffer_load_dwordx4 v[208:211], v10, s[44:47], s69 offen offset:0 sc1
    buffer_load_dwordx4 v[212:215], v10, s[44:47], s69 offen offset:1024 sc1
    buffer_load_dwordx4 v[216:219], v10, s[44:47], s69 offen offset:2048 sc1
    buffer_load_dwordx4 v[220:223], v10, s[44:47], s69 offen offset:3072 sc1
    s_waitcnt vmcnt(0)
    s_branch L_o1_c
L_cc_p:
    s_add_u32 s63, s63, 1
    s_cmp_ge_u32 s63, 65536
    s_cbranch_scc1 L_cc_o
    s_nop 7
    s_sleep 1
    buffer_load_dwordx3 v[240:242], v8, s[44:47], s88 offen sc1
    s_waitcnt vmcnt(0)
    s_branch L_cc_c
L_a1_p:
    s_add_u32 s63, s63, 1
    s_cmp_ge_u32 s63, 65536
    s_cbranch_scc1 L_a1_o
    s_nop 7
    buffer_load_dwordx4 v[128:131], v10, s[44:47], s90 offen sc1
    buffer_load_dwordx4 v[160:163], v10, s[44:47], s91 offen sc1
    s_waitcnt vmcnt(0)
    s_branch L_a1_c
L_bs_p:
    s_add_u32 s63, s63, 1
    s_cmp_ge_u32 s63, 65536
    s_cbranch_scc1 L_bs_o
    s_nop 7
    s_sleep 2
    buffer_load_dword v48, v42, s[44:47], s72 offen sc1
    s_waitcnt vmcnt(0)
    s_branch L_bs_c
L_y_p:
    s_add_u32 s63, s63, 1
    s_cmp_ge_u32 s63, 65536
    s_cbranch_scc1 L_y_o
    s_nop 7
    s_sleep 2
    buffer_load_dwordx4 v[32:35], v46, s[44:47], s65 offen sc1
    buffer_load_dwordx4 v[36:39], v47, s[44:47], s65 offen sc1
    s_waitcnt vmcnt(0)
    s_branch L_y_c
L_exit:
    s_endpgm
L_code_end:
L_exact:
    s_nop 15
    s_nop 15
    s_cmp_lg_u32 s53, 0
    s_cbranch_scc1 L_xk0
    v_readlane_b32 s57, v96, 0
    v_readlane_b32 s58, v96, 32
    s_nop 1
    v_mov_b32 v16, s58
    s_mov_b32 exec_hi, 0
    v_mov_b32 v16, s57
    s_mov_b64 exec, -1
    v_readlane_b32 s57, v97, 0
    v_readlane_b32 s58, v97, 32
    s_nop 1
    v_mov_b32 v17, s58
    s_mov_b32 exec_hi, 0
    v_mov_b32 v17, s57
    s_mov_b64 exec, -1
    v_readlane_b32 s57, v98, 0
    v_readlane_b32 s58, v98, 32
    s_nop 1
    v_mov_b32 v18, s58
    s_mov_b32 exec_hi, 0
    v_mov_b32 v18, s57
    s_mov_b64 exec, -1
    v_readlane_b32 s57, v99, 0
    v_readlane_b32 s58, v99, 32
    s_nop 1
    v_mov_b32 v19, s58
    s_mov_b32 exec_hi, 0
    v_mov_b32 v19, s57
    s_mov_b64 exec, -1
    v_mov_b64 v[128:129], v[16:17]
    v_mov_b64 v[130:131], v[18:19]
    v_mov_b64 v[132:133], v[16:17]
    v_mov_b64 v[134:135], v[18:19]
    v_mov_b64 v[136:137], v[16:17]
    v_mov_b64 v[138:139], v[18:19]
    v_mov_b64 v[140:141], v[16:17]
    v_mov_b64 v[142:143], v[18:19]
    v_mov_b64 v[144:145], v[16:17]
    v_mov_b64 v[146:147], v[18:19]
    v_mov_b64 v[148:149], v[16:17]
    v_mov_b64 v[150:151], v[18:19]
    v_mov_b64 v[152:153], v[16:17]
    v_mov_b64 v[154:155], v[18:19]
    v_mov_b64 v[156:157], v[16:17]
    v_mov_b64 v[158:159], v[18:19]
L_xk0:
    s_cmp_lg_u32 s53, 1
    s_cbranch_scc1 L_xk1
    v_readlane_b32 s57, v152, 0
    v_readlane_b32 s58, v152, 32
    s_nop 1
    v_mov_b32 v16, s58
    s_mov_b32 exec_hi, 0
    v_mov_b32 v16, s57
    s_mov_b64 exec, -1
    v_readlane_b32 s57, v153, 0
    v_readlane_b32 s58, v153, 32
    s_nop 1
    v_mov_b32 v17, s58
    s_mov_b32 exec_hi, 0
    v_mov_b32 v17, s57
    s_mov_b64 exec, -1
    v_readlane_b32 s57, v154, 0
    v_readlane_b32 s58, v154, 32
    s_nop 1
    v_mov_b32 v18, s58
    s_mov_b32 exec_hi, 0
    v_mov_b32 v18, s57
    s_mov_b64 exec, -1
    v_readlane_b32 s57, v155, 0
    v_readlane_b32 s58, v155, 32
    s_nop 1
    v_mov_b32 v19, s58
    s_mov_b32 exec_hi, 0
    v_mov_b32 v19, s57
    s_mov_b64 exec, -1
    v_mov_b64 v[128:129], v[16:17]
    v_mov_b64 v[130:131], v[18:19]
    v_mov_b64 v[132:133], v[16:17]
    v_mov_b64 v[134:135], v[18:19]
    v_mov_b64 v[136:137], v[16:17]
    v_mov_b64 v[138:139], v[18:19]
    v_mov_b64 v[140:141], v[16:17]
    v_mov_b64 v[142:143], v[18:19]
    v_mov_b64 v[144:145], v[16:17]
    v_mov_b64 v[146:147], v[18:19]
    v_mov_b64 v[148:149], v[16:17]
    v_mov_b64 v[150:151], v[18:19]
L_xk1:
    s_cmp_lg_u32 s53, 2
    s_cbranch_scc1 L_xk2
    v_readlane_b32 s57, v144, 0
    v_readlane_b32 s58, v144, 32
    s_nop 1
    v_mov_b32 v16, s58
    s_mov_b32 exec_hi, 0
    v_mov_b32 v16, s57
    s_mov_b64 exec, -1
    v_readlane_b32 s57, v145, 0
    v_readlane_b32 s58, v145, 32
    s_nop 1
    v_mov_b32 v17, s58
    s_mov_b32 exec_hi, 0
    v_mov_b32 v17, s57
    s_mov_b64 exec, -1
    v_readlane_b32 s57, v146, 0
    v_readlane_b32 s58, v146, 32
    s_nop 1
    v_mov_b32 v18, s58
    s_mov_b32 exec_hi, 0
    v_mov_b32 v18, s57
    s_mov_b64 exec, -1
    v_readlane_b32 s57, v147, 0
    v_readlane_b32 s58, v147, 32
    s_nop 1
    v_mov_b32 v19, s58
    s_mov_b32 exec_hi, 0
    v_mov_b32 v19, s57
    s_mov_b64 exec, -1
    v_mov_b64 v[128:129], v[16:17]
    v_mov_b64 v[130:131], v[18:19]
    v_mov_b64 v[132:133], v[16:17]
    v_mov_b64 v[134:135], v[18:19]
    v_mov_b64 v[136:137], v[16:17]
    v_mov_b64 v[138:139], v[18:19]
    v_mov_b64 v[140:141], v[16:17]
    v_mov_b64 v[142:143], v[18:19]
L_xk2:
    s_cmp_lg_u32 s53, 3
    s_cbranch_scc1 L_xk3
    v_readlane_b32 s57, v136, 0
    v_readlane_b32 s58, v136, 32
    s_nop 1
    v_mov_b32 v16, s58
    s_mov_b32 exec_hi, 0
    v_mov_b32 v16, s57
    s_mov_b64 exec, -1
    v_readlane_b32 s57, v137, 0
    v_readlane_b32 s58, v137, 32
    s_nop 1
    v_mov_b32 v17, s58
    s_mov_b32 exec_hi, 0
    v_mov_b32 v17, s57
    s_mov_b64 exec, -1
    v_readlane_b32 s57, v138, 0
    v_readlane_b32 s58, v138, 32
    s_nop 1
    v_mov_b32 v18, s58
    s_mov_b32 exec_hi, 0
    v_mov_b32 v18, s57
    s_mov_b64 exec, -1
    v_readlane_b32 s57, v139, 0
    v_readlane_b32 s58, v139, 32
    s_nop 1
    v_mov_b32 v19, s58
    s_mov_b32 exec_hi, 0
    v_mov_b32 v19, s57
    s_mov_b64 exec, -1
    v_mov_b64 v[128:129], v[16:17]
    v_mov_b64 v[130:131], v[18:19]
    v_mov_b64 v[132:133], v[16:17]
    v_mov_b64 v[134:135], v[18:19]
L_xk3:
    s_nop 1
    v_mfma_f32_32x32x16_bf16 v[64:79], v[96:99], v[120:123], 0
    v_mfma_f32_32x32x16_bf16 v[16:31], v[128:131], v[120:123], 0
    v_mfma_f32_32x32x16_bf16 v[32:47], v[132:135], v[120:123], 0
    v_mfma_f32_32x32x16_bf16 v[48:63], v[136:139], v[120:123], 0
    s_nop 9
    v_cndmask_b32 v64, v16, v64, s[64:65]
    v_cndmask_b32 v65, v17, v65, s[66:67]
    v_cndmask_b32 v66, v18, v66, s[68:69]
    v_cndmask_b32 v67, v19, v67, s[70:71]
    v_cndmask_b32 v68, v20, v68, s[82:83]
    v_cndmask_b32 v69, v21, v69, s[84:85]
    v_cndmask_b32 v70, v22, v70, s[86:87]
    v_cndmask_b32 v71, v23, v71, s[88:89]
    v_cndmask_b32 v72, v24, v72, s[90:91]
    v_cndmask_b32 v73, v25, v73, s[92:93]
    v_cndmask_b32 v74, v26, v74, s[94:95]
    v_cndmask_b32 v75, v27, v75, s[8:9]
    v_cndmask_b32 v76, v28, v76, s[10:11]
    v_cndmask_b32 v77, v29, v77, s[12:13]
    v_cndmask_b32 v78, v30, v78, s[14:15]
    v_cndmask_b32 v79, v31, v79, s[16:17]
    v_max_f32 v8, v64, v65
    v_max_f32 v9, v66, v67
    v_max3_f32 v8, v68, v69, v8
    v_max3_f32 v9, v70, v71, v9
    v_max3_f32 v8, v72, v73, v8
    v_max3_f32 v9, v74, v75, v9
    v_max3_f32 v8, v76, v77, v8
    v_max3_f32 v9, v78, v79, v9
    v_mfma_f32_32x32x16_bf16 v[16:31], v[140:143], v[120:123], 0
    v_max3_f32 v8, v32, v33, v8
    v_max3_f32 v9, v34, v35, v9
    v_max3_f32 v8, v36, v37, v8
    v_max3_f32 v9, v38, v39, v9
    v_max3_f32 v8, v40, v41, v8
    v_max3_f32 v9, v42, v43, v9
    v_max3_f32 v8, v44, v45, v8
    v_max3_f32 v9, v46, v47, v9
    v_mfma_f32_32x32x16_bf16 v[32:47], v[144:147], v[120:123], 0
    v_max3_f32 v8, v48, v49, v8
    v_max3_f32 v9, v50, v51, v9
    v_max3_f32 v8, v52, v53, v8
    v_max3_f32 v9, v54, v55, v9
    v_max3_f32 v8, v56, v57, v8
    v_max3_f32 v9, v58, v59, v9
    v_max3_f32 v8, v60, v61, v8
    v_max3_f32 v9, v62, v63, v9
    v_mfma_f32_32x32x16_bf16 v[48:63], v[148:151], v[120:123], 0
    v_max3_f32 v8, v16, v17, v8
    v_max3_f32 v9, v18, v19, v9
    v_max3_f32 v8, v20, v21, v8
    v_max3_f32 v9, v22, v23, v9
    v_max3_f32 v8, v24, v25, v8
    v_max3_f32 v9, v26, v27, v9
    v_max3_f32 v8, v28, v29, v8
    v_max3_f32 v9, v30, v31, v9
    v_mfma_f32_32x32x16_bf16 v[16:31], v[152:155], v[120:123], 0
    v_max3_f32 v8, v32, v33, v8
    v_max3_f32 v9, v34, v35, v9
    v_max3_f32 v8, v36, v37, v8
    v_max3_f32 v9, v38, v39, v9
    v_max3_f32 v8, v40, v41, v8
    v_max3_f32 v9, v42, v43, v9
    v_max3_f32 v8, v44, v45, v8
    v_max3_f32 v9, v46, v47, v9
    v_mfma_f32_32x32x16_bf16 v[32:47], v[156:159], v[120:123], 0
    v_max3_f32 v8, v48, v49, v8
    v_max3_f32 v9, v50, v51, v9
    v_max3_f32 v8, v52, v53, v8
    v_max3_f32 v9, v54, v55, v9
    v_max3_f32 v8, v56, v57, v8
    v_max3_f32 v9, v58, v59, v9
    v_max3_f32 v8, v60, v61, v8
    v_max3_f32 v9, v62, v63, v9
    v_mfma_f32_32x32x16_bf16 v[224:239], v[100:103], v[124:127], 0
    v_mfma_f32_32x32x16_bf16 v[48:63], v[132:135], v[124:127], 0
    v_max3_f32 v8, v16, v17, v8
    v_max3_f32 v9, v18, v19, v9
    v_max3_f32 v8, v20, v21, v8
    v_max3_f32 v9, v22, v23, v9
    v_max3_f32 v8, v24, v25, v8
    v_max3_f32 v9, v26, v27, v9
    v_max3_f32 v8, v28, v29, v8
    v_max3_f32 v9, v30, v31, v9
    v_mfma_f32_32x32x16_bf16 v[16:31], v[136:139], v[124:127], 0
    v_max3_f32 v8, v32, v33, v8
    v_max3_f32 v9, v34, v35, v9
    v_max3_f32 v8, v36, v37, v8
    v_max3_f32 v9, v38, v39, v9
    v_max3_f32 v8, v40, v41, v8
    v_max3_f32 v9, v42, v43, v9
    v_max3_f32 v8, v44, v45, v8
    v_max3_f32 v9, v46, v47, v9
    v_mfma_f32_32x32x16_bf16 v[32:47], v[140:143], v[124:127], 0
    v_cndmask_b32 v224, v48, v224, s[64:65]
    v_cndmask_b32 v225, v49, v225, s[66:67]
    v_cndmask_b32 v226, v50, v226, s[68:69]
    v_cndmask_b32 v227, v51, v227, s[70:71]
    v_cndmask_b32 v228, v52, v228, s[82:83]
    v_cndmask_b32 v229, v53, v229, s[84:85]
    v_cndmask_b32 v230, v54, v230, s[86:87]
    v_cndmask_b32 v231, v55, v231, s[88:89]
    v_cndmask_b32 v232, v56, v232, s[90:91]
    v_cndmask_b32 v233, v57, v233, s[92:93]
    v_cndmask_b32 v234, v58, v234, s[94:95]
    v_cndmask_b32 v235, v59, v235, s[8:9]
    v_cndmask_b32 v236, v60, v236, s[10:11]
    v_cndmask_b32 v237, v61, v237, s[12:13]
    v_cndmask_b32 v238, v62, v238, s[14:15]
    v_cndmask_b32 v239, v63, v239, s[16:17]
    v_max_f32 v10, v224, v225
    v_max_f32 v11, v226, v227
    v_max3_f32 v10, v228, v229, v10
    v_max3_f32 v11, v230, v231, v11
    v_max3_f32 v10, v232, v233, v10
    v_max3_f32 v11, v234, v235, v11
    v_max3_f32 v10, v236, v237, v10
    v_max3_f32 v11, v238, v239, v11
    v_mfma_f32_32x32x16_bf16 v[48:63], v[144:147], v[124:127], 0
    v_max3_f32 v10, v16, v17, v10
    v_max3_f32 v11, v18, v19, v11
    v_max3_f32 v10, v20, v21, v10
    v_max3_f32 v11, v22, v23, v11
    v_max3_f32 v10, v24, v25, v10
    v_max3_f32 v11, v26, v27, v11
    v_max3_f32 v10, v28, v29, v10
    v_max3_f32 v11, v30, v31, v11
    v_mfma_f32_32x32x16_bf16 v[16:31], v[148:151], v[124:127], 0
    v_max3_f32 v10, v32, v33, v10
    v_max3_f32 v11, v34, v35, v11
    v_max3_f32 v10, v36, v37, v10
    v_max3_f32 v11, v38, v39, v11
    v_max3_f32 v10, v40, v41, v10
    v_max3_f32 v11, v42, v43, v11
    v_max3_f32 v10, v44, v45, v10
    v_max3_f32 v11, v46, v47, v11
    v_mfma_f32_32x32x16_bf16 v[32:47], v[152:155], v[124:127], 0
    v_max3_f32 v10, v48, v49, v10
    v_max3_f32 v11, v50, v51, v11
    v_max3_f32 v10, v52, v53, v10
    v_max3_f32 v11, v54, v55, v11
    v_max3_f32 v10, v56, v57, v10
    v_max3_f32 v11, v58, v59, v11
    v_max3_f32 v10, v60, v61, v10
    v_max3_f32 v11, v62, v63, v11
    v_mfma_f32_32x32x16_bf16 v[48:63], v[156:159], v[124:127], 0
    v_max3_f32 v10, v16, v17, v10
    v_max3_f32 v11, v18, v19, v11
    v_max3_f32 v10, v20, v21, v10
    v_max3_f32 v11, v22, v23, v11
    v_max3_f32 v10, v24, v25, v10
    v_max3_f32 v11, v26, v27, v11
    v_max3_f32 v10, v28, v29, v10
    v_max3_f32 v11, v30, v31, v11
    v_mfma_f32_32x32x16_bf16 v[16:31], v[96:99], v[124:127], 0
    v_max3_f32 v10, v32, v33, v10
    v_max3_f32 v11, v34, v35, v11
    v_max3_f32 v10, v36, v37, v10
    v_max3_f32 v11, v38, v39, v11
    v_max3_f32 v10, v40, v41, v10
    v_max3_f32 v11, v42, v43, v11
    v_max3_f32 v10, v44, v45, v10
    v_max3_f32 v11, v46, v47, v11
    v_max3_f32 v10, v48, v49, v10
    v_max3_f32 v11, v50, v51, v11
    v_max3_f32 v10, v52, v53, v10
    v_max3_f32 v11, v54, v55, v11
    v_max3_f32 v10, v56, v57, v10
    v_max3_f32 v11, v58, v59, v11
    v_max3_f32 v10, v60, v61, v10
    v_max3_f32 v11, v62, v63, v11
    v_max3_f32 v10, v16, v17, v10
    v_max3_f32 v11, v18, v19, v11
    v_max3_f32 v10, v20, v21, v10
    v_max3_f32 v11, v22, v23, v11
    v_max3_f32 v10, v24, v25, v10
    v_max3_f32 v11, v26, v27, v11
    v_max3_f32 v10, v28, v29, v10
    v_max3_f32 v11, v30, v31, v11
    v_max_f32 v8, v8, v9
    v_mov_b32 v9, v8
    s_nop 1
    v_permlane32_swap_b32 v8, v9
    v_max_f32 v8, v8, v9
    v_sub_f32 v8, 0, v8
    v_mov_b32 v9, v8
    v_max_f32 v10, v10, v11
    v_mov_b32 v11, v10
    s_nop 1
    v_permlane32_swap_b32 v10, v11
    v_max_f32 v10, v10, v11
    v_sub_f32 v10, 0, v10
    v_mov_b32 v11, v10
    s_bitcmp1_b32 s2, 0
    s_cbranch_scc1 L_x2b
    v_add_f32 v224, v224, v10
    v_add_f32 v225, v225, v10
    v_add_f32 v226, v226, v10
    v_add_f32 v227, v227, v10
    v_add_f32 v228, v228, v10
    v_add_f32 v229, v229, v10
    v_add_f32 v230, v230, v10
    v_add_f32 v231, v231, v10
    v_mov_b64 v[80:81], v[10:11]
    v_mov_b64 v[82:83], v[10:11]
    v_mov_b64 v[84:85], v[10:11]
    v_mov_b64 v[86:87], v[10:11]
    v_mov_b64 v[88:89], v[10:11]
    v_mov_b64 v[90:91], v[10:11]
    v_mov_b64 v[92:93], v[10:11]
    v_mov_b64 v[94:95], v[10:11]
    v_add_f32 v232, v232, v10
    v_add_f32 v233, v233, v10
    v_add_f32 v234, v234, v10
    v_add_f32 v235, v235, v10
    v_add_f32 v236, v236, v10
    v_add_f32 v237, v237, v10
    v_add_f32 v238, v238, v10
    v_add_f32 v239, v239, v10
    v_exp_f32 v224, v224
    v_exp_f32 v225, v225
    v_exp_f32 v226, v226
    v_exp_f32 v227, v227
    v_cvt_pk_bf16_f32 v224, v224, v225
    v_exp_f32 v228, v228
    v_exp_f32 v229, v229
    v_cvt_pk_bf16_f32 v225, v226, v227
    v_exp_f32 v230, v230
    v_exp_f32 v231, v231
    v_cvt_pk_bf16_f32 v226, v228, v229
    v_exp_f32 v232, v232
    v_exp_f32 v233, v233
    v_cvt_pk_bf16_f32 v227, v230, v231
    v_exp_f32 v234, v234
    v_exp_f32 v235, v235
    v_mfma_f32_32x32x16_bf16 v[16:31], v[136:139], v[124:127], v[80:95]
    v_cvt_pk_bf16_f32 v228, v232, v233
    v_exp_f32 v236, v236
    v_exp_f32 v237, v237
    v_cvt_pk_bf16_f32 v229, v234, v235
    v_exp_f32 v238, v238
    v_exp_f32 v239, v239
    v_cvt_pk_bf16_f32 v230, v236, v237
    v_cvt_pk_bf16_f32 v231, v238, v239
    v_bfi_b32 v232, v240, 0, v224
    v_bfi_b32 v233, v241, 0, v225
    v_bfi_b32 v234, v242, 0, v226
    v_bfi_b32 v235, v243, 0, v227
    v_bfi_b32 v236, v244, 0, v228
    v_bfi_b32 v237, v245, 0, v229
    v_bfi_b32 v238, v246, 0, v230
    v_bfi_b32 v239, v247, 0, v231
    v_and_b32 v224, v240, v224
    v_and_b32 v225, v241, v225
    v_and_b32 v226, v242, v226
    v_and_b32 v227, v243, v227
    v_and_b32 v228, v244, v228
    v_and_b32 v229, v245, v229
    v_and_b32 v230, v246, v230
    v_and_b32 v231, v247, v231
    v_exp_f32 v16, v16
    v_mfma_f32_32x32x16_bf16 v[32:47], v[140:143], v[124:127], v[80:95]
    v_exp_f32 v17, v17
    v_exp_f32 v18, v18
    v_exp_f32 v19, v19
    v_cvt_pk_bf16_f32 v16, v16, v17
    v_exp_f32 v20, v20
    v_mfma_f32_32x32x16_bf16 v[48:63], v[108:111], v[224:227], 0
    v_mfma_f32_16x16x32_bf16 v[112:115], v[116:119], v[224:227], 0
    v_exp_f32 v21, v21
    v_cvt_pk_bf16_f32 v17, v18, v19
    v_exp_f32 v22, v22
    v_exp_f32 v23, v23
    v_cvt_pk_bf16_f32 v18, v20, v21
    v_mfma_f32_32x32x16_bf16 v[192:207], v[108:111], v[228:231], 0
    v_mfma_f32_16x16x32_bf16 v[112:115], v[116:119], v[228:231], v[112:115]
    v_exp_f32 v24, v24
    v_exp_f32 v25, v25
    v_cvt_pk_bf16_f32 v19, v22, v23
    v_exp_f32 v26, v26
    v_exp_f32 v27, v27
    v_mfma_f32_32x32x16_bf16 v[48:63], v[164:167], v[232:235], v[48:63]
    v_mfma_f32_16x16x32_bf16 v[112:115], v[208:211], v[232:235], v[112:115]
    v_cvt_pk_bf16_f32 v20, v24, v25
    v_exp_f32 v28, v28
    v_exp_f32 v29, v29
    v_cvt_pk_bf16_f32 v21, v26, v27
    v_exp_f32 v30, v30
    v_mfma_f32_32x32x16_bf16 v[192:207], v[164:167], v[236:239], v[192:207]
    v_mfma_f32_16x16x32_bf16 v[112:115], v[208:211], v[236:239], v[112:115]
    v_exp_f32 v31, v31
    v_cvt_pk_bf16_f32 v22, v28, v29
    v_cvt_pk_bf16_f32 v23, v30, v31
    v_exp_f32 v32, v32
    v_exp_f32 v33, v33
    v_mfma_f32_32x32x16_bf16 v[224:239], v[144:147], v[124:127], v[80:95]
    v_exp_f32 v34, v34
    v_exp_f32 v35, v35
    v_cvt_pk_bf16_f32 v32, v32, v33
    v_exp_f32 v36, v36
    v_exp_f32 v37, v37
    v_cvt_pk_bf16_f32 v33, v34, v35
    v_exp_f32 v38, v38
    v_exp_f32 v39, v39
    v_mfma_f32_32x32x16_bf16 v[48:63], v[168:171], v[16:19], v[48:63]
    v_mfma_f32_16x16x32_bf16 v[112:115], v[212:215], v[16:19], v[112:115]
    v_cvt_pk_bf16_f32 v34, v36, v37
    v_exp_f32 v40, v40
    v_exp_f32 v41, v41
    v_cvt_pk_bf16_f32 v35, v38, v39
    v_exp_f32 v42, v42
    v_exp_f32 v43, v43
    v_cvt_pk_bf16_f32 v36, v40, v41
    v_exp_f32 v44, v44
    v_mfma_f32_32x32x16_bf16 v[192:207], v[168:171], v[20:23], v[192:207]
    v_mfma_f32_16x16x32_bf16 v[112:115], v[212:215], v[20:23], v[112:115]
    v_exp_f32 v45, v45
    v_cvt_pk_bf16_f32 v37, v42, v43
    v_exp_f32 v46, v46
    v_exp_f32 v47, v47
    v_cvt_pk_bf16_f32 v38, v44, v45
    v_cvt_pk_bf16_f32 v39, v46, v47
    v_exp_f32 v224, v224
    v_exp_f32 v225, v225
    v_mfma_f32_32x32x16_bf16 v[16:31], v[148:151], v[124:127], v[80:95]
    v_exp_f32 v226, v226
    v_exp_f32 v227, v227
    v_cvt_pk_bf16_f32 v224, v224, v225
    v_exp_f32 v228, v228
    v_exp_f32 v229, v229
    v_cvt_pk_bf16_f32 v225, v226, v227
    v_exp_f32 v230, v230
    v_exp_f32 v231, v231
    v_mfma_f32_32x32x16_bf16 v[48:63], v[172:175], v[32:35], v[48:63]
    v_mfma_f32_16x16x32_bf16 v[112:115], v[212:215], v[32:35], v[112:115]
    v_cvt_pk_bf16_f32 v226, v228, v229
    v_exp_f32 v232, v232
    v_exp_f32 v233, v233
    v_cvt_pk_bf16_f32 v227, v230, v231
    v_exp_f32 v234, v234
    v_exp_f32 v235, v235
    v_cvt_pk_bf16_f32 v228, v232, v233
    v_exp_f32 v236, v236
    v_mfma_f32_32x32x16_bf16 v[192:207], v[172:175], v[36:39], v[192:207]
    v_mfma_f32_16x16x32_bf16 v[112:115], v[212:215], v[36:39], v[112:115]
    v_exp_f32 v237, v237
    v_cvt_pk_bf16_f32 v229, v234, v235
    v_exp_f32 v238, v238
    v_exp_f32 v239, v239
    v_cvt_pk_bf16_f32 v230, v236, v237
    v_cvt_pk_bf16_f32 v231, v238, v239
    v_exp_f32 v16, v16
    v_exp_f32 v17, v17
    v_mfma_f32_32x32x16_bf16 v[32:47], v[152:155], v[124:127], v[80:95]
    v_exp_f32 v18, v18
    v_exp_f32 v19, v19
    v_cvt_pk_bf16_f32 v16, v16, v17
    v_exp_f32 v20, v20
    v_exp_f32 v21, v21
    v_cvt_pk_bf16_f32 v17, v18, v19
    v_exp_f32 v22, v22
    v_exp_f32 v23, v23
    v_mfma_f32_32x32x16_bf16 v[48:63], v[176:179], v[224:227], v[48:63]
    v_mfma_f32_16x16x32_bf16 v[112:115], v[216:219], v[224:227], v[112:115]
    v_cvt_pk_bf16_f32 v18, v20, v21
    v_exp_f32 v24, v24
    v_exp_f32 v25, v25
    v_cvt_pk_bf16_f32 v19, v22, v23
    v_exp_f32 v26, v26
    v_exp_f32 v27, v27
    v_cvt_pk_bf16_f32 v20, v24, v25
    v_exp_f32 v28, v28
    v_mfma_f32_32x32x16_bf16 v[192:207], v[176:179], v[228:231], v[192:207]
    v_mfma_f32_16x16x32_bf16 v[112:115], v[216:219], v[228:231], v[112:115]
    v_exp_f32 v29, v29
    v_cvt_pk_bf16_f32 v21, v26, v27
    v_exp_f32 v30, v30
    v_exp_f32 v31, v31
    v_cvt_pk_bf16_f32 v22, v28, v29
    v_cvt_pk_bf16_f32 v23, v30, v31
    v_exp_f32 v32, v32
    v_exp_f32 v33, v33
    v_mfma_f32_32x32x16_bf16 v[224:239], v[156:159], v[124:127], v[80:95]
    v_exp_f32 v34, v34
    v_exp_f32 v35, v35
    v_cvt_pk_bf16_f32 v32, v32, v33
    v_exp_f32 v36, v36
    v_exp_f32 v37, v37
    v_cvt_pk_bf16_f32 v33, v34, v35
    v_exp_f32 v38, v38
    v_exp_f32 v39, v39
    v_mfma_f32_32x32x16_bf16 v[48:63], v[180:183], v[16:19], v[48:63]
    v_mfma_f32_16x16x32_bf16 v[112:115], v[216:219], v[16:19], v[112:115]
    v_cvt_pk_bf16_f32 v34, v36, v37
    v_exp_f32 v40, v40
    v_exp_f32 v41, v41
    v_cvt_pk_bf16_f32 v35, v38, v39
    v_exp_f32 v42, v42
    v_exp_f32 v43, v43
    v_cvt_pk_bf16_f32 v36, v40, v41
    v_exp_f32 v44, v44
    v_mfma_f32_32x32x16_bf16 v[192:207], v[180:183], v[20:23], v[192:207]
    v_mfma_f32_16x16x32_bf16 v[112:115], v[216:219], v[20:23], v[112:115]
    v_exp_f32 v45, v45
    v_cvt_pk_bf16_f32 v37, v42, v43
    v_exp_f32 v46, v46
    v_exp_f32 v47, v47
    v_cvt_pk_bf16_f32 v38, v44, v45
    v_cvt_pk_bf16_f32 v39, v46, v47
    v_exp_f32 v224, v224
    v_exp_f32 v225, v225
    v_mfma_f32_32x32x16_bf16 v[16:31], v[96:99], v[124:127], v[80:95]
    v_exp_f32 v226, v226
    v_exp_f32 v227, v227
    v_cvt_pk_bf16_f32 v224, v224, v225
    v_exp_f32 v228, v228
    v_exp_f32 v229, v229
    v_cvt_pk_bf16_f32 v225, v226, v227
    v_exp_f32 v230, v230
    v_exp_f32 v231, v231
    v_mfma_f32_32x32x16_bf16 v[48:63], v[184:187], v[32:35], v[48:63]
    v_mfma_f32_16x16x32_bf16 v[112:115], v[220:223], v[32:35], v[112:115]
    v_cvt_pk_bf16_f32 v226, v228, v229
    v_exp_f32 v232, v232
    v_exp_f32 v233, v233
    v_cvt_pk_bf16_f32 v227, v230, v231
    v_exp_f32 v234, v234
    v_exp_f32 v235, v235
    v_cvt_pk_bf16_f32 v228, v232, v233
    v_exp_f32 v236, v236
    v_mfma_f32_32x32x16_bf16 v[192:207], v[184:187], v[36:39], v[192:207]
    v_mfma_f32_16x16x32_bf16 v[112:115], v[220:223], v[36:39], v[112:115]
    v_exp_f32 v237, v237
    v_cvt_pk_bf16_f32 v229, v234, v235
    v_exp_f32 v238, v238
    v_exp_f32 v239, v239
    v_cvt_pk_bf16_f32 v230, v236, v237
    v_cvt_pk_bf16_f32 v231, v238, v239
    v_exp_f32 v16, v16
    v_exp_f32 v17, v17
    v_mfma_f32_32x32x16_bf16 v[48:63], v[188:191], v[224:227], v[48:63]
    v_mfma_f32_16x16x32_bf16 v[112:115], v[220:223], v[224:227], v[112:115]
    v_exp_f32 v18, v18
    v_exp_f32 v19, v19
    v_cvt_pk_bf16_f32 v16, v16, v17
    v_exp_f32 v20, v20
    v_exp_f32 v21, v21
    v_cvt_pk_bf16_f32 v17, v18, v19
    v_exp_f32 v22, v22
    v_exp_f32 v23, v23
    v_cvt_pk_bf16_f32 v18, v20, v21
    v_exp_f32 v24, v24
    v_exp_f32 v25, v25
    v_cvt_pk_bf16_f32 v19, v22, v23
    v_mfma_f32_32x32x16_bf16 v[192:207], v[188:191], v[228:231], v[192:207]
    v_mfma_f32_16x16x32_bf16 v[112:115], v[220:223], v[228:231], v[112:115]
    v_exp_f32 v26, v26
    v_exp_f32 v27, v27
    v_cvt_pk_bf16_f32 v20, v24, v25
    v_exp_f32 v28, v28
    v_exp_f32 v29, v29
    v_cvt_pk_bf16_f32 v21, v26, v27
    v_exp_f32 v30, v30
    v_exp_f32 v31, v31
    v_cvt_pk_bf16_f32 v22, v28, v29
    v_cvt_pk_bf16_f32 v23, v30, v31
    v_add_f32 v64, v64, v8
    v_add_f32 v65, v65, v8
    v_mfma_f32_32x32x16_bf16 v[48:63], v[104:107], v[16:19], v[48:63]
    v_mfma_f32_16x16x32_bf16 v[112:115], v[116:119], v[16:19], v[112:115]
    v_add_f32 v66, v66, v8
    v_add_f32 v67, v67, v8
    v_add_f32 v68, v68, v8
    v_add_f32 v69, v69, v8
    v_mfma_f32_32x32x16_bf16 v[192:207], v[104:107], v[20:23], v[192:207]
    v_mfma_f32_16x16x32_bf16 v[112:115], v[116:119], v[20:23], v[112:115]
    v_add_f32 v70, v70, v8
    v_add_f32 v71, v71, v8
    v_mov_b64 v[80:81], v[8:9]
    v_mov_b64 v[82:83], v[8:9]
    v_mov_b64 v[84:85], v[8:9]
    v_mov_b64 v[86:87], v[8:9]
    v_mov_b64 v[88:89], v[8:9]
    v_mov_b64 v[90:91], v[8:9]
    v_mov_b64 v[92:93], v[8:9]
    v_mov_b64 v[94:95], v[8:9]
    v_add_f32 v72, v72, v8
    v_add_f32 v73, v73, v8
    v_add_f32 v74, v74, v8
    v_add_f32 v75, v75, v8
    v_add_f32 v76, v76, v8
    v_add_f32 v77, v77, v8
    v_add_f32 v78, v78, v8
    v_rcp_f32 v56, v112
    s_add_u32 s57, s81, 32768
    s_add_u32 s58, s19, 8192
    v_pk_add_f32 v[48:49], v[48:49], v[200:201]
    v_pk_add_f32 v[50:51], v[50:51], v[202:203]
    v_pk_add_f32 v[52:53], v[52:53], v[204:205]
    v_pk_add_f32 v[54:55], v[54:55], v[206:207]
    v_pk_mul_f32 v[48:49], v[48:49], v[56:57] op_sel_hi:[1,0]
    v_pk_mul_f32 v[50:51], v[50:51], v[56:57] op_sel_hi:[1,0]
    v_pk_mul_f32 v[52:53], v[52:53], v[56:57] op_sel_hi:[1,0]
    v_pk_mul_f32 v[54:55], v[54:55], v[56:57] op_sel_hi:[1,0]
    v_cvt_pk_bf16_f32 v60, v48, v49
    v_cvt_pk_bf16_f32 v61, v50, v51
    v_cvt_pk_bf16_f32 v62, v52, v53
    v_cvt_pk_bf16_f32 v63, v54, v55
    s_cmp_eq_u32 s33, 1
    s_cbranch_scc1 L_xs1
    buffer_store_dwordx4 v[60:63], v1, s[44:47], s57 offen sc1
    v_add3_u32 v56, v60, v61, s56
    v_add3_u32 v56, v62, v63, v56
    buffer_store_dword v56, v14, s[44:47], s58 offen sc1
L_xs1:
    v_add_f32 v79, v79, v8
    v_exp_f32 v64, v64
    v_exp_f32 v65, v65
    v_exp_f32 v66, v66
    v_exp_f32 v67, v67
    v_cvt_pk_bf16_f32 v64, v64, v65
    v_exp_f32 v68, v68
    v_exp_f32 v69, v69
    v_cvt_pk_bf16_f32 v65, v66, v67
    v_exp_f32 v70, v70
    v_exp_f32 v71, v71
    v_cvt_pk_bf16_f32 v66, v68, v69
    v_exp_f32 v72, v72
    v_exp_f32 v73, v73
    v_cvt_pk_bf16_f32 v67, v70, v71
    v_exp_f32 v74, v74
    v_exp_f32 v75, v75
    v_mfma_f32_32x32x16_bf16 v[32:47], v[132:135], v[120:123], v[80:95]
    v_cvt_pk_bf16_f32 v68, v72, v73
    v_exp_f32 v76, v76
    v_exp_f32 v77, v77
    v_cvt_pk_bf16_f32 v69, v74, v75
    v_exp_f32 v78, v78
    v_exp_f32 v79, v79
    v_cvt_pk_bf16_f32 v70, v76, v77
    v_cvt_pk_bf16_f32 v71, v78, v79
    v_bfi_b32 v72, v240, 0, v64
    v_bfi_b32 v73, v241, 0, v65
    v_bfi_b32 v74, v242, 0, v66
    v_bfi_b32 v75, v243, 0, v67
    v_bfi_b32 v76, v244, 0, v68
    v_bfi_b32 v77, v245, 0, v69
    v_bfi_b32 v78, v246, 0, v70
    v_bfi_b32 v79, v247, 0, v71
    v_and_b32 v64, v240, v64
    v_and_b32 v65, v241, v65
    v_and_b32 v66, v242, v66
    v_and_b32 v67, v243, v67
    v_and_b32 v68, v244, v68
    v_and_b32 v69, v245, v69
    v_and_b32 v70, v246, v70
    v_and_b32 v71, v247, v71
    v_exp_f32 v32, v32
    v_mfma_f32_32x32x16_bf16 v[224:239], v[136:139], v[120:123], v[80:95]
    v_exp_f32 v33, v33
    v_exp_f32 v34, v34
    v_exp_f32 v35, v35
    v_cvt_pk_bf16_f32 v32, v32, v33
    v_exp_f32 v36, v36
    v_mfma_f32_32x32x16_bf16 v[48:63], v[104:107], v[64:67], 0
    v_mfma_f32_16x16x32_bf16 v[112:115], v[116:119], v[64:67], 0
    v_exp_f32 v37, v37
    v_cvt_pk_bf16_f32 v33, v34, v35
    v_exp_f32 v38, v38
    v_exp_f32 v39, v39
    v_cvt_pk_bf16_f32 v34, v36, v37
    v_mfma_f32_32x32x16_bf16 v[192:207], v[104:107], v[68:71], 0
    v_mfma_f32_16x16x32_bf16 v[112:115], v[116:119], v[68:71], v[112:115]
    v_exp_f32 v40, v40
    v_exp_f32 v41, v41
    v_cvt_pk_bf16_f32 v35, v38, v39
    v_exp_f32 v42, v42
    v_exp_f32 v43, v43
    v_mfma_f32_32x32x16_bf16 v[48:63], v[160:163], v[72:75], v[48:63]
    v_mfma_f32_16x16x32_bf16 v[112:115], v[208:211], v[72:75], v[112:115]
    v_cvt_pk_bf16_f32 v36, v40, v41
    v_exp_f32 v44, v44
    v_exp_f32 v45, v45
    v_cvt_pk_bf16_f32 v37, v42, v43
    v_exp_f32 v46, v46
    v_mfma_f32_32x32x16_bf16 v[192:207], v[160:163], v[76:79], v[192:207]
    v_mfma_f32_16x16x32_bf16 v[112:115], v[208:211], v[76:79], v[112:115]
    v_exp_f32 v47, v47
    v_cvt_pk_bf16_f32 v38, v44, v45
    v_cvt_pk_bf16_f32 v39, v46, v47
    v_exp_f32 v224, v224
    v_exp_f32 v225, v225
    v_mfma_f32_32x32x16_bf16 v[16:31], v[140:143], v[120:123], v[80:95]
    v_exp_f32 v226, v226
    v_exp_f32 v227, v227
    v_cvt_pk_bf16_f32 v224, v224, v225
    v_exp_f32 v228, v228
    v_exp_f32 v229, v229
    v_cvt_pk_bf16_f32 v225, v226, v227
    v_exp_f32 v230, v230
    v_exp_f32 v231, v231
    v_mfma_f32_32x32x16_bf16 v[48:63], v[164:167], v[32:35], v[48:63]
    v_mfma_f32_16x16x32_bf16 v[112:115], v[208:211], v[32:35], v[112:115]
    v_cvt_pk_bf16_f32 v226, v228, v229
    v_exp_f32 v232, v232
    v_exp_f32 v233, v233
    v_cvt_pk_bf16_f32 v227, v230, v231
    v_exp_f32 v234, v234
    v_exp_f32 v235, v235
    v_cvt_pk_bf16_f32 v228, v232, v233
    v_exp_f32 v236, v236
    v_mfma_f32_32x32x16_bf16 v[192:207], v[164:167], v[36:39], v[192:207]
    v_mfma_f32_16x16x32_bf16 v[112:115], v[208:211], v[36:39], v[112:115]
    v_exp_f32 v237, v237
    v_cvt_pk_bf16_f32 v229, v234, v235
    v_exp_f32 v238, v238
    v_exp_f32 v239, v239
    v_cvt_pk_bf16_f32 v230, v236, v237
    v_cvt_pk_bf16_f32 v231, v238, v239
    v_exp_f32 v16, v16
    v_exp_f32 v17, v17
    v_mfma_f32_32x32x16_bf16 v[32:47], v[144:147], v[120:123], v[80:95]
    v_exp_f32 v18, v18
    v_exp_f32 v19, v19
    v_cvt_pk_bf16_f32 v16, v16, v17
    v_exp_f32 v20, v20
    v_exp_f32 v21, v21
    v_cvt_pk_bf16_f32 v17, v18, v19
    v_exp_f32 v22, v22
    v_exp_f32 v23, v23
    v_mfma_f32_32x32x16_bf16 v[48:63], v[168:171], v[224:227], v[48:63]
    v_mfma_f32_16x16x32_bf16 v[112:115], v[212:215], v[224:227], v[112:115]
    v_cvt_pk_bf16_f32 v18, v20, v21
    v_exp_f32 v24, v24
    v_exp_f32 v25, v25
    v_cvt_pk_bf16_f32 v19, v22, v23
    v_exp_f32 v26, v26
    v_exp_f32 v27, v27
    v_cvt_pk_bf16_f32 v20, v24, v25
    v_exp_f32 v28, v28
    v_mfma_f32_32x32x16_bf16 v[192:207], v[168:171], v[228:231], v[192:207]
    v_mfma_f32_16x16x32_bf16 v[112:115], v[212:215], v[228:231], v[112:115]
    v_exp_f32 v29, v29
    v_cvt_pk_bf16_f32 v21, v26, v27
    v_exp_f32 v30, v30
    v_exp_f32 v31, v31
    v_cvt_pk_bf16_f32 v22, v28, v29
    v_cvt_pk_bf16_f32 v23, v30, v31
    v_exp_f32 v32, v32
    v_exp_f32 v33, v33
    v_mfma_f32_32x32x16_bf16 v[224:239], v[148:151], v[120:123], v[80:95]
    v_exp_f32 v34, v34
    v_exp_f32 v35, v35
    v_cvt_pk_bf16_f32 v32, v32, v33
    v_exp_f32 v36, v36
    v_exp_f32 v37, v37
    v_cvt_pk_bf16_f32 v33, v34, v35
    v_exp_f32 v38, v38
    v_exp_f32 v39, v39
    v_mfma_f32_32x32x16_bf16 v[48:63], v[172:175], v[16:19], v[48:63]
    v_mfma_f32_16x16x32_bf16 v[112:115], v[212:215], v[16:19], v[112:115]
    v_cvt_pk_bf16_f32 v34, v36, v37
    v_exp_f32 v40, v40
    v_exp_f32 v41, v41
    v_cvt_pk_bf16_f32 v35, v38, v39
    v_exp_f32 v42, v42
    v_exp_f32 v43, v43
    v_cvt_pk_bf16_f32 v36, v40, v41
    v_exp_f32 v44, v44
    v_mfma_f32_32x32x16_bf16 v[192:207], v[172:175], v[20:23], v[192:207]
    v_mfma_f32_16x16x32_bf16 v[112:115], v[212:215], v[20:23], v[112:115]
    v_exp_f32 v45, v45
    v_cvt_pk_bf16_f32 v37, v42, v43
    v_exp_f32 v46, v46
    v_exp_f32 v47, v47
    v_cvt_pk_bf16_f32 v38, v44, v45
    v_cvt_pk_bf16_f32 v39, v46, v47
    v_exp_f32 v224, v224
    v_exp_f32 v225, v225
    v_mfma_f32_32x32x16_bf16 v[16:31], v[152:155], v[120:123], v[80:95]
    v_exp_f32 v226, v226
    v_exp_f32 v227, v227
    v_cvt_pk_bf16_f32 v224, v224, v225
    v_exp_f32 v228, v228
    v_exp_f32 v229, v229
    v_cvt_pk_bf16_f32 v225, v226, v227
    v_exp_f32 v230, v230
    v_exp_f32 v231, v231
    v_mfma_f32_32x32x16_bf16 v[48:63], v[176:179], v[32:35], v[48:63]
    v_mfma_f32_16x16x32_bf16 v[112:115], v[216:219], v[32:35], v[112:115]
    v_cvt_pk_bf16_f32 v226, v228, v229
    v_exp_f32 v232, v232
    v_exp_f32 v233, v233
    v_cvt_pk_bf16_f32 v227, v230, v231
    v_exp_f32 v234, v234
    v_exp_f32 v235, v235
    v_cvt_pk_bf16_f32 v228, v232, v233
    v_exp_f32 v236, v236
    v_mfma_f32_32x32x16_bf16 v[192:207], v[176:179], v[36:39], v[192:207]
    v_mfma_f32_16x16x32_bf16 v[112:115], v[216:219], v[36:39], v[112:115]
    v_exp_f32 v237, v237
    v_cvt_pk_bf16_f32 v229, v234, v235
    v_exp_f32 v238, v238
    v_exp_f32 v239, v239
    v_cvt_pk_bf16_f32 v230, v236, v237
    v_cvt_pk_bf16_f32 v231, v238, v239
    v_exp_f32 v16, v16
    v_exp_f32 v17, v17
    v_mfma_f32_32x32x16_bf16 v[32:47], v[156:159], v[120:123], v[80:95]
    v_exp_f32 v18, v18
    v_exp_f32 v19, v19
    v_cvt_pk_bf16_f32 v16, v16, v17
    v_exp_f32 v20, v20
    v_exp_f32 v21, v21
    v_cvt_pk_bf16_f32 v17, v18, v19
    v_exp_f32 v22, v22
    v_exp_f32 v23, v23
    v_mfma_f32_32x32x16_bf16 v[48:63], v[180:183], v[224:227], v[48:63]
    v_mfma_f32_16x16x32_bf16 v[112:115], v[216:219], v[224:227], v[112:115]
    v_cvt_pk_bf16_f32 v18, v20, v21
    v_exp_f32 v24, v24
    v_exp_f32 v25, v25
    v_cvt_pk_bf16_f32 v19, v22, v23
    v_exp_f32 v26, v26
    v_exp_f32 v27, v27
    v_cvt_pk_bf16_f32 v20, v24, v25
    v_exp_f32 v28, v28
    v_mfma_f32_32x32x16_bf16 v[192:207], v[180:183], v[228:231], v[192:207]
    v_mfma_f32_16x16x32_bf16 v[112:115], v[216:219], v[228:231], v[112:115]
    v_exp_f32 v29, v29
    v_cvt_pk_bf16_f32 v21, v26, v27
    v_exp_f32 v30, v30
    v_exp_f32 v31, v31
    v_cvt_pk_bf16_f32 v22, v28, v29
    v_cvt_pk_bf16_f32 v23, v30, v31
    v_exp_f32 v32, v32
    v_exp_f32 v33, v33
    v_mfma_f32_32x32x16_bf16 v[48:63], v[184:187], v[16:19], v[48:63]
    v_mfma_f32_16x16x32_bf16 v[112:115], v[220:223], v[16:19], v[112:115]
    v_exp_f32 v34, v34
    v_exp_f32 v35, v35
    v_cvt_pk_bf16_f32 v32, v32, v33
    v_exp_f32 v36, v36
    v_exp_f32 v37, v37
    v_cvt_pk_bf16_f32 v33, v34, v35
    v_exp_f32 v38, v38
    v_exp_f32 v39, v39
    v_cvt_pk_bf16_f32 v34, v36, v37
    v_exp_f32 v40, v40
    v_exp_f32 v41, v41
    v_cvt_pk_bf16_f32 v35, v38, v39
    v_mfma_f32_32x32x16_bf16 v[192:207], v[184:187], v[20:23], v[192:207]
    v_mfma_f32_16x16x32_bf16 v[112:115], v[220:223], v[20:23], v[112:115]
    v_exp_f32 v42, v42
    v_exp_f32 v43, v43
    v_cvt_pk_bf16_f32 v36, v40, v41
    v_exp_f32 v44, v44
    v_mfma_f32_32x32x16_bf16 v[48:63], v[188:191], v[32:35], v[48:63]
    v_mfma_f32_16x16x32_bf16 v[112:115], v[220:223], v[32:35], v[112:115]
    v_exp_f32 v45, v45
    v_cvt_pk_bf16_f32 v37, v42, v43
    v_exp_f32 v46, v46
    v_exp_f32 v47, v47
    v_cvt_pk_bf16_f32 v38, v44, v45
    v_cvt_pk_bf16_f32 v39, v46, v47
    s_nop 1
    v_mfma_f32_32x32x16_bf16 v[192:207], v[188:191], v[36:39], v[192:207]
    v_mfma_f32_16x16x32_bf16 v[112:115], v[220:223], v[36:39], v[112:115]
    s_bfe_u32 s35, s2, 0x30003
    s_lshr_b32 s57, s2, 6
    s_lshl2_add_u32 s35, s35, s57
    s_and_b32 s38, s2, 7
    s_mul_i32 s38, s38, 14
    s_add_u32 s38, s38, s35
    v_lshrrev_b32 v2, 1, v4
    v_mul_u32_u24 v7, 3584, v2
    v_and_b32 v2, 1, v4
    v_lshl_add_u32 v7, v2, 4, v7
    v_rcp_f32 v56, v112
    s_add_u32 s57, s81, 0
    s_add_u32 s58, s101, 0
    s_add_u32 s57, s57, s39
    s_add_u32 s58, s58, s39
    v_pk_add_f32 v[48:49], v[48:49], v[200:201]
    v_pk_add_f32 v[50:51], v[50:51], v[202:203]
    v_pk_add_f32 v[52:53], v[52:53], v[204:205]
    v_pk_add_f32 v[54:55], v[54:55], v[206:207]
    v_pk_mul_f32 v[48:49], v[48:49], v[56:57] op_sel_hi:[1,0]
    v_pk_mul_f32 v[50:51], v[50:51], v[56:57] op_sel_hi:[1,0]
    v_pk_mul_f32 v[52:53], v[52:53], v[56:57] op_sel_hi:[1,0]
    v_pk_mul_f32 v[54:55], v[54:55], v[56:57] op_sel_hi:[1,0]
    v_cvt_pk_bf16_f32 v60, v48, v49
    v_cvt_pk_bf16_f32 v61, v50, v51
    v_cvt_pk_bf16_f32 v62, v52, v53
    v_cvt_pk_bf16_f32 v63, v54, v55
    s_branch L_p2e
L_x2b:
    s_nop 1
    v_add_f32 v64, v64, v8
    v_add_f32 v65, v65, v8
    v_add_f32 v66, v66, v8
    v_add_f32 v67, v67, v8
    v_add_f32 v68, v68, v8
    v_add_f32 v69, v69, v8
    v_add_f32 v70, v70, v8
    v_add_f32 v71, v71, v8
    v_mov_b64 v[80:81], v[8:9]
    v_mov_b64 v[82:83], v[8:9]
    v_mov_b64 v[84:85], v[8:9]
    v_mov_b64 v[86:87], v[8:9]
    v_mov_b64 v[88:89], v[8:9]
    v_mov_b64 v[90:91], v[8:9]
    v_mov_b64 v[92:93], v[8:9]
    v_mov_b64 v[94:95], v[8:9]
    v_add_f32 v72, v72, v8
    v_add_f32 v73, v73, v8
    v_add_f32 v74, v74, v8
    v_add_f32 v75, v75, v8
    v_add_f32 v76, v76, v8
    v_add_f32 v77, v77, v8
    v_add_f32 v78, v78, v8
    v_add_f32 v79, v79, v8
    v_exp_f32 v64, v64
    v_exp_f32 v65, v65
    v_exp_f32 v66, v66
    v_exp_f32 v67, v67
    v_cvt_pk_bf16_f32 v64, v64, v65
    v_exp_f32 v68, v68
    v_exp_f32 v69, v69
    v_cvt_pk_bf16_f32 v65, v66, v67
    v_exp_f32 v70, v70
    v_exp_f32 v71, v71
    v_cvt_pk_bf16_f32 v66, v68, v69
    v_exp_f32 v72, v72
    v_exp_f32 v73, v73
    v_cvt_pk_bf16_f32 v67, v70, v71
    v_exp_f32 v74, v74
    v_exp_f32 v75, v75
    v_mfma_f32_32x32x16_bf16 v[16:31], v[132:135], v[120:123], v[80:95]
    v_cvt_pk_bf16_f32 v68, v72, v73
    v_exp_f32 v76, v76
    v_exp_f32 v77, v77
    v_cvt_pk_bf16_f32 v69, v74, v75
    v_exp_f32 v78, v78
    v_exp_f32 v79, v79
    v_cvt_pk_bf16_f32 v70, v76, v77
    v_cvt_pk_bf16_f32 v71, v78, v79
    v_bfi_b32 v72, v240, 0, v64
    v_bfi_b32 v73, v241, 0, v65
    v_bfi_b32 v74, v242, 0, v66
    v_bfi_b32 v75, v243, 0, v67
    v_bfi_b32 v76, v244, 0, v68
    v_bfi_b32 v77, v245, 0, v69
    v_bfi_b32 v78, v246, 0, v70
    v_bfi_b32 v79, v247, 0, v71
    v_and_b32 v64, v240, v64
    v_and_b32 v65, v241, v65
    v_and_b32 v66, v242, v66
    v_and_b32 v67, v243, v67
    v_and_b32 v68, v244, v68
    v_and_b32 v69, v245, v69
    v_and_b32 v70, v246, v70
    v_and_b32 v71, v247, v71
    v_exp_f32 v16, v16
    v_mfma_f32_32x32x16_bf16 v[32:47], v[136:139], v[120:123], v[80:95]
    v_exp_f32 v17, v17
    v_exp_f32 v18, v18
    v_exp_f32 v19, v19
    v_cvt_pk_bf16_f32 v16, v16, v17
    v_exp_f32 v20, v20
    v_mfma_f32_32x32x16_bf16 v[48:63], v[104:107], v[64:67], 0
    v_mfma_f32_16x16x32_bf16 v[112:115], v[116:119], v[64:67], 0
    v_exp_f32 v21, v21
    v_cvt_pk_bf16_f32 v17, v18, v19
    v_exp_f32 v22, v22
    v_exp_f32 v23, v23
    v_cvt_pk_bf16_f32 v18, v20, v21
    v_mfma_f32_32x32x16_bf16 v[192:207], v[104:107], v[68:71], 0
    v_mfma_f32_16x16x32_bf16 v[112:115], v[116:119], v[68:71], v[112:115]
    v_exp_f32 v24, v24
    v_exp_f32 v25, v25
    v_cvt_pk_bf16_f32 v19, v22, v23
    v_exp_f32 v26, v26
    v_exp_f32 v27, v27
    v_mfma_f32_32x32x16_bf16 v[48:63], v[160:163], v[72:75], v[48:63]
    v_mfma_f32_16x16x32_bf16 v[112:115], v[208:211], v[72:75], v[112:115]
    v_cvt_pk_bf16_f32 v20, v24, v25
    v_exp_f32 v28, v28
    v_exp_f32 v29, v29
    v_cvt_pk_bf16_f32 v21, v26, v27
    v_exp_f32 v30, v30
    v_mfma_f32_32x32x16_bf16 v[192:207], v[160:163], v[76:79], v[192:207]
    v_mfma_f32_16x16x32_bf16 v[112:115], v[208:211], v[76:79], v[112:115]
    v_exp_f32 v31, v31
    v_cvt_pk_bf16_f32 v22, v28, v29
    v_cvt_pk_bf16_f32 v23, v30, v31
    v_exp_f32 v32, v32
    v_exp_f32 v33, v33
    v_mfma_f32_32x32x16_bf16 v[64:79], v[140:143], v[120:123], v[80:95]
    v_exp_f32 v34, v34
    v_exp_f32 v35, v35
    v_cvt_pk_bf16_f32 v32, v32, v33
    v_exp_f32 v36, v36
    v_exp_f32 v37, v37
    v_cvt_pk_bf16_f32 v33, v34, v35
    v_exp_f32 v38, v38
    v_exp_f32 v39, v39
    v_mfma_f32_32x32x16_bf16 v[48:63], v[164:167], v[16:19], v[48:63]
    v_mfma_f32_16x16x32_bf16 v[112:115], v[208:211], v[16:19], v[112:115]
    v_cvt_pk_bf16_f32 v34, v36, v37
    v_exp_f32 v40, v40
    v_exp_f32 v41, v41
    v_cvt_pk_bf16_f32 v35, v38, v39
    v_exp_f32 v42, v42
    v_exp_f32 v43, v43
    v_cvt_pk_bf16_f32 v36, v40, v41
    v_exp_f32 v44, v44
    v_mfma_f32_32x32x16_bf16 v[192:207], v[164:167], v[20:23], v[192:207]
    v_mfma_f32_16x16x32_bf16 v[112:115], v[208:211], v[20:23], v[112:115]
    v_exp_f32 v45, v45
    v_cvt_pk_bf16_f32 v37, v42, v43
    v_exp_f32 v46, v46
    v_exp_f32 v47, v47
    v_cvt_pk_bf16_f32 v38, v44, v45
    v_cvt_pk_bf16_f32 v39, v46, v47
    v_exp_f32 v64, v64
    v_exp_f32 v65, v65
    v_mfma_f32_32x32x16_bf16 v[16:31], v[144:147], v[120:123], v[80:95]
    v_exp_f32 v66, v66
    v_exp_f32 v67, v67
    v_cvt_pk_bf16_f32 v64, v64, v65
    v_exp_f32 v68, v68
    v_exp_f32 v69, v69
    v_cvt_pk_bf16_f32 v65, v66, v67
    v_exp_f32 v70, v70
    v_exp_f32 v71, v71
    v_mfma_f32_32x32x16_bf16 v[48:63], v[168:171], v[32:35], v[48:63]
    v_mfma_f32_16x16x32_bf16 v[112:115], v[212:215], v[32:35], v[112:115]
    v_cvt_pk_bf16_f32 v66, v68, v69
    v_exp_f32 v72, v72
    v_exp_f32 v73, v73
    v_cvt_pk_bf16_f32 v67, v70, v71
    v_exp_f32 v74, v74
    v_exp_f32 v75, v75
    v_cvt_pk_bf16_f32 v68, v72, v73
    v_exp_f32 v76, v76
    v_mfma_f32_32x32x16_bf16 v[192:207], v[168:171], v[36:39], v[192:207]
    v_mfma_f32_16x16x32_bf16 v[112:115], v[212:215], v[36:39], v[112:115]
    v_exp_f32 v77, v77
    v_cvt_pk_bf16_f32 v69, v74, v75
    v_exp_f32 v78, v78
    v_exp_f32 v79, v79
    v_cvt_pk_bf16_f32 v70, v76, v77
    v_cvt_pk_bf16_f32 v71, v78, v79
    v_exp_f32 v16, v16
    v_exp_f32 v17, v17
    v_mfma_f32_32x32x16_bf16 v[32:47], v[148:151], v[120:123], v[80:95]
    v_exp_f32 v18, v18
    v_exp_f32 v19, v19
    v_cvt_pk_bf16_f32 v16, v16, v17
    v_exp_f32 v20, v20
    v_exp_f32 v21, v21
    v_cvt_pk_bf16_f32 v17, v18, v19
    v_exp_f32 v22, v22
    v_exp_f32 v23, v23
    v_mfma_f32_32x32x16_bf16 v[48:63], v[172:175], v[64:67], v[48:63]
    v_mfma_f32_16x16x32_bf16 v[112:115], v[212:215], v[64:67], v[112:115]
    v_cvt_pk_bf16_f32 v18, v20, v21
    v_exp_f32 v24, v24
    v_exp_f32 v25, v25
    v_cvt_pk_bf16_f32 v19, v22, v23
    v_exp_f32 v26, v26
    v_exp_f32 v27, v27
    v_cvt_pk_bf16_f32 v20, v24, v25
    v_exp_f32 v28, v28
    v_mfma_f32_32x32x16_bf16 v[192:207], v[172:175], v[68:71], v[192:207]
    v_mfma_f32_16x16x32_bf16 v[112:115], v[212:215], v[68:71], v[112:115]
    v_exp_f32 v29, v29
    v_cvt_pk_bf16_f32 v21, v26, v27
    v_exp_f32 v30, v30
    v_exp_f32 v31, v31
    v_cvt_pk_bf16_f32 v22, v28, v29
    v_cvt_pk_bf16_f32 v23, v30, v31
    v_exp_f32 v32, v32
    v_exp_f32 v33, v33
    v_mfma_f32_32x32x16_bf16 v[64:79], v[152:155], v[120:123], v[80:95]
    v_exp_f32 v34, v34
    v_exp_f32 v35, v35
    v_cvt_pk_bf16_f32 v32, v32, v33
    v_exp_f32 v36, v36
    v_exp_f32 v37, v37
    v_cvt_pk_bf16_f32 v33, v34, v35
    v_exp_f32 v38, v38
    v_exp_f32 v39, v39
    v_mfma_f32_32x32x16_bf16 v[48:63], v[176:179], v[16:19], v[48:63]
    v_mfma_f32_16x16x32_bf16 v[112:115], v[216:219], v[16:19], v[112:115]
    v_cvt_pk_bf16_f32 v34, v36, v37
    v_exp_f32 v40, v40
    v_exp_f32 v41, v41
    v_cvt_pk_bf16_f32 v35, v38, v39
    v_exp_f32 v42, v42
    v_exp_f32 v43, v43
    v_cvt_pk_bf16_f32 v36, v40, v41
    v_exp_f32 v44, v44
    v_mfma_f32_32x32x16_bf16 v[192:207], v[176:179], v[20:23], v[192:207]
    v_mfma_f32_16x16x32_bf16 v[112:115], v[216:219], v[20:23], v[112:115]
    v_exp_f32 v45, v45
    v_cvt_pk_bf16_f32 v37, v42, v43
    v_exp_f32 v46, v46
    v_exp_f32 v47, v47
    v_cvt_pk_bf16_f32 v38, v44, v45
    v_cvt_pk_bf16_f32 v39, v46, v47
    v_exp_f32 v64, v64
    v_exp_f32 v65, v65
    v_mfma_f32_32x32x16_bf16 v[16:31], v[156:159], v[120:123], v[80:95]
    v_exp_f32 v66, v66
    v_exp_f32 v67, v67
    v_cvt_pk_bf16_f32 v64, v64, v65
    v_exp_f32 v68, v68
    v_exp_f32 v69, v69
    v_cvt_pk_bf16_f32 v65, v66, v67
    v_exp_f32 v70, v70
    v_exp_f32 v71, v71
    v_mfma_f32_32x32x16_bf16 v[48:63], v[180:183], v[32:35], v[48:63]
    v_mfma_f32_16x16x32_bf16 v[112:115], v[216:219], v[32:35], v[112:115]
    v_cvt_pk_bf16_f32 v66, v68, v69
    v_exp_f32 v72, v72
    v_exp_f32 v73, v73
    v_cvt_pk_bf16_f32 v67, v70, v71
    v_exp_f32 v74, v74
    v_exp_f32 v75, v75
    v_cvt_pk_bf16_f32 v68, v72, v73
    v_exp_f32 v76, v76
    v_mfma_f32_32x32x16_bf16 v[192:207], v[180:183], v[36:39], v[192:207]
    v_mfma_f32_16x16x32_bf16 v[112:115], v[216:219], v[36:39], v[112:115]
    v_exp_f32 v77, v77
    v_cvt_pk_bf16_f32 v69, v74, v75
    v_exp_f32 v78, v78
    v_exp_f32 v79, v79
    v_cvt_pk_bf16_f32 v70, v76, v77
    v_cvt_pk_bf16_f32 v71, v78, v79
    v_exp_f32 v16, v16
    v_exp_f32 v17, v17
    v_mfma_f32_32x32x16_bf16 v[48:63], v[184:187], v[64:67], v[48:63]
    v_mfma_f32_16x16x32_bf16 v[112:115], v[220:223], v[64:67], v[112:115]
    v_exp_f32 v18, v18
    v_exp_f32 v19, v19
    v_cvt_pk_bf16_f32 v16, v16, v17
    v_exp_f32 v20, v20
    v_exp_f32 v21, v21
    v_cvt_pk_bf16_f32 v17, v18, v19
    v_exp_f32 v22, v22
    v_exp_f32 v23, v23
    v_cvt_pk_bf16_f32 v18, v20, v21
    v_exp_f32 v24, v24
    v_exp_f32 v25, v25
    v_cvt_pk_bf16_f32 v19, v22, v23
    v_mfma_f32_32x32x16_bf16 v[192:207], v[184:187], v[68:71], v[192:207]
    v_mfma_f32_16x16x32_bf16 v[112:115], v[220:223], v[68:71], v[112:115]
    v_exp_f32 v26, v26
    v_exp_f32 v27, v27
    v_cvt_pk_bf16_f32 v20, v24, v25
    v_exp_f32 v28, v28
    v_exp_f32 v29, v29
    v_cvt_pk_bf16_f32 v21, v26, v27
    v_exp_f32 v30, v30
    v_exp_f32 v31, v31
    v_cvt_pk_bf16_f32 v22, v28, v29
    v_cvt_pk_bf16_f32 v23, v30, v31
    v_add_f32 v224, v224, v10
    v_add_f32 v225, v225, v10
    v_mfma_f32_32x32x16_bf16 v[48:63], v[188:191], v[16:19], v[48:63]
    v_mfma_f32_16x16x32_bf16 v[112:115], v[220:223], v[16:19], v[112:115]
    v_add_f32 v226, v226, v10
    v_add_f32 v227, v227, v10
    v_add_f32 v228, v228, v10
    v_add_f32 v229, v229, v10
    v_mfma_f32_32x32x16_bf16 v[192:207], v[188:191], v[20:23], v[192:207]
    v_mfma_f32_16x16x32_bf16 v[112:115], v[220:223], v[20:23], v[112:115]
    v_add_f32 v230, v230, v10
    v_add_f32 v231, v231, v10
    v_mov_b64 v[80:81], v[10:11]
    v_mov_b64 v[82:83], v[10:11]
    v_mov_b64 v[84:85], v[10:11]
    v_mov_b64 v[86:87], v[10:11]
    v_mov_b64 v[88:89], v[10:11]
    v_mov_b64 v[90:91], v[10:11]
    v_mov_b64 v[92:93], v[10:11]
    v_mov_b64 v[94:95], v[10:11]
    v_add_f32 v232, v232, v10
    v_add_f32 v233, v233, v10
    v_add_f32 v234, v234, v10
    v_add_f32 v235, v235, v10
    v_add_f32 v236, v236, v10
    v_add_f32 v237, v237, v10
    v_add_f32 v238, v238, v10
    v_rcp_f32 v56, v112
    s_add_u32 s57, s81, 0
    s_add_u32 s58, s19, 0
    v_pk_add_f32 v[48:49], v[48:49], v[200:201]
    v_pk_add_f32 v[50:51], v[50:51], v[202:203]
    v_pk_add_f32 v[52:53], v[52:53], v[204:205]
    v_pk_add_f32 v[54:55], v[54:55], v[206:207]
    v_pk_mul_f32 v[48:49], v[48:49], v[56:57] op_sel_hi:[1,0]
    v_pk_mul_f32 v[50:51], v[50:51], v[56:57] op_sel_hi:[1,0]
    v_pk_mul_f32 v[52:53], v[52:53], v[56:57] op_sel_hi:[1,0]
    v_pk_mul_f32 v[54:55], v[54:55], v[56:57] op_sel_hi:[1,0]
    v_cvt_pk_bf16_f32 v60, v48, v49
    v_cvt_pk_bf16_f32 v61, v50, v51
    v_cvt_pk_bf16_f32 v62, v52, v53
    v_cvt_pk_bf16_f32 v63, v54, v55
    s_cmp_eq_u32 s33, 1
    s_cbranch_scc1 L_xs0
    buffer_store_dwordx4 v[60:63], v1, s[44:47], s57 offen sc1
    v_add3_u32 v56, v60, v61, s56
    v_add3_u32 v56, v62, v63, v56
    buffer_store_dword v56, v14, s[44:47], s58 offen sc1
L_xs0:
    v_add_f32 v239, v239, v10
    v_exp_f32 v224, v224
    v_exp_f32 v225, v225
    v_exp_f32 v226, v226
    v_exp_f32 v227, v227
    v_cvt_pk_bf16_f32 v224, v224, v225
    v_exp_f32 v228, v228
    v_exp_f32 v229, v229
    v_cvt_pk_bf16_f32 v225, v226, v227
    v_exp_f32 v230, v230
    v_exp_f32 v231, v231
    v_cvt_pk_bf16_f32 v226, v228, v229
    v_exp_f32 v232, v232
    v_exp_f32 v233, v233
    v_cvt_pk_bf16_f32 v227, v230, v231
    v_exp_f32 v234, v234
    v_exp_f32 v235, v235
    v_mfma_f32_32x32x16_bf16 v[32:47], v[136:139], v[124:127], v[80:95]
    v_cvt_pk_bf16_f32 v228, v232, v233
    v_exp_f32 v236, v236
    v_exp_f32 v237, v237
    v_cvt_pk_bf16_f32 v229, v234, v235
    v_exp_f32 v238, v238
    v_exp_f32 v239, v239
    v_cvt_pk_bf16_f32 v230, v236, v237
    v_cvt_pk_bf16_f32 v231, v238, v239
    v_bfi_b32 v232, v240, 0, v224
    v_bfi_b32 v233, v241, 0, v225
    v_bfi_b32 v234, v242, 0, v226
    v_bfi_b32 v235, v243, 0, v227
    v_bfi_b32 v236, v244, 0, v228
    v_bfi_b32 v237, v245, 0, v229
    v_bfi_b32 v238, v246, 0, v230
    v_bfi_b32 v239, v247, 0, v231
    v_and_b32 v224, v240, v224
    v_and_b32 v225, v241, v225
    v_and_b32 v226, v242, v226
    v_and_b32 v227, v243, v227
    v_and_b32 v228, v244, v228
    v_and_b32 v229, v245, v229
    v_and_b32 v230, v246, v230
    v_and_b32 v231, v247, v231
    v_exp_f32 v32, v32
    v_mfma_f32_32x32x16_bf16 v[64:79], v[140:143], v[124:127], v[80:95]
    v_exp_f32 v33, v33
    v_exp_f32 v34, v34
    v_exp_f32 v35, v35
    v_cvt_pk_bf16_f32 v32, v32, v33
    v_exp_f32 v36, v36
    v_mfma_f32_32x32x16_bf16 v[48:63], v[108:111], v[224:227], 0
    v_mfma_f32_16x16x32_bf16 v[112:115], v[116:119], v[224:227], 0
    v_exp_f32 v37, v37
    v_cvt_pk_bf16_f32 v33, v34, v35
    v_exp_f32 v38, v38
    v_exp_f32 v39, v39
    v_cvt_pk_bf16_f32 v34, v36, v37
    v_mfma_f32_32x32x16_bf16 v[192:207], v[108:111], v[228:231], 0
    v_mfma_f32_16x16x32_bf16 v[112:115], v[116:119], v[228:231], v[112:115]
    v_exp_f32 v40, v40
    v_exp_f32 v41, v41
    v_cvt_pk_bf16_f32 v35, v38, v39
    v_exp_f32 v42, v42
    v_exp_f32 v43, v43
    v_mfma_f32_32x32x16_bf16 v[48:63], v[164:167], v[232:235], v[48:63]
    v_mfma_f32_16x16x32_bf16 v[112:115], v[208:211], v[232:235], v[112:115]
    v_cvt_pk_bf16_f32 v36, v40, v41
    v_exp_f32 v44, v44
    v_exp_f32 v45, v45
    v_cvt_pk_bf16_f32 v37, v42, v43
    v_exp_f32 v46, v46
    v_mfma_f32_32x32x16_bf16 v[192:207], v[164:167], v[236:239], v[192:207]
    v_mfma_f32_16x16x32_bf16 v[112:115], v[208:211], v[236:239], v[112:115]
    v_exp_f32 v47, v47
    v_cvt_pk_bf16_f32 v38, v44, v45
    v_cvt_pk_bf16_f32 v39, v46, v47
    v_exp_f32 v64, v64
    v_exp_f32 v65, v65
    v_mfma_f32_32x32x16_bf16 v[16:31], v[144:147], v[124:127], v[80:95]
    v_exp_f32 v66, v66
    v_exp_f32 v67, v67
    v_cvt_pk_bf16_f32 v64, v64, v65
    v_exp_f32 v68, v68
    v_exp_f32 v69, v69
    v_cvt_pk_bf16_f32 v65, v66, v67
    v_exp_f32 v70, v70
    v_exp_f32 v71, v71
    v_mfma_f32_32x32x16_bf16 v[48:63], v[168:171], v[32:35], v[48:63]
    v_mfma_f32_16x16x32_bf16 v[112:115], v[212:215], v[32:35], v[112:115]
    v_cvt_pk_bf16_f32 v66, v68, v69
    v_exp_f32 v72, v72
    v_exp_f32 v73, v73
    v_cvt_pk_bf16_f32 v67, v70, v71
    v_exp_f32 v74, v74
    v_exp_f32 v75, v75
    v_cvt_pk_bf16_f32 v68, v72, v73
    v_exp_f32 v76, v76
    v_mfma_f32_32x32x16_bf16 v[192:207], v[168:171], v[36:39], v[192:207]
    v_mfma_f32_16x16x32_bf16 v[112:115], v[212:215], v[36:39], v[112:115]
    v_exp_f32 v77, v77
    v_cvt_pk_bf16_f32 v69, v74, v75
    v_exp_f32 v78, v78
    v_exp_f32 v79, v79
    v_cvt_pk_bf16_f32 v70, v76, v77
    v_cvt_pk_bf16_f32 v71, v78, v79
    v_exp_f32 v16, v16
    v_exp_f32 v17, v17
    v_mfma_f32_32x32x16_bf16 v[32:47], v[148:151], v[124:127], v[80:95]
    v_exp_f32 v18, v18
    v_exp_f32 v19, v19
    v_cvt_pk_bf16_f32 v16, v16, v17
    v_exp_f32 v20, v20
    v_exp_f32 v21, v21
    v_cvt_pk_bf16_f32 v17, v18, v19
    v_exp_f32 v22, v22
    v_exp_f32 v23, v23
    v_mfma_f32_32x32x16_bf16 v[48:63], v[172:175], v[64:67], v[48:63]
    v_mfma_f32_16x16x32_bf16 v[112:115], v[212:215], v[64:67], v[112:115]
    v_cvt_pk_bf16_f32 v18, v20, v21
    v_exp_f32 v24, v24
    v_exp_f32 v25, v25
    v_cvt_pk_bf16_f32 v19, v22, v23
    v_exp_f32 v26, v26
    v_exp_f32 v27, v27
    v_cvt_pk_bf16_f32 v20, v24, v25
    v_exp_f32 v28, v28
    v_mfma_f32_32x32x16_bf16 v[192:207], v[172:175], v[68:71], v[192:207]
    v_mfma_f32_16x16x32_bf16 v[112:115], v[212:215], v[68:71], v[112:115]
    v_exp_f32 v29, v29
    v_cvt_pk_bf16_f32 v21, v26, v27
    v_exp_f32 v30, v30
    v_exp_f32 v31, v31
    v_cvt_pk_bf16_f32 v22, v28, v29
    v_cvt_pk_bf16_f32 v23, v30, v31
    v_exp_f32 v32, v32
    v_exp_f32 v33, v33
    v_mfma_f32_32x32x16_bf16 v[64:79], v[152:155], v[124:127], v[80:95]
    v_exp_f32 v34, v34
    v_exp_f32 v35, v35
    v_cvt_pk_bf16_f32 v32, v32, v33
    v_exp_f32 v36, v36
    v_exp_f32 v37, v37
    v_cvt_pk_bf16_f32 v33, v34, v35
    v_exp_f32 v38, v38
    v_exp_f32 v39, v39
    v_mfma_f32_32x32x16_bf16 v[48:63], v[176:179], v[16:19], v[48:63]
    v_mfma_f32_16x16x32_bf16 v[112:115], v[216:219], v[16:19], v[112:115]
    v_cvt_pk_bf16_f32 v34, v36, v37
    v_exp_f32 v40, v40
    v_exp_f32 v41, v41
    v_cvt_pk_bf16_f32 v35, v38, v39
    v_exp_f32 v42, v42
    v_exp_f32 v43, v43
    v_cvt_pk_bf16_f32 v36, v40, v41
    v_exp_f32 v44, v44
    v_mfma_f32_32x32x16_bf16 v[192:207], v[176:179], v[20:23], v[192:207]
    v_mfma_f32_16x16x32_bf16 v[112:115], v[216:219], v[20:23], v[112:115]
    v_exp_f32 v45, v45
    v_cvt_pk_bf16_f32 v37, v42, v43
    v_exp_f32 v46, v46
    v_exp_f32 v47, v47
    v_cvt_pk_bf16_f32 v38, v44, v45
    v_cvt_pk_bf16_f32 v39, v46, v47
    v_exp_f32 v64, v64
    v_exp_f32 v65, v65
    v_mfma_f32_32x32x16_bf16 v[16:31], v[156:159], v[124:127], v[80:95]
    v_exp_f32 v66, v66
    v_exp_f32 v67, v67
    v_cvt_pk_bf16_f32 v64, v64, v65
    v_exp_f32 v68, v68
    v_exp_f32 v69, v69
    v_cvt_pk_bf16_f32 v65, v66, v67
    v_exp_f32 v70, v70
    v_exp_f32 v71, v71
    v_mfma_f32_32x32x16_bf16 v[48:63], v[180:183], v[32:35], v[48:63]
    v_mfma_f32_16x16x32_bf16 v[112:115], v[216:219], v[32:35], v[112:115]
    v_cvt_pk_bf16_f32 v66, v68, v69
    v_exp_f32 v72, v72
    v_exp_f32 v73, v73
    v_cvt_pk_bf16_f32 v67, v70, v71
    v_exp_f32 v74, v74
    v_exp_f32 v75, v75
    v_cvt_pk_bf16_f32 v68, v72, v73
    v_exp_f32 v76, v76
    v_mfma_f32_32x32x16_bf16 v[192:207], v[180:183], v[36:39], v[192:207]
    v_mfma_f32_16x16x32_bf16 v[112:115], v[216:219], v[36:39], v[112:115]
    v_exp_f32 v77, v77
    v_cvt_pk_bf16_f32 v69, v74, v75
    v_exp_f32 v78, v78
    v_exp_f32 v79, v79
    v_cvt_pk_bf16_f32 v70, v76, v77
    v_cvt_pk_bf16_f32 v71, v78, v79
    v_exp_f32 v16, v16
    v_exp_f32 v17, v17
    v_mfma_f32_32x32x16_bf16 v[32:47], v[96:99], v[124:127], v[80:95]
    v_exp_f32 v18, v18
    v_exp_f32 v19, v19
    v_cvt_pk_bf16_f32 v16, v16, v17
    v_exp_f32 v20, v20
    v_exp_f32 v21, v21
    v_cvt_pk_bf16_f32 v17, v18, v19
    v_exp_f32 v22, v22
    v_exp_f32 v23, v23
    v_mfma_f32_32x32x16_bf16 v[48:63], v[184:187], v[64:67], v[48:63]
    v_mfma_f32_16x16x32_bf16 v[112:115], v[220:223], v[64:67], v[112:115]
    v_cvt_pk_bf16_f32 v18, v20, v21
    v_exp_f32 v24, v24
    v_exp_f32 v25, v25
    v_cvt_pk_bf16_f32 v19, v22, v23
    v_exp_f32 v26, v26
    v_exp_f32 v27, v27
    v_cvt_pk_bf16_f32 v20, v24, v25
    v_exp_f32 v28, v28
    v_mfma_f32_32x32x16_bf16 v[192:207], v[184:187], v[68:71], v[192:207]
    v_mfma_f32_16x16x32_bf16 v[112:115], v[220:223], v[68:71], v[112:115]
    v_exp_f32 v29, v29
    v_cvt_pk_bf16_f32 v21, v26, v27
    v_exp_f32 v30, v30
    v_exp_f32 v31, v31
    v_cvt_pk_bf16_f32 v22, v28, v29
    v_cvt_pk_bf16_f32 v23, v30, v31
    v_exp_f32 v32, v32
    v_exp_f32 v33, v33
    v_mfma_f32_32x32x16_bf16 v[48:63], v[188:191], v[16:19], v[48:63]
    v_mfma_f32_16x16x32_bf16 v[112:115], v[220:223], v[16:19], v[112:115]
    v_exp_f32 v34, v34
    v_exp_f32 v35, v35
    v_cvt_pk_bf16_f32 v32, v32, v33
    v_exp_f32 v36, v36
    v_exp_f32 v37, v37
    v_cvt_pk_bf16_f32 v33, v34, v35
    v_exp_f32 v38, v38
    v_exp_f32 v39, v39
    v_cvt_pk_bf16_f32 v34, v36, v37
    v_exp_f32 v40, v40
    v_exp_f32 v41, v41
    v_cvt_pk_bf16_f32 v35, v38, v39
    v_mfma_f32_32x32x16_bf16 v[192:207], v[188:191], v[20:23], v[192:207]
    v_mfma_f32_16x16x32_bf16 v[112:115], v[220:223], v[20:23], v[112:115]
    v_exp_f32 v42, v42
    v_exp_f32 v43, v43
    v_cvt_pk_bf16_f32 v36, v40, v41
    v_exp_f32 v44, v44
    v_mfma_f32_32x32x16_bf16 v[48:63], v[104:107], v[32:35], v[48:63]
    v_mfma_f32_16x16x32_bf16 v[112:115], v[116:119], v[32:35], v[112:115]
    v_exp_f32 v45, v45
    v_cvt_pk_bf16_f32 v37, v42, v43
    v_exp_f32 v46, v46
    v_exp_f32 v47, v47
    v_cvt_pk_bf16_f32 v38, v44, v45
    v_cvt_pk_bf16_f32 v39, v46, v47
    s_nop 1
    v_mfma_f32_32x32x16_bf16 v[192:207], v[104:107], v[36:39], v[192:207]
    v_mfma_f32_16x16x32_bf16 v[112:115], v[116:119], v[36:39], v[112:115]
    s_bfe_u32 s35, s2, 0x30003
    s_lshr_b32 s57, s2, 6
    s_lshl2_add_u32 s35, s35, s57
    s_and_b32 s38, s2, 7
    s_mul_i32 s38, s38, 14
    s_add_u32 s38, s38, s35
    v_lshrrev_b32 v2, 1, v4
    v_mul_u32_u24 v7, 3584, v2
    v_and_b32 v2, 1, v4
    v_lshl_add_u32 v7, v2, 4, v7
    v_rcp_f32 v56, v112
    s_add_u32 s57, s81, 32768
    s_add_u32 s58, s101, 8192
    s_add_u32 s57, s57, s39
    s_add_u32 s58, s58, s39
    v_pk_add_f32 v[48:49], v[48:49], v[200:201]
    v_pk_add_f32 v[50:51], v[50:51], v[202:203]
    v_pk_add_f32 v[52:53], v[52:53], v[204:205]
    v_pk_add_f32 v[54:55], v[54:55], v[206:207]
    v_pk_mul_f32 v[48:49], v[48:49], v[56:57] op_sel_hi:[1,0]
    v_pk_mul_f32 v[50:51], v[50:51], v[56:57] op_sel_hi:[1,0]
    v_pk_mul_f32 v[52:53], v[52:53], v[56:57] op_sel_hi:[1,0]
    v_pk_mul_f32 v[54:55], v[54:55], v[56:57] op_sel_hi:[1,0]
    v_cvt_pk_bf16_f32 v60, v48, v49
    v_cvt_pk_bf16_f32 v61, v50, v51
    v_cvt_pk_bf16_f32 v62, v52, v53
    v_cvt_pk_bf16_f32 v63, v54, v55
    s_branch L_p2e

.section .rodata,"a"
.p2align 6
.amdhsa_kernel adaLN_cond__sliding_block__moe_arch_mod__prompt_kernel
  .amdhsa_next_free_vgpr 256
  .amdhsa_next_free_sgpr 102
  .amdhsa_accum_offset 256
  .amdhsa_group_segment_fixed_size 0
  .amdhsa_kernarg_size 104
  .amdhsa_user_sgpr_count 2
  .amdhsa_user_sgpr_kernarg_segment_ptr 1
  .amdhsa_system_sgpr_workgroup_id_x 1
.end_amdhsa_kernel
```
